```python
import torch

def _softmax(x, axis=-1):
    return torch.softmax(x, dim=axis)
def _gelu(x):
    return torch.nn.functional.gelu(x, approximate="tanh")
def _silu(x):
    return torch.nn.functional.silu(x)
def _sigmoid(x):
    return torch.sigmoid(x)
def _layernorm(x, axis=-1, eps=1e-5):
    m = x.mean(dim=axis, keepdim=True)
    v = x.var(dim=axis, keepdim=True, unbiased=False)
    return (x - m) / torch.sqrt(v + eps)
def _scatter_add(tgt, idx, src, axis=0):
    return tgt.clone().index_add_(axis, idx, src)
def _segment_sum(src, seg, n):
    out = torch.zeros((n,) + src.shape[1:], dtype=src.dtype)
    return out.index_add_(0, seg, src)
def _pad(x, pw):
    flat = tuple(v for pair in reversed(pw) for v in pair)
    return torch.nn.functional.pad(x, flat)

kernel_name = 'concat_heads__ssm_conv_h3__sliding_block__prompt'

def setup_inputs():

    _w = (lambda a: (lambda t: t.to(torch.bfloat16) if t.is_floating_point() else t)(torch.as_tensor(a)))
    def _A_setup():
        B, S, D = 1, 2048, 1024
        ks = 4
        return {
            "q": _w((lambda *s: torch.randn(*s, dtype=torch.bfloat16) * 0.05)(B, S, D)),
            "k": _w((lambda *s: torch.randn(*s, dtype=torch.bfloat16) * 1.6)(B, S, D)),
            "v": _w((lambda *s: torch.randn(*s, dtype=torch.bfloat16) * 0.8)(B, S, D)),
            "shift_k": _w((lambda *s: torch.randn(*s, dtype=torch.bfloat16) * 1.6)(D, ks) * 0.5),
            "ssm_k": _w((lambda *s: torch.randn(*s, dtype=torch.bfloat16) * 1.6)(D, S) * (1.0 / S ** 0.5)),
            "ssm_D": _w((lambda *s: torch.randn(*s, dtype=torch.bfloat16) * 0.8)(D)),
        }
    _A_in = _A_setup()

    def _B_setup():
        B, S, D = 1, 2048, 1024
        return {
            "x": _w((lambda *s: torch.randn(*s, dtype=torch.bfloat16) * 0.2)(B, S, D)),
            "wqkv": _w((lambda *s: torch.randn(*s, dtype=torch.bfloat16) * 0.2)(D, 3 * D)),
            "wo": _w((lambda *s: torch.randn(*s, dtype=torch.bfloat16) * 0.05)(D, D)),
        }
    _B_in = _B_setup()

    return {
        "A_q": _A_in["q"],
        "A_k": _A_in["k"],
        "A_v": _A_in["v"],
        "A_shift_k": _A_in["shift_k"],
        "A_ssm_k": _A_in["ssm_k"],
        "A_ssm_D": _A_in["ssm_D"],
        "B_x": _B_in["x"],
        "B_wqkv": _B_in["wqkv"],
        "B_wo": _B_in["wo"],
    }

def reference(A_q, A_k, A_v, A_shift_k, A_ssm_k, A_ssm_D, B_x, B_wqkv, B_wo):
    def _A_ref(q, k, v, shift_k, ssm_k, ssm_D):
        B, S, D = q.shape
        ks = shift_k.shape[-1]
        k_pad = _pad(k, ((0, 0), (ks - 1, 0), (0, 0)))
        k_shift = torch.zeros_like(k)
        for t in range(ks):
            k_shift = k_shift + k_pad[:, t:t + S, :] * shift_k[:, ks - 1 - t][None, None, :]
        kv = k_shift * v
        L = 2 * S
        kv_pad = _pad(kv, ((0, 0), (0, S), (0, 0)))
        kf_pad = _pad(ssm_k, ((0, 0), (0, S)))
        kv_f = (lambda x, axes=(-2,-1): torch.fft.rfft2(x.float(), dim=axes))(kv_pad[:, None, :, :], axes=(1, 2))
        kf_f = (lambda x, axes=(-2,-1): torch.fft.rfft2(x.float(), dim=axes))(kf_pad[:, None, :], axes=(1, 2))
        kf_f = (lambda x, *d: x.permute(*d))(kf_f, 1, 2, 0)
        y_f = kv_f * kf_f[None, :, :, :]
        y = (lambda x, s, axes=(-2,-1): torch.fft.irfft2(x, s=s, dim=axes).to(torch.bfloat16))(y_f, (1, L), axes=(1, 2))[:, 0, :S, :]
        y = y + kv * ssm_D[None, None, :]
        return q * y

    def _B_ref(x, wqkv, wo):
        B, S, D = x.shape
        H = 32; Dh = D // H; W = 256
        qkv = (lambda x, *d: x.permute(*d))((x @ wqkv).reshape(B, S, 3, H, Dh), 2, 0, 3, 1, 4)
        q, k, v = qkv[0], qkv[1], qkv[2]
        scores = torch.einsum("bhqd,bhkd->bhqk", q, k) * (Dh ** -0.5)
        idx = torch.arange(S)
        mask = (idx[:, None] - idx[None, :] >= 0) & (idx[:, None] - idx[None, :] < W)
        scores = torch.where(mask[None, None], scores, -1e9)
        p = _softmax(scores, axis=-1)
        o = torch.einsum("bhqk,bhkd->bhqd", p, v)
        return (lambda x, *d: x.permute(*d))(o, 0, 2, 1, 3).reshape(B, S, D) @ wo

    a = _A_ref(A_q, A_k, A_v, A_shift_k, A_ssm_k, A_ssm_D)
    b = _B_ref(B_x, B_wqkv, B_wo)
    return torch.concatenate([a, b], axis=-1)
```

```asm
; @launch grid=(256,1,1) block=(512,1,1) lds=163840
.amdgcn_target "amdgcn-amd-amdhsa--gfx950"
.text
.globl concat_heads__ssm_conv_h3__sliding_block__prompt_kernel
.p2align 8
.type concat_heads__ssm_conv_h3__sliding_block__prompt_kernel,@function
concat_heads__ssm_conv_h3__sliding_block__prompt_kernel:
  s_cmp_ge_u32 s2, 256
  s_cbranch_scc1 mk_end
  s_load_dwordx16 s[76:91], s[0:1], 0
  s_load_dwordx8 s[92:99], s[0:1], 64
  v_lshrrev_b32 v1, 6, v0
  v_and_b32 v0, 63, v0
  v_readfirstlane_b32 s3, v1
  s_getpc_b64 s[4:5]
  s_nop 0
  s_cmp_lt_u32 s3, 6
  s_cbranch_scc1 mk_nocpf
  s_lshr_b32 s6, s2, 3
  s_lshl_b32 s6, s6, 1
  s_add_u32 s6, s6, s3
  s_sub_u32 s6, s6, 6
  s_and_b32 s6, s6, 63
  s_min_u32 s6, s6, ((mk_code_end - concat_heads__ssm_conv_h3__sliding_block__prompt_kernel - 1152) >> 10)
  s_lshl_b32 s6, s6, 10
  v_lshl_add_u32 v1, v0, 4, s6
  global_load_dwordx4 v[100:103], v1, s[4:5]
mk_nocpf:
  s_cmp_ge_u32 s3, 4
  s_cbranch_scc1 mk_ld
  v_and_b32 v2, 15, v0
  v_lshrrev_b32 v3, 4, v0
  s_and_b32 s35, s2, 7
  s_lshr_b32 s36, s2, 7
  s_lshl1_add_u32 s35, s35, s36
  s_bfe_u32 s36, s2, 0x40003
  s_lshl2_add_u32 s36, s36, s3
  s_lshl_b32 s35, s35, 6
  s_lshl_b32 s36, s36, 5
  v_lshl_add_u32 v96, v2, 2, s35
  v_lshl_add_u32 v97, v3, 3, s36
  v_lshlrev_b32 v70, 11, v97
  v_lshl_add_u32 v70, v96, 1, v70
  v_lshlrev_b32 v95, 3, v96
  v_add_u32 v88, 4294959104, v70
  v_add_u32 v89, 4294963200, v70
  v_add_u32 v90, 0, v70
  v_add_u32 v91, 4096, v70
  v_add_u32 v92, 8192, v70
  v_add_u32 v93, 12288, v70
  v_add_u32 v94, 4294961152, v70
  s_mov_b32 s10, 0x400000
  s_mov_b32 s11, 0x00020000
  s_mov_b32 s14, 0x400000
  s_mov_b32 s15, 0x00020000
  s_mov_b32 s18, 0x2000
  s_mov_b32 s19, 0x00020000
  s_waitcnt lgkmcnt(0)
  s_mov_b64 s[16:17], s[82:83]
  s_mov_b64 s[8:9], s[78:79]
  s_mov_b64 s[12:13], s[80:81]
  buffer_load_dwordx4 v[62:65], v95, s[16:19], 0 offen offset:0
  buffer_load_dwordx4 v[66:69], v95, s[16:19], 0 offen offset:16
  buffer_load_dwordx2 v[24:25], v94, s[8:11], 0 offen offset:0 nt
  buffer_load_dwordx2 v[26:27], v89, s[8:11], 0 offen offset:0 nt
  buffer_load_dwordx2 v[28:29], v89, s[8:11], 0 offen offset:2048 nt
  buffer_load_dwordx2 v[30:31], v90, s[8:11], 0 offen offset:0 nt
  buffer_load_dwordx2 v[46:47], v90, s[12:15], 0 offen offset:0 nt
  buffer_load_dwordx2 v[32:33], v90, s[8:11], 0 offen offset:2048 nt
  buffer_load_dwordx2 v[48:49], v90, s[12:15], 0 offen offset:2048 nt
  buffer_load_dwordx2 v[34:35], v91, s[8:11], 0 offen offset:0 nt
  buffer_load_dwordx2 v[50:51], v91, s[12:15], 0 offen offset:0 nt
  buffer_load_dwordx2 v[36:37], v91, s[8:11], 0 offen offset:2048 nt
  buffer_load_dwordx2 v[52:53], v91, s[12:15], 0 offen offset:2048 nt
  buffer_load_dwordx2 v[38:39], v92, s[8:11], 0 offen offset:0 nt
  buffer_load_dwordx2 v[54:55], v92, s[12:15], 0 offen offset:0 nt
  buffer_load_dwordx2 v[40:41], v92, s[8:11], 0 offen offset:2048 nt
  buffer_load_dwordx2 v[56:57], v92, s[12:15], 0 offen offset:2048 nt
  buffer_load_dwordx2 v[42:43], v93, s[8:11], 0 offen offset:0 nt
  buffer_load_dwordx2 v[58:59], v93, s[12:15], 0 offen offset:0 nt
  buffer_load_dwordx2 v[44:45], v93, s[8:11], 0 offen offset:2048 nt
  buffer_load_dwordx2 v[60:61], v93, s[12:15], 0 offen offset:2048 nt
  s_lshl_b32 s38, s35, 12
  s_lshl_b32 s39, s36, 7
  s_add_u32 s38, s38, s39
  v_lshlrev_b32 v71, 8, v2
  v_lshl_add_u32 v71, v3, 4, v71
  v_add_u32 v71, s38, v71
  s_and_b32 s52, s2, 7
  s_lshr_b32 s53, s2, 3
  s_lshr_b32 s54, s53, 1
  s_and_b32 s59, s53, 1
  s_lshl_b32 s56, s52, 1
  s_add_u32 s55, s56, s59
  s_lshl_b32 s51, s52, 5
  s_add_u32 s50, s51, s53
  s_lshl_b32 s51, s50, 2
  s_and_b32 s56, s52, 3
  s_lshl_b32 s56, s56, 2
  s_and_b32 s58, s53, 3
  s_add_u32 s56, s56, s58
  s_lshr_b32 s57, s52, 2
  s_lshl_b32 s57, s57, 3
  s_lshr_b32 s59, s53, 2
  s_add_u32 s57, s57, s59
  s_mul_i32 s58, s58, 4
  s_mul_i32 s59, s59, 2
  s_add_u32 s59, s59, s58
  s_and_b32 s59, s59, 15
  s_add_u32 s68, s98, 0x1800000
  s_addc_u32 s69, s99, 0
  s_mov_b32 s70, 0x2c00
  s_mov_b32 s71, 0x00020000
  s_mov_b32 s72, s96
  s_mov_b32 s73, s97
  s_mov_b32 s74, 0x100
  s_mov_b32 s75, 0x00020000
  s_add_u32 s20, s98, 0x1000000
  s_addc_u32 s21, s99, 0
  s_mov_b32 s22, 0x400000
  s_mov_b32 s23, 0x00020000
  s_add_u32 s12, s98, 0x400000
  s_addc_u32 s13, s99, 0
  s_mov_b32 s14, 0x800000
  s_mov_b32 s15, 0x00020000
  v_and_b32 v4, 31, v0
  s_lshl_b32 s31, s52, 7
  s_add_u32 s31, s31, 1024
  v_lshl_add_u32 v23, v4, 2, s31
  s_add_u32 s38, s51, 1024
  v_mov_b32 v254, s38
  s_getreg_b32 s39, hwreg(HW_REG_XCC_ID)
  s_and_b32 s39, s39, 15
  s_add_u32 s39, s39, 1
  v_mov_b32 v253, s39
  s_cmp_eq_u32 s3, 0
  s_cselect_b32 s48, 5, 0
  s_cmp_eq_u32 s3, 1
  s_cselect_b32 s48, 2, s48
  s_and_b32 s26, s3, 1
  s_lshr_b32 s27, s3, 1
  v_and_b32 v4, 7, v2
  v_lshrrev_b32 v5, 3, v2
  v_lshl_add_u32 v4, v5, 4, v4
  v_lshrrev_b32 v5, 1, v2
  v_xor_b32 v5, v5, v3
  v_lshlrev_b32 v6, 7, v4
  v_lshl_add_u32 v6, v5, 4, v6
  s_lshl_b32 s28, s26, 13
  s_add_u32 s28, s28, 0
  v_add_u32 v8, s28, v6
  v_xor_b32 v9, 64, v8
  v_add_u32 v10, 40960, v8
  v_add_u32 v11, 40960, v9
  v_add_u32 v12, 81920, v8
  v_add_u32 v13, 81920, v9
  v_bfe_u32 v5, v0, 2, 2
  v_lshl_add_u32 v6, v3, 3, v5
  v_lshlrev_b32 v6, 7, v6
  v_bfe_u32 v7, v0, 1, 1
  s_lshl_b32 s28, s27, 2
  v_or_b32 v7, s28, v7
  v_lshrrev_b32 v5, 1, v5
  v_lshlrev_b32 v5, 2, v5
  v_xor_b32 v7, v7, v5
  v_and_b32 v5, 1, v3
  v_lshlrev_b32 v5, 1, v5
  v_xor_b32 v7, v7, v5
  v_lshl_add_u32 v6, v7, 4, v6
  v_and_b32 v5, 1, v0
  v_lshl_add_u32 v6, v5, 3, v6
  v_add_u32 v14, 16384, v6
  v_xor_b32 v15, 32, v14
  v_add_u32 v16, 40960, v14
  v_add_u32 v17, 40960, v15
  v_add_u32 v18, 81920, v14
  v_add_u32 v19, 81920, v15
  v_mov_b32 v104, 0
  v_mov_b32 v105, 0
  v_mov_b32 v106, 0
  v_mov_b32 v107, 0
  v_mov_b32 v108, 0
  v_mov_b32 v109, 0
  v_mov_b32 v110, 0
  v_mov_b32 v111, 0
  v_mov_b32 v112, 0
  v_mov_b32 v113, 0
  v_mov_b32 v114, 0
  v_mov_b32 v115, 0
  v_mov_b32 v116, 0
  v_mov_b32 v117, 0
  v_mov_b32 v118, 0
  v_mov_b32 v119, 0
  v_mov_b32 v120, 0
  v_mov_b32 v121, 0
  v_mov_b32 v122, 0
  v_mov_b32 v123, 0
  v_mov_b32 v124, 0
  v_mov_b32 v125, 0
  v_mov_b32 v126, 0
  v_mov_b32 v127, 0
  v_mov_b32 v128, 0
  v_mov_b32 v129, 0
  v_mov_b32 v130, 0
  v_mov_b32 v131, 0
  v_mov_b32 v132, 0
  v_mov_b32 v133, 0
  v_mov_b32 v134, 0
  v_mov_b32 v135, 0
  v_mov_b32 v136, 0
  v_mov_b32 v137, 0
  v_mov_b32 v138, 0
  v_mov_b32 v139, 0
  v_mov_b32 v140, 0
  v_mov_b32 v141, 0
  v_mov_b32 v142, 0
  v_mov_b32 v143, 0
  v_mov_b32 v144, 0
  v_mov_b32 v145, 0
  v_mov_b32 v146, 0
  v_mov_b32 v147, 0
  v_mov_b32 v148, 0
  v_mov_b32 v149, 0
  v_mov_b32 v150, 0
  v_mov_b32 v151, 0
  v_mov_b32 v152, 0
  v_mov_b32 v153, 0
  v_mov_b32 v154, 0
  v_mov_b32 v155, 0
  v_mov_b32 v156, 0
  v_mov_b32 v157, 0
  v_mov_b32 v158, 0
  v_mov_b32 v159, 0
  v_mov_b32 v160, 0
  v_mov_b32 v161, 0
  v_mov_b32 v162, 0
  v_mov_b32 v163, 0
  v_mov_b32 v164, 0
  v_mov_b32 v165, 0
  v_mov_b32 v166, 0
  v_mov_b32 v167, 0
  v_mov_b32 v168, 0
  v_mov_b32 v169, 0
  v_mov_b32 v170, 0
  v_mov_b32 v171, 0
  v_mov_b32 v172, 0
  v_mov_b32 v173, 0
  v_mov_b32 v174, 0
  v_mov_b32 v175, 0
  v_mov_b32 v176, 0
  v_mov_b32 v177, 0
  v_mov_b32 v178, 0
  v_mov_b32 v179, 0
  v_mov_b32 v180, 0
  v_mov_b32 v181, 0
  v_mov_b32 v182, 0
  v_mov_b32 v183, 0
  v_mov_b32 v184, 0
  v_mov_b32 v185, 0
  v_mov_b32 v186, 0
  v_mov_b32 v187, 0
  v_mov_b32 v188, 0
  v_mov_b32 v189, 0
  v_mov_b32 v190, 0
  v_mov_b32 v191, 0
  v_mov_b32 v192, 0
  v_mov_b32 v193, 0
  v_mov_b32 v194, 0
  v_mov_b32 v195, 0
  v_mov_b32 v196, 0
  v_mov_b32 v197, 0
  v_mov_b32 v198, 0
  v_mov_b32 v199, 0
  v_and_b32 v212, 7, v0
  v_bfe_u32 v213, v0, 4, 1
  v_lshlrev_b32 v213, 2, v213
  v_xor_b32 v212, v212, v213
  v_bfe_u32 v213, v0, 5, 1
  v_lshlrev_b32 v213, 1, v213
  v_xor_b32 v212, v212, v213
  v_lshrrev_b32 v213, 3, v0
  v_lshlrev_b32 v213, 11, v213
  v_lshl_add_u32 v252, v212, 4, v213
  s_lshl_b32 s58, s57, 7
  v_add_u32 v252, s58, v252
  s_mov_b32 s60, s92
  s_mov_b32 s61, s93
  s_mov_b32 s62, 0x200000
  s_mov_b32 s63, 0x00020000
  s_lshr_b32 s38, s3, 2
  s_and_b32 s39, s3, 3
  s_lshl_b32 s24, s55, 1
  s_add_u32 s24, s24, s38
  s_lshl_b32 s25, s54, 2
  s_add_u32 s25, s25, s39
  v_lshlrev_b32 v2, 4, v0
  v_bfe_u32 v1, v0, 3, 1
  v_lshlrev_b32 v1, 10, v1
  v_lshrrev_b32 v6, 5, v0
  v_lshl_add_u32 v1, v6, 8, v1
  v_bfe_u32 v5, v0, 4, 1
  v_lshl_add_u32 v1, v5, 7, v1
  v_and_b32 v7, 7, v0
  v_lshl_add_u32 v1, v7, 4, v1
  v_lshlrev_b32 v3, 10, v5
  v_lshl_add_u32 v3, v6, 8, v3
  v_and_b32 v7, 15, v0
  v_lshl_add_u32 v3, v7, 4, v3
  v_and_b32 v5, 31, v0
  v_lshlrev_b32 v7, 2, v6
  v_sub_u32 v7, v5, v7
  s_xor_b32 s32, s38, 1
  s_mul_i32 s32, s32, 49152
  s_lshl_b32 s33, s39, 11
  s_add_u32 s32, s32, s33
  s_add_u32 s33, s32, 0
  v_add_u32 v4, s33, v1
  s_add_u32 s33, s32, 24576
  v_add_u32 v3, s33, v3
  s_lshl_b32 s33, s3, 11
  s_add_u32 s33, s33, 98304
  v_add_u32 v1, s33, v1
  v_mov_b32 v5, 0xffff
  v_mov_b32 v6, 0xffff0000
  v_cmp_le_i32 vcc, 0, v7
  s_nop 1
  v_cndmask_b32 v232, 0, v5, vcc
  v_cmp_le_i32 vcc, 1, v7
  s_nop 1
  v_cndmask_b32 v212, 0, v6, vcc
  v_or_b32 v232, v232, v212
  v_cmp_le_i32 vcc, 2, v7
  s_nop 1
  v_cndmask_b32 v233, 0, v5, vcc
  v_cmp_le_i32 vcc, 3, v7
  s_nop 1
  v_cndmask_b32 v212, 0, v6, vcc
  v_or_b32 v233, v233, v212
  v_cmp_le_i32 vcc, 8, v7
  s_nop 1
  v_cndmask_b32 v234, 0, v5, vcc
  v_cmp_le_i32 vcc, 9, v7
  s_nop 1
  v_cndmask_b32 v212, 0, v6, vcc
  v_or_b32 v234, v234, v212
  v_cmp_le_i32 vcc, 10, v7
  s_nop 1
  v_cndmask_b32 v235, 0, v5, vcc
  v_cmp_le_i32 vcc, 11, v7
  s_nop 1
  v_cndmask_b32 v212, 0, v6, vcc
  v_or_b32 v235, v235, v212
  v_cmp_le_i32 vcc, 16, v7
  s_nop 1
  v_cndmask_b32 v236, 0, v5, vcc
  v_cmp_le_i32 vcc, 17, v7
  s_nop 1
  v_cndmask_b32 v212, 0, v6, vcc
  v_or_b32 v236, v236, v212
  v_cmp_le_i32 vcc, 18, v7
  s_nop 1
  v_cndmask_b32 v237, 0, v5, vcc
  v_cmp_le_i32 vcc, 19, v7
  s_nop 1
  v_cndmask_b32 v212, 0, v6, vcc
  v_or_b32 v237, v237, v212
  v_cmp_le_i32 vcc, 24, v7
  s_nop 1
  v_cndmask_b32 v238, 0, v5, vcc
  v_cmp_le_i32 vcc, 25, v7
  s_nop 1
  v_cndmask_b32 v212, 0, v6, vcc
  v_or_b32 v238, v238, v212
  v_cmp_le_i32 vcc, 26, v7
  s_nop 1
  v_cndmask_b32 v239, 0, v5, vcc
  v_cmp_le_i32 vcc, 27, v7
  s_nop 1
  v_cndmask_b32 v212, 0, v6, vcc
  v_or_b32 v239, v239, v212
  v_lshrrev_b32 v212, 4, v0
  v_lshrrev_b32 v213, 2, v0
  v_xor_b32 v212, v212, v213
  v_and_b32 v212, 1, v212
  v_cmp_eq_u32 vcc, 0, v212
  v_mov_b32 v213, 0x3f803f80
  s_nop 0
  v_cndmask_b32 v240, 0, v213, vcc
  v_cndmask_b32 v241, 0, v213, vcc
  v_cndmask_b32 v242, 0, v213, vcc
  v_cndmask_b32 v243, 0, v213, vcc
  s_lshl_b32 s31, s54, 2
  s_lshl_b32 s30, s26, 1
  s_add_u32 s37, s30, s31
  s_lshl_b32 s29, s26, 16
  s_lshr_b32 s32, s53, 4
  s_lshl_b32 s28, s52, 1
  s_add_u32 s32, s32, s28
  s_lshl_b32 s32, s32, 1
  s_add_u32 s32, s32, s27
  s_lshl_b32 s32, s32, 17
  s_and_b32 s28, s53, 15
  s_lshl_b32 s28, s28, 8
  s_add_u32 s32, s32, s28
  s_add_u32 s32, s32, s29
  s_xor_b32 s39, s53, 1
  s_lshr_b32 s33, s39, 4
  s_lshl_b32 s28, s52, 1
  s_add_u32 s33, s33, s28
  s_lshl_b32 s33, s33, 1
  s_add_u32 s33, s33, s27
  s_lshl_b32 s33, s33, 17
  s_and_b32 s28, s39, 15
  s_lshl_b32 s28, s28, 8
  s_add_u32 s33, s33, s28
  s_add_u32 s33, s33, s29
  s_lshl_b32 s30, s55, 1
  s_add_u32 s30, s30, s27
  s_lshl_b32 s30, s30, 6
  s_add_u32 s35, s30, s37
  s_lshl_b32 s35, s35, 11
  s_xor_b32 s34, s35, 0
  s_xor_b32 s44, s35, 4456448
  s_add_u32 s38, s54, s26
  s_sub_u32 s38, s38, 2
  s_lshl_b32 s41, s38, 2
  s_add_u32 s41, s41, s30
  s_lshl_b32 s41, s41, 11
  s_lshl_b32 s36, s26, 1
  s_add_u32 s36, s36, s53
  s_sub_u32 s36, s36, 4
  s_xor_b32 s39, s36, 1
  s_lshr_b32 s40, s39, 4
  s_lshl_b32 s28, s52, 1
  s_add_u32 s40, s40, s28
  s_lshl_b32 s40, s40, 1
  s_add_u32 s40, s40, s27
  s_lshl_b32 s40, s40, 17
  s_and_b32 s28, s39, 15
  s_lshl_b32 s28, s28, 8
  s_add_u32 s40, s40, s28
  s_add_u32 s28, s41, 4194304
  s_sub_u32 s29, s36, 96
  s_cmp_lt_i32 s36, 0
  s_cselect_b32 s47, 1, 0
  s_cselect_b32 s40, s28, s40
  s_cselect_b32 s36, s29, s36
  s_cmp_lt_i32 s38, 0
  s_cselect_b32 s41, 0x40000000, s41
  s_cselect_b32 s40, 0x40000000, s40
  s_cselect_b32 s36, s53, s36
  s_xor_b32 s39, s53, 1
  v_mov_b32 v5, s39
  s_xor_b32 s39, s36, 1
  v_writelane_b32 v5, s39, 1
  s_xor_b32 s28, s36, 0
  s_cmp_lt_i32 s38, 0
  s_cselect_b32 s28, s39, s28
  v_writelane_b32 v5, s28, 0
  s_lshr_b32 s28, s54, 1
  s_cmp_eq_u32 s28, 99
  s_cselect_b32 s44, s44, 0
  s_xor_b32 s42, s27, 1
  s_mul_i32 s42, s42, 49152
  s_lshl_b32 s43, s26, 12
  s_add_u32 s43, s43, s42
  s_add_u32 s43, s43, 16384
  s_lshl_b32 s28, s26, 13
  s_add_u32 s42, s42, s28
  s_add_u32 s45, s51, 0
  s_lshl_b32 s28, s52, 7
  v_lshl_add_u32 v20, v5, 2, s28
  v_mov_b32 v21, 0
  s_lshl_b32 s46, s27, 1
  s_add_u32 s46, s46, s26
  s_lshl_b32 s46, s46, 12
  s_add_u32 s46, s46, 98304
  v_and_b32 v5, 1, v0
  v_cmp_eq_u32 s[28:29], 1, v5
  v_mul_u32_u24 v5, 192, v5
  v_sub_u32 v71, v71, v5
  s_waitcnt vmcnt(19)
  v_lshlrev_b32 v72, 16, v62
  v_and_b32 v76, 0xffff0000, v62
  v_lshlrev_b32 v80, 16, v63
  v_and_b32 v84, 0xffff0000, v63
  v_lshlrev_b32 v73, 16, v64
  v_and_b32 v77, 0xffff0000, v64
  v_lshlrev_b32 v81, 16, v65
  v_and_b32 v85, 0xffff0000, v65
  v_lshlrev_b32 v74, 16, v66
  v_and_b32 v78, 0xffff0000, v66
  v_lshlrev_b32 v82, 16, v67
  v_and_b32 v86, 0xffff0000, v67
  v_lshlrev_b32 v75, 16, v68
  v_and_b32 v79, 0xffff0000, v68
  v_lshlrev_b32 v83, 16, v69
  v_and_b32 v87, 0xffff0000, v69
  s_waitcnt vmcnt(18)
  v_lshlrev_b32 v216, 16, v24
  v_and_b32 v217, 0xffff0000, v24
  v_lshlrev_b32 v218, 16, v25
  v_and_b32 v219, 0xffff0000, v25
  s_waitcnt vmcnt(17)
  v_lshlrev_b32 v220, 16, v26
  v_and_b32 v221, 0xffff0000, v26
  v_lshlrev_b32 v222, 16, v27
  v_and_b32 v223, 0xffff0000, v27
  s_waitcnt vmcnt(16)
  v_lshlrev_b32 v224, 16, v28
  v_and_b32 v225, 0xffff0000, v28
  v_lshlrev_b32 v226, 16, v29
  v_and_b32 v227, 0xffff0000, v29
  s_waitcnt vmcnt(15)
  v_lshlrev_b32 v228, 16, v30
  v_and_b32 v229, 0xffff0000, v30
  v_lshlrev_b32 v230, 16, v31
  v_and_b32 v231, 0xffff0000, v31
  v_pk_mul_f32 v[100:101], v[216:217], v[84:85]
  v_pk_mul_f32 v[102:103], v[218:219], v[86:87]
  v_pk_fma_f32 v[100:101], v[220:221], v[80:81], v[100:101]
  v_pk_fma_f32 v[102:103], v[222:223], v[82:83], v[102:103]
  v_pk_fma_f32 v[100:101], v[224:225], v[76:77], v[100:101]
  v_pk_fma_f32 v[102:103], v[226:227], v[78:79], v[102:103]
  v_pk_fma_f32 v[100:101], v[228:229], v[72:73], v[100:101]
  v_pk_fma_f32 v[102:103], v[230:231], v[74:75], v[102:103]
  s_waitcnt vmcnt(14)
  v_lshlrev_b32 v96, 16, v46
  v_and_b32 v97, 0xffff0000, v46
  v_lshlrev_b32 v98, 16, v47
  v_and_b32 v99, 0xffff0000, v47
  v_pk_mul_f32 v[100:101], v[100:101], v[96:97]
  v_pk_mul_f32 v[102:103], v[102:103], v[98:99]
  s_waitcnt vmcnt(13)
  v_lshlrev_b32 v216, 16, v32
  v_and_b32 v217, 0xffff0000, v32
  v_lshlrev_b32 v218, 16, v33
  v_and_b32 v219, 0xffff0000, v33
  v_pk_mul_f32 v[88:89], v[220:221], v[84:85]
  v_pk_mul_f32 v[90:91], v[222:223], v[86:87]
  v_pk_fma_f32 v[88:89], v[224:225], v[80:81], v[88:89]
  v_pk_fma_f32 v[90:91], v[226:227], v[82:83], v[90:91]
  v_pk_fma_f32 v[88:89], v[228:229], v[76:77], v[88:89]
  v_pk_fma_f32 v[90:91], v[230:231], v[78:79], v[90:91]
  v_pk_fma_f32 v[88:89], v[216:217], v[72:73], v[88:89]
  v_pk_fma_f32 v[90:91], v[218:219], v[74:75], v[90:91]
  s_waitcnt vmcnt(12)
  v_lshlrev_b32 v96, 16, v48
  v_and_b32 v97, 0xffff0000, v48
  v_lshlrev_b32 v98, 16, v49
  v_and_b32 v99, 0xffff0000, v49
  v_pk_mul_f32 v[88:89], v[88:89], v[96:97]
  v_pk_mul_f32 v[90:91], v[90:91], v[98:99]
  v_cvt_pk_bf16_f32 v200, v100, v88
  v_cvt_pk_bf16_f32 v204, v101, v89
  v_cvt_pk_bf16_f32 v208, v102, v90
  v_cvt_pk_bf16_f32 v212, v103, v91
  s_waitcnt vmcnt(11)
  v_lshlrev_b32 v220, 16, v34
  v_and_b32 v221, 0xffff0000, v34
  v_lshlrev_b32 v222, 16, v35
  v_and_b32 v223, 0xffff0000, v35
  v_pk_mul_f32 v[100:101], v[224:225], v[84:85]
  v_pk_mul_f32 v[102:103], v[226:227], v[86:87]
  v_pk_fma_f32 v[100:101], v[228:229], v[80:81], v[100:101]
  v_pk_fma_f32 v[102:103], v[230:231], v[82:83], v[102:103]
  v_pk_fma_f32 v[100:101], v[216:217], v[76:77], v[100:101]
  v_pk_fma_f32 v[102:103], v[218:219], v[78:79], v[102:103]
  v_pk_fma_f32 v[100:101], v[220:221], v[72:73], v[100:101]
  v_pk_fma_f32 v[102:103], v[222:223], v[74:75], v[102:103]
  s_waitcnt vmcnt(10)
  v_lshlrev_b32 v96, 16, v50
  v_and_b32 v97, 0xffff0000, v50
  v_lshlrev_b32 v98, 16, v51
  v_and_b32 v99, 0xffff0000, v51
  v_pk_mul_f32 v[100:101], v[100:101], v[96:97]
  v_pk_mul_f32 v[102:103], v[102:103], v[98:99]
  s_waitcnt vmcnt(9)
  v_lshlrev_b32 v224, 16, v36
  v_and_b32 v225, 0xffff0000, v36
  v_lshlrev_b32 v226, 16, v37
  v_and_b32 v227, 0xffff0000, v37
  v_pk_mul_f32 v[88:89], v[228:229], v[84:85]
  v_pk_mul_f32 v[90:91], v[230:231], v[86:87]
  v_pk_fma_f32 v[88:89], v[216:217], v[80:81], v[88:89]
  v_pk_fma_f32 v[90:91], v[218:219], v[82:83], v[90:91]
  v_pk_fma_f32 v[88:89], v[220:221], v[76:77], v[88:89]
  v_pk_fma_f32 v[90:91], v[222:223], v[78:79], v[90:91]
  v_pk_fma_f32 v[88:89], v[224:225], v[72:73], v[88:89]
  v_pk_fma_f32 v[90:91], v[226:227], v[74:75], v[90:91]
  s_waitcnt vmcnt(8)
  v_lshlrev_b32 v96, 16, v52
  v_and_b32 v97, 0xffff0000, v52
  v_lshlrev_b32 v98, 16, v53
  v_and_b32 v99, 0xffff0000, v53
  v_pk_mul_f32 v[88:89], v[88:89], v[96:97]
  v_pk_mul_f32 v[90:91], v[90:91], v[98:99]
  v_cvt_pk_bf16_f32 v201, v100, v88
  v_cvt_pk_bf16_f32 v205, v101, v89
  v_cvt_pk_bf16_f32 v209, v102, v90
  v_cvt_pk_bf16_f32 v213, v103, v91
  s_waitcnt vmcnt(7)
  v_lshlrev_b32 v228, 16, v38
  v_and_b32 v229, 0xffff0000, v38
  v_lshlrev_b32 v230, 16, v39
  v_and_b32 v231, 0xffff0000, v39
  v_pk_mul_f32 v[100:101], v[216:217], v[84:85]
  v_pk_mul_f32 v[102:103], v[218:219], v[86:87]
  v_pk_fma_f32 v[100:101], v[220:221], v[80:81], v[100:101]
  v_pk_fma_f32 v[102:103], v[222:223], v[82:83], v[102:103]
  v_pk_fma_f32 v[100:101], v[224:225], v[76:77], v[100:101]
  v_pk_fma_f32 v[102:103], v[226:227], v[78:79], v[102:103]
  v_pk_fma_f32 v[100:101], v[228:229], v[72:73], v[100:101]
  v_pk_fma_f32 v[102:103], v[230:231], v[74:75], v[102:103]
  s_waitcnt vmcnt(6)
  v_lshlrev_b32 v96, 16, v54
  v_and_b32 v97, 0xffff0000, v54
  v_lshlrev_b32 v98, 16, v55
  v_and_b32 v99, 0xffff0000, v55
  v_pk_mul_f32 v[100:101], v[100:101], v[96:97]
  v_pk_mul_f32 v[102:103], v[102:103], v[98:99]
  s_waitcnt vmcnt(5)
  v_lshlrev_b32 v216, 16, v40
  v_and_b32 v217, 0xffff0000, v40
  v_lshlrev_b32 v218, 16, v41
  v_and_b32 v219, 0xffff0000, v41
  v_pk_mul_f32 v[88:89], v[220:221], v[84:85]
  v_pk_mul_f32 v[90:91], v[222:223], v[86:87]
  v_pk_fma_f32 v[88:89], v[224:225], v[80:81], v[88:89]
  v_pk_fma_f32 v[90:91], v[226:227], v[82:83], v[90:91]
  v_pk_fma_f32 v[88:89], v[228:229], v[76:77], v[88:89]
  v_pk_fma_f32 v[90:91], v[230:231], v[78:79], v[90:91]
  v_pk_fma_f32 v[88:89], v[216:217], v[72:73], v[88:89]
  v_pk_fma_f32 v[90:91], v[218:219], v[74:75], v[90:91]
  s_waitcnt vmcnt(4)
  v_lshlrev_b32 v96, 16, v56
  v_and_b32 v97, 0xffff0000, v56
  v_lshlrev_b32 v98, 16, v57
  v_and_b32 v99, 0xffff0000, v57
  v_pk_mul_f32 v[88:89], v[88:89], v[96:97]
  v_pk_mul_f32 v[90:91], v[90:91], v[98:99]
  v_cvt_pk_bf16_f32 v202, v100, v88
  v_cvt_pk_bf16_f32 v206, v101, v89
  v_cvt_pk_bf16_f32 v210, v102, v90
  v_cvt_pk_bf16_f32 v214, v103, v91
  s_waitcnt vmcnt(3)
  v_lshlrev_b32 v220, 16, v42
  v_and_b32 v221, 0xffff0000, v42
  v_lshlrev_b32 v222, 16, v43
  v_and_b32 v223, 0xffff0000, v43
  v_pk_mul_f32 v[100:101], v[224:225], v[84:85]
  v_pk_mul_f32 v[102:103], v[226:227], v[86:87]
  v_pk_fma_f32 v[100:101], v[228:229], v[80:81], v[100:101]
  v_pk_fma_f32 v[102:103], v[230:231], v[82:83], v[102:103]
  v_pk_fma_f32 v[100:101], v[216:217], v[76:77], v[100:101]
  v_pk_fma_f32 v[102:103], v[218:219], v[78:79], v[102:103]
  v_pk_fma_f32 v[100:101], v[220:221], v[72:73], v[100:101]
  v_pk_fma_f32 v[102:103], v[222:223], v[74:75], v[102:103]
  s_waitcnt vmcnt(2)
  v_lshlrev_b32 v96, 16, v58
  v_and_b32 v97, 0xffff0000, v58
  v_lshlrev_b32 v98, 16, v59
  v_and_b32 v99, 0xffff0000, v59
  v_pk_mul_f32 v[100:101], v[100:101], v[96:97]
  v_pk_mul_f32 v[102:103], v[102:103], v[98:99]
  s_waitcnt vmcnt(1)
  v_lshlrev_b32 v224, 16, v44
  v_and_b32 v225, 0xffff0000, v44
  v_lshlrev_b32 v226, 16, v45
  v_and_b32 v227, 0xffff0000, v45
  v_pk_mul_f32 v[88:89], v[228:229], v[84:85]
  v_pk_mul_f32 v[90:91], v[230:231], v[86:87]
  v_pk_fma_f32 v[88:89], v[216:217], v[80:81], v[88:89]
  v_pk_fma_f32 v[90:91], v[218:219], v[82:83], v[90:91]
  v_pk_fma_f32 v[88:89], v[220:221], v[76:77], v[88:89]
  v_pk_fma_f32 v[90:91], v[222:223], v[78:79], v[90:91]
  v_pk_fma_f32 v[88:89], v[224:225], v[72:73], v[88:89]
  v_pk_fma_f32 v[90:91], v[226:227], v[74:75], v[90:91]
  s_waitcnt vmcnt(0)
  v_lshlrev_b32 v96, 16, v60
  v_and_b32 v97, 0xffff0000, v60
  v_lshlrev_b32 v98, 16, v61
  v_and_b32 v99, 0xffff0000, v61
  v_pk_mul_f32 v[88:89], v[88:89], v[96:97]
  v_pk_mul_f32 v[90:91], v[90:91], v[98:99]
  v_cvt_pk_bf16_f32 v203, v100, v88
  v_cvt_pk_bf16_f32 v207, v101, v89
  v_cvt_pk_bf16_f32 v211, v102, v90
  v_cvt_pk_bf16_f32 v215, v103, v91
  v_mov_b32_dpp v216, v204 quad_perm:[0,0,2,2] row_mask:0xf bank_mask:0xf
  v_mov_b32_dpp v220, v200 quad_perm:[1,1,3,3] row_mask:0xf bank_mask:0xf
  v_mov_b32_dpp v217, v205 quad_perm:[0,0,2,2] row_mask:0xf bank_mask:0xf
  v_mov_b32_dpp v221, v201 quad_perm:[1,1,3,3] row_mask:0xf bank_mask:0xf
  v_mov_b32_dpp v218, v206 quad_perm:[0,0,2,2] row_mask:0xf bank_mask:0xf
  v_mov_b32_dpp v222, v202 quad_perm:[1,1,3,3] row_mask:0xf bank_mask:0xf
  v_mov_b32_dpp v219, v207 quad_perm:[0,0,2,2] row_mask:0xf bank_mask:0xf
  v_mov_b32_dpp v223, v203 quad_perm:[1,1,3,3] row_mask:0xf bank_mask:0xf
  v_cndmask_b32 v216, v200, v216, s[28:29]
  v_cndmask_b32 v220, v220, v204, s[28:29]
  v_cndmask_b32 v217, v201, v217, s[28:29]
  v_cndmask_b32 v221, v221, v205, s[28:29]
  v_cndmask_b32 v218, v202, v218, s[28:29]
  v_cndmask_b32 v222, v222, v206, s[28:29]
  v_cndmask_b32 v219, v203, v219, s[28:29]
  v_cndmask_b32 v223, v223, v207, s[28:29]
  v_mov_b32_dpp v224, v212 quad_perm:[0,0,2,2] row_mask:0xf bank_mask:0xf
  v_mov_b32_dpp v228, v208 quad_perm:[1,1,3,3] row_mask:0xf bank_mask:0xf
  v_mov_b32_dpp v225, v213 quad_perm:[0,0,2,2] row_mask:0xf bank_mask:0xf
  v_mov_b32_dpp v229, v209 quad_perm:[1,1,3,3] row_mask:0xf bank_mask:0xf
  v_mov_b32_dpp v226, v214 quad_perm:[0,0,2,2] row_mask:0xf bank_mask:0xf
  v_mov_b32_dpp v230, v210 quad_perm:[1,1,3,3] row_mask:0xf bank_mask:0xf
  v_mov_b32_dpp v227, v215 quad_perm:[0,0,2,2] row_mask:0xf bank_mask:0xf
  v_mov_b32_dpp v231, v211 quad_perm:[1,1,3,3] row_mask:0xf bank_mask:0xf
  v_cndmask_b32 v224, v208, v224, s[28:29]
  v_cndmask_b32 v228, v228, v212, s[28:29]
  v_cndmask_b32 v225, v209, v225, s[28:29]
  v_cndmask_b32 v229, v229, v213, s[28:29]
  v_cndmask_b32 v226, v210, v226, s[28:29]
  v_cndmask_b32 v230, v230, v214, s[28:29]
  v_cndmask_b32 v227, v211, v227, s[28:29]
  v_cndmask_b32 v231, v231, v215, s[28:29]
  v_mov_b32 v215, v71
  s_lshr_b32 s37, s53, 2
  s_and_b32 s37, s37, 7
  s_barrier
  ds_read_b64_tr_b16 v[48:49], v14 offset:8192
  ds_read_b64_tr_b16 v[50:51], v14 offset:8704
  ds_read_b64_tr_b16 v[88:89], v14 offset:12288
  ds_read_b64_tr_b16 v[90:91], v14 offset:12800
  ds_read_b64_tr_b16 v[92:93], v15 offset:12288
  ds_read_b64_tr_b16 v[94:95], v15 offset:12800
  ds_read_b128 v[24:27], v8 offset:0
  ds_read_b128 v[64:67], v9 offset:0
  ds_read_b64_tr_b16 v[52:53], v15 offset:8192
  ds_read_b64_tr_b16 v[54:55], v15 offset:8704
  ds_read_b64_tr_b16 v[56:57], v14 offset:16384
  ds_read_b64_tr_b16 v[58:59], v14 offset:16896
  ds_read_b128 v[28:31], v8 offset:1024
  ds_read_b128 v[68:71], v9 offset:1024
  ds_read_b64_tr_b16 v[96:97], v14 offset:20480
  ds_read_b64_tr_b16 v[98:99], v14 offset:20992
  ds_read_b128 v[32:35], v8 offset:4096
  ds_read_b128 v[72:75], v9 offset:4096
  s_bitcmp1_b32 1, s37
  s_cbranch_scc1 g1_us0
g1_ub0:
  s_waitcnt lgkmcnt(14)
  s_waitcnt lgkmcnt(10)
  v_mfma_f32_16x16x32_bf16 v[136:139], v[48:51], v[24:27], v[136:139]
  ds_read_b128 v[36:39], v8 offset:5120
  v_mfma_f32_16x16x32_bf16 v[136:139], v[88:91], v[64:67], v[136:139]
  ds_read_b128 v[76:79], v9 offset:5120
  s_waitcnt lgkmcnt(10)
  v_mfma_f32_16x16x32_bf16 v[152:155], v[92:95], v[64:67], v[152:155]
  ds_read_b64_tr_b16 v[60:61], v15 offset:16384
  v_mfma_f32_16x16x32_bf16 v[152:155], v[52:55], v[24:27], v[152:155]
  s_waitcnt lgkmcnt(5)
  v_mfma_f32_16x16x32_bf16 v[168:171], v[24:27], v[56:59], v[168:171]
  ds_read_b64_tr_b16 v[62:63], v15 offset:16896
  v_mfma_f32_16x16x32_bf16 v[168:171], v[64:67], v[96:99], v[168:171]
  ds_read_b64_tr_b16 v[100:101], v15 offset:20480
  v_mfma_f32_16x16x32_bf16 v[172:175], v[68:71], v[96:99], v[172:175]
  v_mfma_f32_16x16x32_bf16 v[172:175], v[28:31], v[56:59], v[172:175]
  ds_read_b64_tr_b16 v[102:103], v15 offset:20992
  v_mfma_f32_16x16x32_bf16 v[156:159], v[52:55], v[28:31], v[156:159]
  ds_read_b64_tr_b16 v[80:81], v14 offset:4096
  v_mfma_f32_16x16x32_bf16 v[156:159], v[92:95], v[68:71], v[156:159]
  v_mfma_f32_16x16x32_bf16 v[140:143], v[88:91], v[68:71], v[140:143]
  ds_read_b64_tr_b16 v[82:83], v14 offset:4608
  v_mfma_f32_16x16x32_bf16 v[140:143], v[48:51], v[28:31], v[140:143]
  ds_read_b64_tr_b16 v[40:41], v14 offset:0
  s_waitcnt lgkmcnt(9)
  v_mfma_f32_16x16x32_bf16 v[144:147], v[48:51], v[32:35], v[144:147]
  ds_read_b64_tr_b16 v[42:43], v14 offset:512
  v_mfma_f32_16x16x32_bf16 v[144:147], v[88:91], v[72:75], v[144:147]
  v_mfma_f32_16x16x32_bf16 v[160:163], v[92:95], v[72:75], v[160:163]
  ds_read_b64_tr_b16 v[44:45], v15 offset:0
  v_mfma_f32_16x16x32_bf16 v[160:163], v[52:55], v[32:35], v[160:163]
  ds_read_b64_tr_b16 v[46:47], v15 offset:512
  v_mfma_f32_16x16x32_bf16 v[176:179], v[32:35], v[56:59], v[176:179]
  v_mfma_f32_16x16x32_bf16 v[176:179], v[72:75], v[96:99], v[176:179]
  ds_read_b64_tr_b16 v[84:85], v15 offset:4096
  s_waitcnt lgkmcnt(11)
  v_mfma_f32_16x16x32_bf16 v[180:183], v[76:79], v[96:99], v[180:183]
  ds_read_b64_tr_b16 v[86:87], v15 offset:4608
  v_mfma_f32_16x16x32_bf16 v[180:183], v[36:39], v[56:59], v[180:183]
  v_mfma_f32_16x16x32_bf16 v[164:167], v[52:55], v[36:39], v[164:167]
  v_mfma_f32_16x16x32_bf16 v[164:167], v[92:95], v[76:79], v[164:167]
  v_mfma_f32_16x16x32_bf16 v[148:151], v[88:91], v[76:79], v[148:151]
  v_mfma_f32_16x16x32_bf16 v[148:151], v[48:51], v[36:39], v[148:151]
  s_waitcnt lgkmcnt(0)
  v_mfma_f32_16x16x32_bf16 v[184:187], v[24:27], v[60:63], v[184:187]
  s_barrier
  ds_read_b64_tr_b16 v[48:49], v16 offset:8192
  v_mfma_f32_16x16x32_bf16 v[184:187], v[64:67], v[100:103], v[184:187]
  ds_read_b64_tr_b16 v[50:51], v16 offset:8704
  v_mfma_f32_16x16x32_bf16 v[104:107], v[80:83], v[64:67], v[104:107]
  ds_read_b64_tr_b16 v[88:89], v16 offset:12288
  v_mfma_f32_16x16x32_bf16 v[104:107], v[40:43], v[24:27], v[104:107]
  ds_read_b64_tr_b16 v[90:91], v16 offset:12800
  v_mfma_f32_16x16x32_bf16 v[120:123], v[44:47], v[24:27], v[120:123]
  ds_read_b64_tr_b16 v[92:93], v17 offset:12288
  v_mfma_f32_16x16x32_bf16 v[120:123], v[84:87], v[64:67], v[120:123]
  ds_read_b64_tr_b16 v[94:95], v17 offset:12800
  v_mfma_f32_16x16x32_bf16 v[124:127], v[84:87], v[68:71], v[124:127]
  ds_read_b128 v[24:27], v10 offset:0
  v_mfma_f32_16x16x32_bf16 v[124:127], v[44:47], v[28:31], v[124:127]
  ds_read_b128 v[64:67], v11 offset:0
  v_mfma_f32_16x16x32_bf16 v[108:111], v[40:43], v[28:31], v[108:111]
  ds_read_b64_tr_b16 v[52:53], v17 offset:8192
  s_bitcmp1_b32 2, s37
  s_cbranch_scc1 g1_us2
g1_ub2:
  v_mfma_f32_16x16x32_bf16 v[108:111], v[80:83], v[68:71], v[108:111]
  ds_read_b64_tr_b16 v[54:55], v17 offset:8704
  v_mfma_f32_16x16x32_bf16 v[188:191], v[68:71], v[100:103], v[188:191]
  ds_read_b64_tr_b16 v[56:57], v16 offset:16384
  v_mfma_f32_16x16x32_bf16 v[188:191], v[28:31], v[60:63], v[188:191]
  ds_read_b64_tr_b16 v[58:59], v16 offset:16896
  v_mfma_f32_16x16x32_bf16 v[192:195], v[32:35], v[60:63], v[192:195]
  ds_read_b128 v[28:31], v10 offset:1024
  v_mfma_f32_16x16x32_bf16 v[192:195], v[72:75], v[100:103], v[192:195]
  ds_read_b128 v[68:71], v11 offset:1024
  s_waitcnt lgkmcnt(10)
  v_mfma_f32_16x16x32_bf16 v[112:115], v[80:83], v[72:75], v[112:115]
  ds_read_b64_tr_b16 v[96:97], v16 offset:20480
  v_mfma_f32_16x16x32_bf16 v[112:115], v[40:43], v[32:35], v[112:115]
  ds_read_b64_tr_b16 v[98:99], v16 offset:20992
  v_mfma_f32_16x16x32_bf16 v[128:131], v[44:47], v[32:35], v[128:131]
  v_mfma_f32_16x16x32_bf16 v[128:131], v[84:87], v[72:75], v[128:131]
  v_mfma_f32_16x16x32_bf16 v[132:135], v[84:87], v[76:79], v[132:135]
  ds_read_b128 v[32:35], v10 offset:4096
  v_mfma_f32_16x16x32_bf16 v[132:135], v[44:47], v[36:39], v[132:135]
  ds_read_b128 v[72:75], v11 offset:4096
  v_mfma_f32_16x16x32_bf16 v[116:119], v[40:43], v[36:39], v[116:119]
  v_mfma_f32_16x16x32_bf16 v[116:119], v[80:83], v[76:79], v[116:119]
  v_mfma_f32_16x16x32_bf16 v[196:199], v[76:79], v[100:103], v[196:199]
  v_mfma_f32_16x16x32_bf16 v[196:199], v[36:39], v[60:63], v[196:199]
  s_waitcnt lgkmcnt(10)
  v_mfma_f32_16x16x32_bf16 v[136:139], v[48:51], v[24:27], v[136:139]
  ds_read_b128 v[36:39], v10 offset:5120
  v_mfma_f32_16x16x32_bf16 v[136:139], v[88:91], v[64:67], v[136:139]
  ds_read_b128 v[76:79], v11 offset:5120
  s_waitcnt lgkmcnt(10)
  v_mfma_f32_16x16x32_bf16 v[152:155], v[92:95], v[64:67], v[152:155]
  ds_read_b64_tr_b16 v[60:61], v17 offset:16384
  v_mfma_f32_16x16x32_bf16 v[152:155], v[52:55], v[24:27], v[152:155]
  s_waitcnt lgkmcnt(5)
  v_mfma_f32_16x16x32_bf16 v[168:171], v[24:27], v[56:59], v[168:171]
  ds_read_b64_tr_b16 v[62:63], v17 offset:16896
  v_mfma_f32_16x16x32_bf16 v[168:171], v[64:67], v[96:99], v[168:171]
  ds_read_b64_tr_b16 v[100:101], v17 offset:20480
  v_mfma_f32_16x16x32_bf16 v[172:175], v[68:71], v[96:99], v[172:175]
  v_mfma_f32_16x16x32_bf16 v[172:175], v[28:31], v[56:59], v[172:175]
  ds_read_b64_tr_b16 v[102:103], v17 offset:20992
  v_mfma_f32_16x16x32_bf16 v[156:159], v[52:55], v[28:31], v[156:159]
  ds_read_b64_tr_b16 v[80:81], v16 offset:4096
  v_mfma_f32_16x16x32_bf16 v[156:159], v[92:95], v[68:71], v[156:159]
  v_mfma_f32_16x16x32_bf16 v[140:143], v[88:91], v[68:71], v[140:143]
  ds_read_b64_tr_b16 v[82:83], v16 offset:4608
  v_mfma_f32_16x16x32_bf16 v[140:143], v[48:51], v[28:31], v[140:143]
  ds_read_b64_tr_b16 v[40:41], v16 offset:0
  s_waitcnt lgkmcnt(9)
  v_mfma_f32_16x16x32_bf16 v[144:147], v[48:51], v[32:35], v[144:147]
  ds_read_b64_tr_b16 v[42:43], v16 offset:512
  v_mfma_f32_16x16x32_bf16 v[144:147], v[88:91], v[72:75], v[144:147]
  v_mfma_f32_16x16x32_bf16 v[160:163], v[92:95], v[72:75], v[160:163]
  ds_read_b64_tr_b16 v[44:45], v17 offset:0
  v_mfma_f32_16x16x32_bf16 v[160:163], v[52:55], v[32:35], v[160:163]
  ds_read_b64_tr_b16 v[46:47], v17 offset:512
  v_mfma_f32_16x16x32_bf16 v[176:179], v[32:35], v[56:59], v[176:179]
  v_mfma_f32_16x16x32_bf16 v[176:179], v[72:75], v[96:99], v[176:179]
  ds_read_b64_tr_b16 v[84:85], v17 offset:4096
  s_waitcnt lgkmcnt(11)
  v_mfma_f32_16x16x32_bf16 v[180:183], v[76:79], v[96:99], v[180:183]
  ds_read_b64_tr_b16 v[86:87], v17 offset:4608
  v_mfma_f32_16x16x32_bf16 v[180:183], v[36:39], v[56:59], v[180:183]
  v_mfma_f32_16x16x32_bf16 v[164:167], v[52:55], v[36:39], v[164:167]
  v_mfma_f32_16x16x32_bf16 v[164:167], v[92:95], v[76:79], v[164:167]
  v_mfma_f32_16x16x32_bf16 v[148:151], v[88:91], v[76:79], v[148:151]
  v_mfma_f32_16x16x32_bf16 v[148:151], v[48:51], v[36:39], v[148:151]
  s_waitcnt lgkmcnt(0)
  v_mfma_f32_16x16x32_bf16 v[184:187], v[24:27], v[60:63], v[184:187]
  s_barrier
  ds_read_b64_tr_b16 v[48:49], v18 offset:8192
  v_mfma_f32_16x16x32_bf16 v[184:187], v[64:67], v[100:103], v[184:187]
  ds_read_b64_tr_b16 v[50:51], v18 offset:8704
  v_mfma_f32_16x16x32_bf16 v[104:107], v[80:83], v[64:67], v[104:107]
  ds_read_b64_tr_b16 v[88:89], v18 offset:12288
  v_mfma_f32_16x16x32_bf16 v[104:107], v[40:43], v[24:27], v[104:107]
  ds_read_b64_tr_b16 v[90:91], v18 offset:12800
  v_mfma_f32_16x16x32_bf16 v[120:123], v[44:47], v[24:27], v[120:123]
  ds_read_b64_tr_b16 v[92:93], v19 offset:12288
  v_mfma_f32_16x16x32_bf16 v[120:123], v[84:87], v[64:67], v[120:123]
  ds_read_b64_tr_b16 v[94:95], v19 offset:12800
  v_mfma_f32_16x16x32_bf16 v[124:127], v[84:87], v[68:71], v[124:127]
  ds_read_b128 v[24:27], v12 offset:0
  v_mfma_f32_16x16x32_bf16 v[124:127], v[44:47], v[28:31], v[124:127]
  ds_read_b128 v[64:67], v13 offset:0
  v_mfma_f32_16x16x32_bf16 v[108:111], v[40:43], v[28:31], v[108:111]
  ds_read_b64_tr_b16 v[52:53], v19 offset:8192
  s_bitcmp1_b32 4, s37
  s_cbranch_scc1 g1_us4
g1_ub4:
  v_mfma_f32_16x16x32_bf16 v[108:111], v[80:83], v[68:71], v[108:111]
  ds_read_b64_tr_b16 v[54:55], v19 offset:8704
  v_mfma_f32_16x16x32_bf16 v[188:191], v[68:71], v[100:103], v[188:191]
  ds_read_b64_tr_b16 v[56:57], v18 offset:16384
  v_mfma_f32_16x16x32_bf16 v[188:191], v[28:31], v[60:63], v[188:191]
  ds_read_b64_tr_b16 v[58:59], v18 offset:16896
  v_mfma_f32_16x16x32_bf16 v[192:195], v[32:35], v[60:63], v[192:195]
  ds_read_b128 v[28:31], v12 offset:1024
  v_mfma_f32_16x16x32_bf16 v[192:195], v[72:75], v[100:103], v[192:195]
  ds_read_b128 v[68:71], v13 offset:1024
  s_waitcnt lgkmcnt(10)
  v_mfma_f32_16x16x32_bf16 v[112:115], v[80:83], v[72:75], v[112:115]
  ds_read_b64_tr_b16 v[96:97], v18 offset:20480
  v_mfma_f32_16x16x32_bf16 v[112:115], v[40:43], v[32:35], v[112:115]
  ds_read_b64_tr_b16 v[98:99], v18 offset:20992
  v_mfma_f32_16x16x32_bf16 v[128:131], v[44:47], v[32:35], v[128:131]
  v_mfma_f32_16x16x32_bf16 v[128:131], v[84:87], v[72:75], v[128:131]
  v_mfma_f32_16x16x32_bf16 v[132:135], v[84:87], v[76:79], v[132:135]
  ds_read_b128 v[32:35], v12 offset:4096
  v_mfma_f32_16x16x32_bf16 v[132:135], v[44:47], v[36:39], v[132:135]
  ds_read_b128 v[72:75], v13 offset:4096
  v_mfma_f32_16x16x32_bf16 v[116:119], v[40:43], v[36:39], v[116:119]
  v_mfma_f32_16x16x32_bf16 v[116:119], v[80:83], v[76:79], v[116:119]
  v_mfma_f32_16x16x32_bf16 v[196:199], v[76:79], v[100:103], v[196:199]
  v_mfma_f32_16x16x32_bf16 v[196:199], v[36:39], v[60:63], v[196:199]
  s_waitcnt lgkmcnt(10)
  v_mfma_f32_16x16x32_bf16 v[136:139], v[48:51], v[24:27], v[136:139]
  ds_read_b128 v[36:39], v12 offset:5120
  v_mfma_f32_16x16x32_bf16 v[136:139], v[88:91], v[64:67], v[136:139]
  ds_read_b128 v[76:79], v13 offset:5120
  s_waitcnt lgkmcnt(10)
  v_mfma_f32_16x16x32_bf16 v[152:155], v[92:95], v[64:67], v[152:155]
  ds_read_b64_tr_b16 v[60:61], v19 offset:16384
  v_mfma_f32_16x16x32_bf16 v[152:155], v[52:55], v[24:27], v[152:155]
  s_waitcnt lgkmcnt(5)
  v_mfma_f32_16x16x32_bf16 v[168:171], v[24:27], v[56:59], v[168:171]
  ds_read_b64_tr_b16 v[62:63], v19 offset:16896
  v_mfma_f32_16x16x32_bf16 v[168:171], v[64:67], v[96:99], v[168:171]
  ds_read_b64_tr_b16 v[100:101], v19 offset:20480
  v_mfma_f32_16x16x32_bf16 v[172:175], v[68:71], v[96:99], v[172:175]
  v_mfma_f32_16x16x32_bf16 v[172:175], v[28:31], v[56:59], v[172:175]
  ds_read_b64_tr_b16 v[102:103], v19 offset:20992
  v_mfma_f32_16x16x32_bf16 v[156:159], v[52:55], v[28:31], v[156:159]
  ds_read_b64_tr_b16 v[80:81], v18 offset:4096
  v_mfma_f32_16x16x32_bf16 v[156:159], v[92:95], v[68:71], v[156:159]
  v_mfma_f32_16x16x32_bf16 v[140:143], v[88:91], v[68:71], v[140:143]
  ds_read_b64_tr_b16 v[82:83], v18 offset:4608
  v_mfma_f32_16x16x32_bf16 v[140:143], v[48:51], v[28:31], v[140:143]
  ds_read_b64_tr_b16 v[40:41], v18 offset:0
  s_waitcnt lgkmcnt(9)
  v_mfma_f32_16x16x32_bf16 v[144:147], v[48:51], v[32:35], v[144:147]
  ds_read_b64_tr_b16 v[42:43], v18 offset:512
  v_mfma_f32_16x16x32_bf16 v[144:147], v[88:91], v[72:75], v[144:147]
  v_mfma_f32_16x16x32_bf16 v[160:163], v[92:95], v[72:75], v[160:163]
  ds_read_b64_tr_b16 v[44:45], v19 offset:0
  v_mfma_f32_16x16x32_bf16 v[160:163], v[52:55], v[32:35], v[160:163]
  ds_read_b64_tr_b16 v[46:47], v19 offset:512
  v_mfma_f32_16x16x32_bf16 v[176:179], v[32:35], v[56:59], v[176:179]
  v_mfma_f32_16x16x32_bf16 v[176:179], v[72:75], v[96:99], v[176:179]
  ds_read_b64_tr_b16 v[84:85], v19 offset:4096
  s_waitcnt lgkmcnt(11)
  v_mfma_f32_16x16x32_bf16 v[180:183], v[76:79], v[96:99], v[180:183]
  ds_read_b64_tr_b16 v[86:87], v19 offset:4608
  v_mfma_f32_16x16x32_bf16 v[180:183], v[36:39], v[56:59], v[180:183]
  v_mfma_f32_16x16x32_bf16 v[164:167], v[52:55], v[36:39], v[164:167]
  v_mfma_f32_16x16x32_bf16 v[164:167], v[92:95], v[76:79], v[164:167]
  v_mfma_f32_16x16x32_bf16 v[148:151], v[88:91], v[76:79], v[148:151]
  v_mfma_f32_16x16x32_bf16 v[148:151], v[48:51], v[36:39], v[148:151]
  s_waitcnt lgkmcnt(0)
  v_mfma_f32_16x16x32_bf16 v[184:187], v[24:27], v[60:63], v[184:187]
  s_barrier
  ds_read_b64_tr_b16 v[48:49], v14 offset:8192
  v_mfma_f32_16x16x32_bf16 v[184:187], v[64:67], v[100:103], v[184:187]
  ds_read_b64_tr_b16 v[50:51], v14 offset:8704
  v_mfma_f32_16x16x32_bf16 v[104:107], v[80:83], v[64:67], v[104:107]
  ds_read_b64_tr_b16 v[88:89], v14 offset:12288
  v_mfma_f32_16x16x32_bf16 v[104:107], v[40:43], v[24:27], v[104:107]
  ds_read_b64_tr_b16 v[90:91], v14 offset:12800
  v_mfma_f32_16x16x32_bf16 v[120:123], v[44:47], v[24:27], v[120:123]
  ds_read_b64_tr_b16 v[92:93], v15 offset:12288
  buffer_load_dword v22, v21, s[72:75], 0 offen sc1
  v_mfma_f32_16x16x32_bf16 v[120:123], v[84:87], v[64:67], v[120:123]
  ds_read_b64_tr_b16 v[94:95], v15 offset:12800
  v_mfma_f32_16x16x32_bf16 v[124:127], v[84:87], v[68:71], v[124:127]
  ds_read_b128 v[24:27], v8 offset:0
  v_mfma_f32_16x16x32_bf16 v[124:127], v[44:47], v[28:31], v[124:127]
  ds_read_b128 v[64:67], v9 offset:0
  v_mfma_f32_16x16x32_bf16 v[108:111], v[40:43], v[28:31], v[108:111]
  ds_read_b64_tr_b16 v[52:53], v15 offset:8192
  s_bitcmp1_b32 8, s37
  s_cbranch_scc1 g1_us6
g1_ub6:
  v_mfma_f32_16x16x32_bf16 v[108:111], v[80:83], v[68:71], v[108:111]
  ds_read_b64_tr_b16 v[54:55], v15 offset:8704
  v_mfma_f32_16x16x32_bf16 v[188:191], v[68:71], v[100:103], v[188:191]
  ds_read_b64_tr_b16 v[56:57], v14 offset:16384
  v_mfma_f32_16x16x32_bf16 v[188:191], v[28:31], v[60:63], v[188:191]
  ds_read_b64_tr_b16 v[58:59], v14 offset:16896
  v_mfma_f32_16x16x32_bf16 v[192:195], v[32:35], v[60:63], v[192:195]
  ds_read_b128 v[28:31], v8 offset:1024
  v_mfma_f32_16x16x32_bf16 v[192:195], v[72:75], v[100:103], v[192:195]
  ds_read_b128 v[68:71], v9 offset:1024
  s_waitcnt lgkmcnt(10)
  v_mfma_f32_16x16x32_bf16 v[112:115], v[80:83], v[72:75], v[112:115]
  ds_read_b64_tr_b16 v[96:97], v14 offset:20480
  v_mfma_f32_16x16x32_bf16 v[112:115], v[40:43], v[32:35], v[112:115]
  ds_read_b64_tr_b16 v[98:99], v14 offset:20992
  v_mfma_f32_16x16x32_bf16 v[128:131], v[44:47], v[32:35], v[128:131]
  v_mfma_f32_16x16x32_bf16 v[128:131], v[84:87], v[72:75], v[128:131]
  v_mfma_f32_16x16x32_bf16 v[132:135], v[84:87], v[76:79], v[132:135]
  ds_read_b128 v[32:35], v8 offset:4096
  v_mfma_f32_16x16x32_bf16 v[132:135], v[44:47], v[36:39], v[132:135]
  ds_read_b128 v[72:75], v9 offset:4096
  v_mfma_f32_16x16x32_bf16 v[116:119], v[40:43], v[36:39], v[116:119]
  v_mfma_f32_16x16x32_bf16 v[116:119], v[80:83], v[76:79], v[116:119]
  v_mfma_f32_16x16x32_bf16 v[196:199], v[76:79], v[100:103], v[196:199]
  v_mfma_f32_16x16x32_bf16 v[196:199], v[36:39], v[60:63], v[196:199]
  s_waitcnt lgkmcnt(10)
  v_mfma_f32_16x16x32_bf16 v[136:139], v[48:51], v[24:27], v[136:139]
  ds_read_b128 v[36:39], v8 offset:5120
  v_mfma_f32_16x16x32_bf16 v[136:139], v[88:91], v[64:67], v[136:139]
  ds_read_b128 v[76:79], v9 offset:5120
  s_waitcnt lgkmcnt(10)
  v_mfma_f32_16x16x32_bf16 v[152:155], v[92:95], v[64:67], v[152:155]
  ds_read_b64_tr_b16 v[60:61], v15 offset:16384
  v_mfma_f32_16x16x32_bf16 v[152:155], v[52:55], v[24:27], v[152:155]
  s_waitcnt lgkmcnt(5)
  v_mfma_f32_16x16x32_bf16 v[168:171], v[24:27], v[56:59], v[168:171]
  ds_read_b64_tr_b16 v[62:63], v15 offset:16896
  v_mfma_f32_16x16x32_bf16 v[168:171], v[64:67], v[96:99], v[168:171]
  ds_read_b64_tr_b16 v[100:101], v15 offset:20480
  v_mfma_f32_16x16x32_bf16 v[172:175], v[68:71], v[96:99], v[172:175]
  v_mfma_f32_16x16x32_bf16 v[172:175], v[28:31], v[56:59], v[172:175]
  ds_read_b64_tr_b16 v[102:103], v15 offset:20992
  v_mfma_f32_16x16x32_bf16 v[156:159], v[52:55], v[28:31], v[156:159]
  ds_read_b64_tr_b16 v[80:81], v14 offset:4096
  s_bitcmp1_b32 128, s37
  s_cbranch_scc1 g1_us7
g1_ub7:
  v_mfma_f32_16x16x32_bf16 v[156:159], v[92:95], v[68:71], v[156:159]
  v_mfma_f32_16x16x32_bf16 v[140:143], v[88:91], v[68:71], v[140:143]
  ds_read_b64_tr_b16 v[82:83], v14 offset:4608
  v_mfma_f32_16x16x32_bf16 v[140:143], v[48:51], v[28:31], v[140:143]
  ds_read_b64_tr_b16 v[40:41], v14 offset:0
  s_waitcnt lgkmcnt(9)
  v_mfma_f32_16x16x32_bf16 v[144:147], v[48:51], v[32:35], v[144:147]
  ds_read_b64_tr_b16 v[42:43], v14 offset:512
  v_mfma_f32_16x16x32_bf16 v[144:147], v[88:91], v[72:75], v[144:147]
  v_mfma_f32_16x16x32_bf16 v[160:163], v[92:95], v[72:75], v[160:163]
  ds_read_b64_tr_b16 v[44:45], v15 offset:0
  v_mfma_f32_16x16x32_bf16 v[160:163], v[52:55], v[32:35], v[160:163]
  ds_read_b64_tr_b16 v[46:47], v15 offset:512
  v_mfma_f32_16x16x32_bf16 v[176:179], v[32:35], v[56:59], v[176:179]
  v_mfma_f32_16x16x32_bf16 v[176:179], v[72:75], v[96:99], v[176:179]
  ds_read_b64_tr_b16 v[84:85], v15 offset:4096
  s_waitcnt lgkmcnt(11)
  v_mfma_f32_16x16x32_bf16 v[180:183], v[76:79], v[96:99], v[180:183]
  ds_read_b64_tr_b16 v[86:87], v15 offset:4608
  v_mfma_f32_16x16x32_bf16 v[180:183], v[36:39], v[56:59], v[180:183]
  v_mfma_f32_16x16x32_bf16 v[164:167], v[52:55], v[36:39], v[164:167]
  v_mfma_f32_16x16x32_bf16 v[164:167], v[92:95], v[76:79], v[164:167]
  v_mfma_f32_16x16x32_bf16 v[148:151], v[88:91], v[76:79], v[148:151]
  v_mfma_f32_16x16x32_bf16 v[148:151], v[48:51], v[36:39], v[148:151]
  s_waitcnt lgkmcnt(0)
  v_mfma_f32_16x16x32_bf16 v[184:187], v[24:27], v[60:63], v[184:187]
  s_barrier
  ds_read_b64_tr_b16 v[48:49], v16 offset:8192
  v_mfma_f32_16x16x32_bf16 v[184:187], v[64:67], v[100:103], v[184:187]
  ds_read_b64_tr_b16 v[50:51], v16 offset:8704
  v_mfma_f32_16x16x32_bf16 v[104:107], v[80:83], v[64:67], v[104:107]
  ds_read_b64_tr_b16 v[88:89], v16 offset:12288
  v_mfma_f32_16x16x32_bf16 v[104:107], v[40:43], v[24:27], v[104:107]
  ds_read_b64_tr_b16 v[90:91], v16 offset:12800
  v_mfma_f32_16x16x32_bf16 v[120:123], v[44:47], v[24:27], v[120:123]
  ds_read_b64_tr_b16 v[92:93], v17 offset:12288
  v_mfma_f32_16x16x32_bf16 v[120:123], v[84:87], v[64:67], v[120:123]
  ds_read_b64_tr_b16 v[94:95], v17 offset:12800
  v_mfma_f32_16x16x32_bf16 v[124:127], v[84:87], v[68:71], v[124:127]
  ds_read_b128 v[24:27], v10 offset:0
  v_mfma_f32_16x16x32_bf16 v[124:127], v[44:47], v[28:31], v[124:127]
  ds_read_b128 v[64:67], v11 offset:0
  v_mfma_f32_16x16x32_bf16 v[108:111], v[40:43], v[28:31], v[108:111]
  ds_read_b64_tr_b16 v[52:53], v17 offset:8192
  s_bitcmp1_b32 16, s37
  s_cbranch_scc1 g1_us8
g1_ub8:
  v_mfma_f32_16x16x32_bf16 v[108:111], v[80:83], v[68:71], v[108:111]
  ds_read_b64_tr_b16 v[54:55], v17 offset:8704
  v_mfma_f32_16x16x32_bf16 v[188:191], v[68:71], v[100:103], v[188:191]
  ds_read_b64_tr_b16 v[56:57], v16 offset:16384
  v_mfma_f32_16x16x32_bf16 v[188:191], v[28:31], v[60:63], v[188:191]
  ds_read_b64_tr_b16 v[58:59], v16 offset:16896
  v_mfma_f32_16x16x32_bf16 v[192:195], v[32:35], v[60:63], v[192:195]
  ds_read_b128 v[28:31], v10 offset:1024
  v_mfma_f32_16x16x32_bf16 v[192:195], v[72:75], v[100:103], v[192:195]
  ds_read_b128 v[68:71], v11 offset:1024
  s_waitcnt lgkmcnt(10)
  v_mfma_f32_16x16x32_bf16 v[112:115], v[80:83], v[72:75], v[112:115]
  ds_read_b64_tr_b16 v[96:97], v16 offset:20480
  v_mfma_f32_16x16x32_bf16 v[112:115], v[40:43], v[32:35], v[112:115]
  ds_read_b64_tr_b16 v[98:99], v16 offset:20992
  v_mfma_f32_16x16x32_bf16 v[128:131], v[44:47], v[32:35], v[128:131]
  v_mfma_f32_16x16x32_bf16 v[128:131], v[84:87], v[72:75], v[128:131]
  v_mfma_f32_16x16x32_bf16 v[132:135], v[84:87], v[76:79], v[132:135]
  ds_read_b128 v[32:35], v10 offset:4096
  v_mfma_f32_16x16x32_bf16 v[132:135], v[44:47], v[36:39], v[132:135]
  ds_read_b128 v[72:75], v11 offset:4096
  v_mfma_f32_16x16x32_bf16 v[116:119], v[40:43], v[36:39], v[116:119]
  v_mfma_f32_16x16x32_bf16 v[116:119], v[80:83], v[76:79], v[116:119]
  v_mfma_f32_16x16x32_bf16 v[196:199], v[76:79], v[100:103], v[196:199]
  v_mfma_f32_16x16x32_bf16 v[196:199], v[36:39], v[60:63], v[196:199]
  s_waitcnt lgkmcnt(10)
  v_mfma_f32_16x16x32_bf16 v[136:139], v[48:51], v[24:27], v[136:139]
  ds_read_b128 v[36:39], v10 offset:5120
  v_mfma_f32_16x16x32_bf16 v[136:139], v[88:91], v[64:67], v[136:139]
  ds_read_b128 v[76:79], v11 offset:5120
  s_waitcnt lgkmcnt(10)
  v_mfma_f32_16x16x32_bf16 v[152:155], v[92:95], v[64:67], v[152:155]
  ds_read_b64_tr_b16 v[60:61], v17 offset:16384
  v_mfma_f32_16x16x32_bf16 v[152:155], v[52:55], v[24:27], v[152:155]
  s_waitcnt lgkmcnt(5)
  v_mfma_f32_16x16x32_bf16 v[168:171], v[24:27], v[56:59], v[168:171]
  ds_read_b64_tr_b16 v[62:63], v17 offset:16896
  v_mfma_f32_16x16x32_bf16 v[168:171], v[64:67], v[96:99], v[168:171]
  ds_read_b64_tr_b16 v[100:101], v17 offset:20480
  v_mfma_f32_16x16x32_bf16 v[172:175], v[68:71], v[96:99], v[172:175]
  v_mfma_f32_16x16x32_bf16 v[172:175], v[28:31], v[56:59], v[172:175]
  ds_read_b64_tr_b16 v[102:103], v17 offset:20992
  v_mfma_f32_16x16x32_bf16 v[156:159], v[52:55], v[28:31], v[156:159]
  ds_read_b64_tr_b16 v[80:81], v16 offset:4096
  s_bitcmp1_b32 32, s37
  s_cbranch_scc1 g1_us9
g1_ub9:
  v_mfma_f32_16x16x32_bf16 v[156:159], v[92:95], v[68:71], v[156:159]
  v_mfma_f32_16x16x32_bf16 v[140:143], v[88:91], v[68:71], v[140:143]
  ds_read_b64_tr_b16 v[82:83], v16 offset:4608
  v_mfma_f32_16x16x32_bf16 v[140:143], v[48:51], v[28:31], v[140:143]
  ds_read_b64_tr_b16 v[40:41], v16 offset:0
  s_waitcnt lgkmcnt(9)
  v_mfma_f32_16x16x32_bf16 v[144:147], v[48:51], v[32:35], v[144:147]
  ds_read_b64_tr_b16 v[42:43], v16 offset:512
  v_mfma_f32_16x16x32_bf16 v[144:147], v[88:91], v[72:75], v[144:147]
  v_mfma_f32_16x16x32_bf16 v[160:163], v[92:95], v[72:75], v[160:163]
  ds_read_b64_tr_b16 v[44:45], v17 offset:0
  v_mfma_f32_16x16x32_bf16 v[160:163], v[52:55], v[32:35], v[160:163]
  ds_read_b64_tr_b16 v[46:47], v17 offset:512
  v_mfma_f32_16x16x32_bf16 v[176:179], v[32:35], v[56:59], v[176:179]
  v_mfma_f32_16x16x32_bf16 v[176:179], v[72:75], v[96:99], v[176:179]
  ds_read_b64_tr_b16 v[84:85], v17 offset:4096
  s_waitcnt lgkmcnt(11)
  v_mfma_f32_16x16x32_bf16 v[180:183], v[76:79], v[96:99], v[180:183]
  ds_read_b64_tr_b16 v[86:87], v17 offset:4608
  v_mfma_f32_16x16x32_bf16 v[180:183], v[36:39], v[56:59], v[180:183]
  v_mfma_f32_16x16x32_bf16 v[164:167], v[52:55], v[36:39], v[164:167]
  v_mfma_f32_16x16x32_bf16 v[164:167], v[92:95], v[76:79], v[164:167]
  v_mfma_f32_16x16x32_bf16 v[148:151], v[88:91], v[76:79], v[148:151]
  v_mfma_f32_16x16x32_bf16 v[148:151], v[48:51], v[36:39], v[148:151]
  s_waitcnt lgkmcnt(0)
  v_mfma_f32_16x16x32_bf16 v[184:187], v[24:27], v[60:63], v[184:187]
  s_barrier
  ds_read_b64_tr_b16 v[48:49], v18 offset:8192
  v_mfma_f32_16x16x32_bf16 v[184:187], v[64:67], v[100:103], v[184:187]
  ds_read_b64_tr_b16 v[50:51], v18 offset:8704
  v_mfma_f32_16x16x32_bf16 v[104:107], v[80:83], v[64:67], v[104:107]
  ds_read_b64_tr_b16 v[88:89], v18 offset:12288
  v_mfma_f32_16x16x32_bf16 v[104:107], v[40:43], v[24:27], v[104:107]
  ds_read_b64_tr_b16 v[90:91], v18 offset:12800
  v_mfma_f32_16x16x32_bf16 v[120:123], v[44:47], v[24:27], v[120:123]
  ds_read_b64_tr_b16 v[92:93], v19 offset:12288
  v_mfma_f32_16x16x32_bf16 v[120:123], v[84:87], v[64:67], v[120:123]
  ds_read_b64_tr_b16 v[94:95], v19 offset:12800
  v_mfma_f32_16x16x32_bf16 v[124:127], v[84:87], v[68:71], v[124:127]
  ds_read_b128 v[24:27], v12 offset:0
  v_mfma_f32_16x16x32_bf16 v[124:127], v[44:47], v[28:31], v[124:127]
  ds_read_b128 v[64:67], v13 offset:0
  v_mfma_f32_16x16x32_bf16 v[108:111], v[40:43], v[28:31], v[108:111]
  ds_read_b64_tr_b16 v[52:53], v19 offset:8192
  s_bitcmp1_b32 64, s37
  s_cbranch_scc1 g1_us10
g1_ub10:
  v_mfma_f32_16x16x32_bf16 v[108:111], v[80:83], v[68:71], v[108:111]
  ds_read_b64_tr_b16 v[54:55], v19 offset:8704
  v_mfma_f32_16x16x32_bf16 v[188:191], v[68:71], v[100:103], v[188:191]
  ds_read_b64_tr_b16 v[56:57], v18 offset:16384
  v_mfma_f32_16x16x32_bf16 v[188:191], v[28:31], v[60:63], v[188:191]
  ds_read_b64_tr_b16 v[58:59], v18 offset:16896
  v_mfma_f32_16x16x32_bf16 v[192:195], v[32:35], v[60:63], v[192:195]
  ds_read_b128 v[28:31], v12 offset:1024
  v_mfma_f32_16x16x32_bf16 v[192:195], v[72:75], v[100:103], v[192:195]
  ds_read_b128 v[68:71], v13 offset:1024
  s_waitcnt lgkmcnt(10)
  v_mfma_f32_16x16x32_bf16 v[112:115], v[80:83], v[72:75], v[112:115]
  ds_read_b64_tr_b16 v[96:97], v18 offset:20480
  v_mfma_f32_16x16x32_bf16 v[112:115], v[40:43], v[32:35], v[112:115]
  ds_read_b64_tr_b16 v[98:99], v18 offset:20992
  v_mfma_f32_16x16x32_bf16 v[128:131], v[44:47], v[32:35], v[128:131]
  v_mfma_f32_16x16x32_bf16 v[128:131], v[84:87], v[72:75], v[128:131]
  v_mfma_f32_16x16x32_bf16 v[132:135], v[84:87], v[76:79], v[132:135]
  ds_read_b128 v[32:35], v12 offset:4096
  v_mfma_f32_16x16x32_bf16 v[132:135], v[44:47], v[36:39], v[132:135]
  ds_read_b128 v[72:75], v13 offset:4096
  v_mfma_f32_16x16x32_bf16 v[116:119], v[40:43], v[36:39], v[116:119]
  v_mfma_f32_16x16x32_bf16 v[116:119], v[80:83], v[76:79], v[116:119]
  v_mfma_f32_16x16x32_bf16 v[196:199], v[76:79], v[100:103], v[196:199]
  v_mfma_f32_16x16x32_bf16 v[196:199], v[36:39], v[60:63], v[196:199]
  s_waitcnt lgkmcnt(10)
  v_mfma_f32_16x16x32_bf16 v[136:139], v[48:51], v[24:27], v[136:139]
  ds_read_b128 v[36:39], v12 offset:5120
  v_mfma_f32_16x16x32_bf16 v[136:139], v[88:91], v[64:67], v[136:139]
  ds_read_b128 v[76:79], v13 offset:5120
  s_waitcnt lgkmcnt(10)
  v_mfma_f32_16x16x32_bf16 v[152:155], v[92:95], v[64:67], v[152:155]
  ds_read_b64_tr_b16 v[60:61], v19 offset:16384
  v_mfma_f32_16x16x32_bf16 v[152:155], v[52:55], v[24:27], v[152:155]
  s_waitcnt lgkmcnt(5)
  v_mfma_f32_16x16x32_bf16 v[168:171], v[24:27], v[56:59], v[168:171]
  ds_read_b64_tr_b16 v[62:63], v19 offset:16896
  v_mfma_f32_16x16x32_bf16 v[168:171], v[64:67], v[96:99], v[168:171]
  ds_read_b64_tr_b16 v[100:101], v19 offset:20480
  v_mfma_f32_16x16x32_bf16 v[172:175], v[68:71], v[96:99], v[172:175]
  v_mfma_f32_16x16x32_bf16 v[172:175], v[28:31], v[56:59], v[172:175]
  ds_read_b64_tr_b16 v[102:103], v19 offset:20992
  v_mfma_f32_16x16x32_bf16 v[156:159], v[52:55], v[28:31], v[156:159]
  ds_read_b64_tr_b16 v[80:81], v18 offset:4096
  v_mfma_f32_16x16x32_bf16 v[156:159], v[92:95], v[68:71], v[156:159]
  v_mfma_f32_16x16x32_bf16 v[140:143], v[88:91], v[68:71], v[140:143]
  ds_read_b64_tr_b16 v[82:83], v18 offset:4608
  v_mfma_f32_16x16x32_bf16 v[140:143], v[48:51], v[28:31], v[140:143]
  ds_read_b64_tr_b16 v[40:41], v18 offset:0
  s_waitcnt lgkmcnt(9)
  v_mfma_f32_16x16x32_bf16 v[144:147], v[48:51], v[32:35], v[144:147]
  ds_read_b64_tr_b16 v[42:43], v18 offset:512
  v_mfma_f32_16x16x32_bf16 v[144:147], v[88:91], v[72:75], v[144:147]
  v_mfma_f32_16x16x32_bf16 v[160:163], v[92:95], v[72:75], v[160:163]
  ds_read_b64_tr_b16 v[44:45], v19 offset:0
  v_mfma_f32_16x16x32_bf16 v[160:163], v[52:55], v[32:35], v[160:163]
  ds_read_b64_tr_b16 v[46:47], v19 offset:512
  v_mfma_f32_16x16x32_bf16 v[176:179], v[32:35], v[56:59], v[176:179]
  v_mfma_f32_16x16x32_bf16 v[176:179], v[72:75], v[96:99], v[176:179]
  ds_read_b64_tr_b16 v[84:85], v19 offset:4096
  s_waitcnt lgkmcnt(11)
  v_mfma_f32_16x16x32_bf16 v[180:183], v[76:79], v[96:99], v[180:183]
  ds_read_b64_tr_b16 v[86:87], v19 offset:4608
  v_mfma_f32_16x16x32_bf16 v[180:183], v[36:39], v[56:59], v[180:183]
  v_mfma_f32_16x16x32_bf16 v[164:167], v[52:55], v[36:39], v[164:167]
  v_mfma_f32_16x16x32_bf16 v[164:167], v[92:95], v[76:79], v[164:167]
  v_mfma_f32_16x16x32_bf16 v[148:151], v[88:91], v[76:79], v[148:151]
  v_mfma_f32_16x16x32_bf16 v[148:151], v[48:51], v[36:39], v[148:151]
  s_waitcnt lgkmcnt(0)
  v_mfma_f32_16x16x32_bf16 v[184:187], v[24:27], v[60:63], v[184:187]
  s_waitcnt vmcnt(0)
  s_barrier
  ds_read_b64_tr_b16 v[48:49], v14 offset:8192
  v_mfma_f32_16x16x32_bf16 v[184:187], v[64:67], v[100:103], v[184:187]
  ds_read_b64_tr_b16 v[50:51], v14 offset:8704
  v_mfma_f32_16x16x32_bf16 v[104:107], v[80:83], v[64:67], v[104:107]
  ds_read_b64_tr_b16 v[88:89], v14 offset:12288
  v_mfma_f32_16x16x32_bf16 v[104:107], v[40:43], v[24:27], v[104:107]
  ds_read_b64_tr_b16 v[90:91], v14 offset:12800
  v_mfma_f32_16x16x32_bf16 v[120:123], v[44:47], v[24:27], v[120:123]
  ds_read_b64_tr_b16 v[92:93], v15 offset:12288
  v_mfma_f32_16x16x32_bf16 v[120:123], v[84:87], v[64:67], v[120:123]
  ds_read_b64_tr_b16 v[94:95], v15 offset:12800
  v_mfma_f32_16x16x32_bf16 v[124:127], v[84:87], v[68:71], v[124:127]
  ds_read_b128 v[24:27], v8 offset:0
  v_mfma_f32_16x16x32_bf16 v[124:127], v[44:47], v[28:31], v[124:127]
  ds_read_b128 v[64:67], v9 offset:0
  v_mfma_f32_16x16x32_bf16 v[108:111], v[40:43], v[28:31], v[108:111]
  ds_read_b64_tr_b16 v[52:53], v15 offset:8192
  v_mfma_f32_16x16x32_bf16 v[108:111], v[80:83], v[68:71], v[108:111]
  ds_read_b64_tr_b16 v[54:55], v15 offset:8704
  v_mfma_f32_16x16x32_bf16 v[188:191], v[68:71], v[100:103], v[188:191]
  ds_read_b64_tr_b16 v[56:57], v14 offset:16384
  v_mfma_f32_16x16x32_bf16 v[188:191], v[28:31], v[60:63], v[188:191]
  ds_read_b64_tr_b16 v[58:59], v14 offset:16896
  v_mfma_f32_16x16x32_bf16 v[192:195], v[32:35], v[60:63], v[192:195]
  ds_read_b128 v[28:31], v8 offset:1024
  v_mfma_f32_16x16x32_bf16 v[192:195], v[72:75], v[100:103], v[192:195]
  ds_read_b128 v[68:71], v9 offset:1024
  s_waitcnt lgkmcnt(10)
  v_mfma_f32_16x16x32_bf16 v[112:115], v[80:83], v[72:75], v[112:115]
  ds_read_b64_tr_b16 v[96:97], v14 offset:20480
  v_mfma_f32_16x16x32_bf16 v[112:115], v[40:43], v[32:35], v[112:115]
  ds_read_b64_tr_b16 v[98:99], v14 offset:20992
  v_mfma_f32_16x16x32_bf16 v[128:131], v[44:47], v[32:35], v[128:131]
  v_mfma_f32_16x16x32_bf16 v[128:131], v[84:87], v[72:75], v[128:131]
  v_mfma_f32_16x16x32_bf16 v[132:135], v[84:87], v[76:79], v[132:135]
  ds_read_b128 v[32:35], v8 offset:4096
  v_mfma_f32_16x16x32_bf16 v[132:135], v[44:47], v[36:39], v[132:135]
  ds_read_b128 v[72:75], v9 offset:4096
  v_mfma_f32_16x16x32_bf16 v[116:119], v[40:43], v[36:39], v[116:119]
  v_mfma_f32_16x16x32_bf16 v[116:119], v[80:83], v[76:79], v[116:119]
  v_mfma_f32_16x16x32_bf16 v[196:199], v[76:79], v[100:103], v[196:199]
  v_mfma_f32_16x16x32_bf16 v[196:199], v[36:39], v[60:63], v[196:199]
  s_cmp_eq_u32 s48, 5
  s_cbranch_scc1 g1_hook
g1_hb5:
  s_mov_b32 s29, 3
g1_cloop:
  s_waitcnt lgkmcnt(10)
  v_mfma_f32_16x16x32_bf16 v[136:139], v[48:51], v[24:27], v[136:139]
  ds_read_b128 v[36:39], v8 offset:5120
  v_mfma_f32_16x16x32_bf16 v[136:139], v[88:91], v[64:67], v[136:139]
  ds_read_b128 v[76:79], v9 offset:5120
  s_waitcnt lgkmcnt(10)
  v_mfma_f32_16x16x32_bf16 v[152:155], v[92:95], v[64:67], v[152:155]
  ds_read_b64_tr_b16 v[60:61], v15 offset:16384
  v_mfma_f32_16x16x32_bf16 v[152:155], v[52:55], v[24:27], v[152:155]
  s_waitcnt lgkmcnt(5)
  v_mfma_f32_16x16x32_bf16 v[168:171], v[24:27], v[56:59], v[168:171]
  ds_read_b64_tr_b16 v[62:63], v15 offset:16896
  v_mfma_f32_16x16x32_bf16 v[168:171], v[64:67], v[96:99], v[168:171]
  ds_read_b64_tr_b16 v[100:101], v15 offset:20480
  v_mfma_f32_16x16x32_bf16 v[172:175], v[68:71], v[96:99], v[172:175]
  v_mfma_f32_16x16x32_bf16 v[172:175], v[28:31], v[56:59], v[172:175]
  ds_read_b64_tr_b16 v[102:103], v15 offset:20992
  v_mfma_f32_16x16x32_bf16 v[156:159], v[52:55], v[28:31], v[156:159]
  ds_read_b64_tr_b16 v[80:81], v14 offset:4096
  v_mfma_f32_16x16x32_bf16 v[156:159], v[92:95], v[68:71], v[156:159]
  v_mfma_f32_16x16x32_bf16 v[140:143], v[88:91], v[68:71], v[140:143]
  ds_read_b64_tr_b16 v[82:83], v14 offset:4608
  v_mfma_f32_16x16x32_bf16 v[140:143], v[48:51], v[28:31], v[140:143]
  ds_read_b64_tr_b16 v[40:41], v14 offset:0
  s_waitcnt lgkmcnt(9)
  v_mfma_f32_16x16x32_bf16 v[144:147], v[48:51], v[32:35], v[144:147]
  ds_read_b64_tr_b16 v[42:43], v14 offset:512
  v_mfma_f32_16x16x32_bf16 v[144:147], v[88:91], v[72:75], v[144:147]
  v_mfma_f32_16x16x32_bf16 v[160:163], v[92:95], v[72:75], v[160:163]
  ds_read_b64_tr_b16 v[44:45], v15 offset:0
  v_mfma_f32_16x16x32_bf16 v[160:163], v[52:55], v[32:35], v[160:163]
  ds_read_b64_tr_b16 v[46:47], v15 offset:512
  v_mfma_f32_16x16x32_bf16 v[176:179], v[32:35], v[56:59], v[176:179]
  v_mfma_f32_16x16x32_bf16 v[176:179], v[72:75], v[96:99], v[176:179]
  ds_read_b64_tr_b16 v[84:85], v15 offset:4096
  s_waitcnt lgkmcnt(11)
  v_mfma_f32_16x16x32_bf16 v[180:183], v[76:79], v[96:99], v[180:183]
  ds_read_b64_tr_b16 v[86:87], v15 offset:4608
  v_mfma_f32_16x16x32_bf16 v[180:183], v[36:39], v[56:59], v[180:183]
  v_mfma_f32_16x16x32_bf16 v[164:167], v[52:55], v[36:39], v[164:167]
  v_mfma_f32_16x16x32_bf16 v[164:167], v[92:95], v[76:79], v[164:167]
  v_mfma_f32_16x16x32_bf16 v[148:151], v[88:91], v[76:79], v[148:151]
  v_mfma_f32_16x16x32_bf16 v[148:151], v[48:51], v[36:39], v[148:151]
  s_waitcnt lgkmcnt(0)
  v_mfma_f32_16x16x32_bf16 v[184:187], v[24:27], v[60:63], v[184:187]
  s_barrier
  ds_read_b64_tr_b16 v[48:49], v16 offset:8192
  v_mfma_f32_16x16x32_bf16 v[184:187], v[64:67], v[100:103], v[184:187]
  ds_read_b64_tr_b16 v[50:51], v16 offset:8704
  v_mfma_f32_16x16x32_bf16 v[104:107], v[80:83], v[64:67], v[104:107]
  ds_read_b64_tr_b16 v[88:89], v16 offset:12288
  v_mfma_f32_16x16x32_bf16 v[104:107], v[40:43], v[24:27], v[104:107]
  ds_read_b64_tr_b16 v[90:91], v16 offset:12800
  v_mfma_f32_16x16x32_bf16 v[120:123], v[44:47], v[24:27], v[120:123]
  ds_read_b64_tr_b16 v[92:93], v17 offset:12288
  s_cmp_eq_u32 s29, s48
  s_cbranch_scc1 g1_hook
g1_hb3:
  v_mfma_f32_16x16x32_bf16 v[120:123], v[84:87], v[64:67], v[120:123]
  ds_read_b64_tr_b16 v[94:95], v17 offset:12800
  v_mfma_f32_16x16x32_bf16 v[124:127], v[84:87], v[68:71], v[124:127]
  ds_read_b128 v[24:27], v10 offset:0
  v_mfma_f32_16x16x32_bf16 v[124:127], v[44:47], v[28:31], v[124:127]
  ds_read_b128 v[64:67], v11 offset:0
  v_mfma_f32_16x16x32_bf16 v[108:111], v[40:43], v[28:31], v[108:111]
  ds_read_b64_tr_b16 v[52:53], v17 offset:8192
  v_mfma_f32_16x16x32_bf16 v[108:111], v[80:83], v[68:71], v[108:111]
  ds_read_b64_tr_b16 v[54:55], v17 offset:8704
  v_mfma_f32_16x16x32_bf16 v[188:191], v[68:71], v[100:103], v[188:191]
  ds_read_b64_tr_b16 v[56:57], v16 offset:16384
  v_mfma_f32_16x16x32_bf16 v[188:191], v[28:31], v[60:63], v[188:191]
  ds_read_b64_tr_b16 v[58:59], v16 offset:16896
  v_mfma_f32_16x16x32_bf16 v[192:195], v[32:35], v[60:63], v[192:195]
  ds_read_b128 v[28:31], v10 offset:1024
  v_mfma_f32_16x16x32_bf16 v[192:195], v[72:75], v[100:103], v[192:195]
  ds_read_b128 v[68:71], v11 offset:1024
  s_waitcnt lgkmcnt(10)
  v_mfma_f32_16x16x32_bf16 v[112:115], v[80:83], v[72:75], v[112:115]
  ds_read_b64_tr_b16 v[96:97], v16 offset:20480
  v_mfma_f32_16x16x32_bf16 v[112:115], v[40:43], v[32:35], v[112:115]
  ds_read_b64_tr_b16 v[98:99], v16 offset:20992
  v_mfma_f32_16x16x32_bf16 v[128:131], v[44:47], v[32:35], v[128:131]
  v_mfma_f32_16x16x32_bf16 v[128:131], v[84:87], v[72:75], v[128:131]
  v_mfma_f32_16x16x32_bf16 v[132:135], v[84:87], v[76:79], v[132:135]
  ds_read_b128 v[32:35], v10 offset:4096
  v_mfma_f32_16x16x32_bf16 v[132:135], v[44:47], v[36:39], v[132:135]
  ds_read_b128 v[72:75], v11 offset:4096
  v_mfma_f32_16x16x32_bf16 v[116:119], v[40:43], v[36:39], v[116:119]
  v_mfma_f32_16x16x32_bf16 v[116:119], v[80:83], v[76:79], v[116:119]
  v_mfma_f32_16x16x32_bf16 v[196:199], v[76:79], v[100:103], v[196:199]
  v_mfma_f32_16x16x32_bf16 v[196:199], v[36:39], v[60:63], v[196:199]
  s_waitcnt lgkmcnt(10)
  v_mfma_f32_16x16x32_bf16 v[136:139], v[48:51], v[24:27], v[136:139]
  ds_read_b128 v[36:39], v10 offset:5120
  v_mfma_f32_16x16x32_bf16 v[136:139], v[88:91], v[64:67], v[136:139]
  ds_read_b128 v[76:79], v11 offset:5120
  s_waitcnt lgkmcnt(10)
  v_mfma_f32_16x16x32_bf16 v[152:155], v[92:95], v[64:67], v[152:155]
  ds_read_b64_tr_b16 v[60:61], v17 offset:16384
  v_mfma_f32_16x16x32_bf16 v[152:155], v[52:55], v[24:27], v[152:155]
  s_waitcnt lgkmcnt(5)
  v_mfma_f32_16x16x32_bf16 v[168:171], v[24:27], v[56:59], v[168:171]
  ds_read_b64_tr_b16 v[62:63], v17 offset:16896
  v_mfma_f32_16x16x32_bf16 v[168:171], v[64:67], v[96:99], v[168:171]
  ds_read_b64_tr_b16 v[100:101], v17 offset:20480
  v_mfma_f32_16x16x32_bf16 v[172:175], v[68:71], v[96:99], v[172:175]
  v_mfma_f32_16x16x32_bf16 v[172:175], v[28:31], v[56:59], v[172:175]
  ds_read_b64_tr_b16 v[102:103], v17 offset:20992
  v_mfma_f32_16x16x32_bf16 v[156:159], v[52:55], v[28:31], v[156:159]
  ds_read_b64_tr_b16 v[80:81], v16 offset:4096
  v_mfma_f32_16x16x32_bf16 v[156:159], v[92:95], v[68:71], v[156:159]
  v_mfma_f32_16x16x32_bf16 v[140:143], v[88:91], v[68:71], v[140:143]
  ds_read_b64_tr_b16 v[82:83], v16 offset:4608
  v_mfma_f32_16x16x32_bf16 v[140:143], v[48:51], v[28:31], v[140:143]
  ds_read_b64_tr_b16 v[40:41], v16 offset:0
  s_waitcnt lgkmcnt(9)
  v_mfma_f32_16x16x32_bf16 v[144:147], v[48:51], v[32:35], v[144:147]
  ds_read_b64_tr_b16 v[42:43], v16 offset:512
  v_mfma_f32_16x16x32_bf16 v[144:147], v[88:91], v[72:75], v[144:147]
  v_mfma_f32_16x16x32_bf16 v[160:163], v[92:95], v[72:75], v[160:163]
  ds_read_b64_tr_b16 v[44:45], v17 offset:0
  v_mfma_f32_16x16x32_bf16 v[160:163], v[52:55], v[32:35], v[160:163]
  ds_read_b64_tr_b16 v[46:47], v17 offset:512
  v_mfma_f32_16x16x32_bf16 v[176:179], v[32:35], v[56:59], v[176:179]
  v_mfma_f32_16x16x32_bf16 v[176:179], v[72:75], v[96:99], v[176:179]
  ds_read_b64_tr_b16 v[84:85], v17 offset:4096
  s_waitcnt lgkmcnt(11)
  v_mfma_f32_16x16x32_bf16 v[180:183], v[76:79], v[96:99], v[180:183]
  ds_read_b64_tr_b16 v[86:87], v17 offset:4608
  v_mfma_f32_16x16x32_bf16 v[180:183], v[36:39], v[56:59], v[180:183]
  v_mfma_f32_16x16x32_bf16 v[164:167], v[52:55], v[36:39], v[164:167]
  v_mfma_f32_16x16x32_bf16 v[164:167], v[92:95], v[76:79], v[164:167]
  v_mfma_f32_16x16x32_bf16 v[148:151], v[88:91], v[76:79], v[148:151]
  v_mfma_f32_16x16x32_bf16 v[148:151], v[48:51], v[36:39], v[148:151]
  s_waitcnt lgkmcnt(0)
  v_mfma_f32_16x16x32_bf16 v[184:187], v[24:27], v[60:63], v[184:187]
  s_barrier
  ds_read_b64_tr_b16 v[48:49], v18 offset:8192
  v_mfma_f32_16x16x32_bf16 v[184:187], v[64:67], v[100:103], v[184:187]
  ds_read_b64_tr_b16 v[50:51], v18 offset:8704
  v_mfma_f32_16x16x32_bf16 v[104:107], v[80:83], v[64:67], v[104:107]
  ds_read_b64_tr_b16 v[88:89], v18 offset:12288
  v_mfma_f32_16x16x32_bf16 v[104:107], v[40:43], v[24:27], v[104:107]
  ds_read_b64_tr_b16 v[90:91], v18 offset:12800
  v_mfma_f32_16x16x32_bf16 v[120:123], v[44:47], v[24:27], v[120:123]
  ds_read_b64_tr_b16 v[92:93], v19 offset:12288
  v_mfma_f32_16x16x32_bf16 v[120:123], v[84:87], v[64:67], v[120:123]
  ds_read_b64_tr_b16 v[94:95], v19 offset:12800
  v_mfma_f32_16x16x32_bf16 v[124:127], v[84:87], v[68:71], v[124:127]
  ds_read_b128 v[24:27], v12 offset:0
  v_mfma_f32_16x16x32_bf16 v[124:127], v[44:47], v[28:31], v[124:127]
  ds_read_b128 v[64:67], v13 offset:0
  v_mfma_f32_16x16x32_bf16 v[108:111], v[40:43], v[28:31], v[108:111]
  ds_read_b64_tr_b16 v[52:53], v19 offset:8192
  v_mfma_f32_16x16x32_bf16 v[108:111], v[80:83], v[68:71], v[108:111]
  ds_read_b64_tr_b16 v[54:55], v19 offset:8704
  v_mfma_f32_16x16x32_bf16 v[188:191], v[68:71], v[100:103], v[188:191]
  ds_read_b64_tr_b16 v[56:57], v18 offset:16384
  v_mfma_f32_16x16x32_bf16 v[188:191], v[28:31], v[60:63], v[188:191]
  ds_read_b64_tr_b16 v[58:59], v18 offset:16896
  v_mfma_f32_16x16x32_bf16 v[192:195], v[32:35], v[60:63], v[192:195]
  ds_read_b128 v[28:31], v12 offset:1024
  v_mfma_f32_16x16x32_bf16 v[192:195], v[72:75], v[100:103], v[192:195]
  ds_read_b128 v[68:71], v13 offset:1024
  s_waitcnt lgkmcnt(10)
  v_mfma_f32_16x16x32_bf16 v[112:115], v[80:83], v[72:75], v[112:115]
  ds_read_b64_tr_b16 v[96:97], v18 offset:20480
  v_mfma_f32_16x16x32_bf16 v[112:115], v[40:43], v[32:35], v[112:115]
  ds_read_b64_tr_b16 v[98:99], v18 offset:20992
  v_mfma_f32_16x16x32_bf16 v[128:131], v[44:47], v[32:35], v[128:131]
  v_mfma_f32_16x16x32_bf16 v[128:131], v[84:87], v[72:75], v[128:131]
  v_mfma_f32_16x16x32_bf16 v[132:135], v[84:87], v[76:79], v[132:135]
  ds_read_b128 v[32:35], v12 offset:4096
  v_mfma_f32_16x16x32_bf16 v[132:135], v[44:47], v[36:39], v[132:135]
  ds_read_b128 v[72:75], v13 offset:4096
  v_mfma_f32_16x16x32_bf16 v[116:119], v[40:43], v[36:39], v[116:119]
  v_mfma_f32_16x16x32_bf16 v[116:119], v[80:83], v[76:79], v[116:119]
  v_mfma_f32_16x16x32_bf16 v[196:199], v[76:79], v[100:103], v[196:199]
  v_mfma_f32_16x16x32_bf16 v[196:199], v[36:39], v[60:63], v[196:199]
  s_waitcnt lgkmcnt(10)
  v_mfma_f32_16x16x32_bf16 v[136:139], v[48:51], v[24:27], v[136:139]
  ds_read_b128 v[36:39], v12 offset:5120
  v_mfma_f32_16x16x32_bf16 v[136:139], v[88:91], v[64:67], v[136:139]
  ds_read_b128 v[76:79], v13 offset:5120
  s_waitcnt lgkmcnt(10)
  v_mfma_f32_16x16x32_bf16 v[152:155], v[92:95], v[64:67], v[152:155]
  ds_read_b64_tr_b16 v[60:61], v19 offset:16384
  v_mfma_f32_16x16x32_bf16 v[152:155], v[52:55], v[24:27], v[152:155]
  s_waitcnt lgkmcnt(5)
  v_mfma_f32_16x16x32_bf16 v[168:171], v[24:27], v[56:59], v[168:171]
  ds_read_b64_tr_b16 v[62:63], v19 offset:16896
  v_mfma_f32_16x16x32_bf16 v[168:171], v[64:67], v[96:99], v[168:171]
  ds_read_b64_tr_b16 v[100:101], v19 offset:20480
  v_mfma_f32_16x16x32_bf16 v[172:175], v[68:71], v[96:99], v[172:175]
  v_mfma_f32_16x16x32_bf16 v[172:175], v[28:31], v[56:59], v[172:175]
  ds_read_b64_tr_b16 v[102:103], v19 offset:20992
  v_mfma_f32_16x16x32_bf16 v[156:159], v[52:55], v[28:31], v[156:159]
  ds_read_b64_tr_b16 v[80:81], v18 offset:4096
  v_mfma_f32_16x16x32_bf16 v[156:159], v[92:95], v[68:71], v[156:159]
  v_mfma_f32_16x16x32_bf16 v[140:143], v[88:91], v[68:71], v[140:143]
  ds_read_b64_tr_b16 v[82:83], v18 offset:4608
  v_mfma_f32_16x16x32_bf16 v[140:143], v[48:51], v[28:31], v[140:143]
  ds_read_b64_tr_b16 v[40:41], v18 offset:0
  s_waitcnt lgkmcnt(9)
  v_mfma_f32_16x16x32_bf16 v[144:147], v[48:51], v[32:35], v[144:147]
  ds_read_b64_tr_b16 v[42:43], v18 offset:512
  v_mfma_f32_16x16x32_bf16 v[144:147], v[88:91], v[72:75], v[144:147]
  v_mfma_f32_16x16x32_bf16 v[160:163], v[92:95], v[72:75], v[160:163]
  ds_read_b64_tr_b16 v[44:45], v19 offset:0
  v_mfma_f32_16x16x32_bf16 v[160:163], v[52:55], v[32:35], v[160:163]
  ds_read_b64_tr_b16 v[46:47], v19 offset:512
  v_mfma_f32_16x16x32_bf16 v[176:179], v[32:35], v[56:59], v[176:179]
  v_mfma_f32_16x16x32_bf16 v[176:179], v[72:75], v[96:99], v[176:179]
  ds_read_b64_tr_b16 v[84:85], v19 offset:4096
  s_waitcnt lgkmcnt(11)
  v_mfma_f32_16x16x32_bf16 v[180:183], v[76:79], v[96:99], v[180:183]
  ds_read_b64_tr_b16 v[86:87], v19 offset:4608
  v_mfma_f32_16x16x32_bf16 v[180:183], v[36:39], v[56:59], v[180:183]
  v_mfma_f32_16x16x32_bf16 v[164:167], v[52:55], v[36:39], v[164:167]
  v_mfma_f32_16x16x32_bf16 v[164:167], v[92:95], v[76:79], v[164:167]
  v_mfma_f32_16x16x32_bf16 v[148:151], v[88:91], v[76:79], v[148:151]
  v_mfma_f32_16x16x32_bf16 v[148:151], v[48:51], v[36:39], v[148:151]
  s_waitcnt lgkmcnt(0)
  v_mfma_f32_16x16x32_bf16 v[184:187], v[24:27], v[60:63], v[184:187]
  s_waitcnt vmcnt(0)
  s_barrier
  ds_read_b64_tr_b16 v[48:49], v14 offset:8192
  v_mfma_f32_16x16x32_bf16 v[184:187], v[64:67], v[100:103], v[184:187]
  ds_read_b64_tr_b16 v[50:51], v14 offset:8704
  v_mfma_f32_16x16x32_bf16 v[104:107], v[80:83], v[64:67], v[104:107]
  ds_read_b64_tr_b16 v[88:89], v14 offset:12288
  v_mfma_f32_16x16x32_bf16 v[104:107], v[40:43], v[24:27], v[104:107]
  ds_read_b64_tr_b16 v[90:91], v14 offset:12800
  v_mfma_f32_16x16x32_bf16 v[120:123], v[44:47], v[24:27], v[120:123]
  ds_read_b64_tr_b16 v[92:93], v15 offset:12288
  v_mfma_f32_16x16x32_bf16 v[120:123], v[84:87], v[64:67], v[120:123]
  ds_read_b64_tr_b16 v[94:95], v15 offset:12800
  v_mfma_f32_16x16x32_bf16 v[124:127], v[84:87], v[68:71], v[124:127]
  ds_read_b128 v[24:27], v8 offset:0
  v_mfma_f32_16x16x32_bf16 v[124:127], v[44:47], v[28:31], v[124:127]
  ds_read_b128 v[64:67], v9 offset:0
  v_mfma_f32_16x16x32_bf16 v[108:111], v[40:43], v[28:31], v[108:111]
  ds_read_b64_tr_b16 v[52:53], v15 offset:8192
  v_mfma_f32_16x16x32_bf16 v[108:111], v[80:83], v[68:71], v[108:111]
  ds_read_b64_tr_b16 v[54:55], v15 offset:8704
  v_mfma_f32_16x16x32_bf16 v[188:191], v[68:71], v[100:103], v[188:191]
  ds_read_b64_tr_b16 v[56:57], v14 offset:16384
  v_mfma_f32_16x16x32_bf16 v[188:191], v[28:31], v[60:63], v[188:191]
  ds_read_b64_tr_b16 v[58:59], v14 offset:16896
  v_mfma_f32_16x16x32_bf16 v[192:195], v[32:35], v[60:63], v[192:195]
  ds_read_b128 v[28:31], v8 offset:1024
  v_mfma_f32_16x16x32_bf16 v[192:195], v[72:75], v[100:103], v[192:195]
  ds_read_b128 v[68:71], v9 offset:1024
  s_waitcnt lgkmcnt(10)
  v_mfma_f32_16x16x32_bf16 v[112:115], v[80:83], v[72:75], v[112:115]
  ds_read_b64_tr_b16 v[96:97], v14 offset:20480
  v_mfma_f32_16x16x32_bf16 v[112:115], v[40:43], v[32:35], v[112:115]
  ds_read_b64_tr_b16 v[98:99], v14 offset:20992
  v_mfma_f32_16x16x32_bf16 v[128:131], v[44:47], v[32:35], v[128:131]
  v_mfma_f32_16x16x32_bf16 v[128:131], v[84:87], v[72:75], v[128:131]
  v_mfma_f32_16x16x32_bf16 v[132:135], v[84:87], v[76:79], v[132:135]
  ds_read_b128 v[32:35], v8 offset:4096
  v_mfma_f32_16x16x32_bf16 v[132:135], v[44:47], v[36:39], v[132:135]
  ds_read_b128 v[72:75], v9 offset:4096
  v_mfma_f32_16x16x32_bf16 v[116:119], v[40:43], v[36:39], v[116:119]
  v_mfma_f32_16x16x32_bf16 v[116:119], v[80:83], v[76:79], v[116:119]
  v_mfma_f32_16x16x32_bf16 v[196:199], v[76:79], v[100:103], v[196:199]
  v_mfma_f32_16x16x32_bf16 v[196:199], v[36:39], v[60:63], v[196:199]
  s_sub_u32 s29, s29, 1
  s_cmp_lg_u32 s29, 0
  s_cbranch_scc1 g1_cloop
  v_mov_b32 v5, 122880
  s_waitcnt lgkmcnt(10)
  v_mfma_f32_16x16x32_bf16 v[136:139], v[48:51], v[24:27], v[136:139]
  ds_read_b128 v[36:39], v8 offset:5120
  v_mfma_f32_16x16x32_bf16 v[136:139], v[88:91], v[64:67], v[136:139]
  ds_read_b128 v[76:79], v9 offset:5120
  s_waitcnt lgkmcnt(10)
  v_mfma_f32_16x16x32_bf16 v[152:155], v[92:95], v[64:67], v[152:155]
  ds_read_b64_tr_b16 v[60:61], v15 offset:16384
  v_mfma_f32_16x16x32_bf16 v[152:155], v[52:55], v[24:27], v[152:155]
  ds_read_b64_tr_b16 v[62:63], v15 offset:16896
  s_waitcnt lgkmcnt(6)
  v_mfma_f32_16x16x32_bf16 v[168:171], v[24:27], v[56:59], v[168:171]
  ds_read_b64_tr_b16 v[100:101], v15 offset:20480
  v_mfma_f32_16x16x32_bf16 v[168:171], v[64:67], v[96:99], v[168:171]
  ds_read_b64_tr_b16 v[102:103], v15 offset:20992
  v_mfma_f32_16x16x32_bf16 v[172:175], v[68:71], v[96:99], v[172:175]
  ds_read_b64_tr_b16 v[40:41], v14 offset:0
  v_mfma_f32_16x16x32_bf16 v[172:175], v[28:31], v[56:59], v[172:175]
  ds_read_b64_tr_b16 v[42:43], v14 offset:512
  v_mfma_f32_16x16x32_bf16 v[156:159], v[52:55], v[28:31], v[156:159]
  ds_read_b64_tr_b16 v[80:81], v14 offset:4096
  v_mfma_f32_16x16x32_bf16 v[156:159], v[92:95], v[68:71], v[156:159]
  ds_read_b64_tr_b16 v[82:83], v14 offset:4608
  v_mfma_f32_16x16x32_bf16 v[140:143], v[88:91], v[68:71], v[140:143]
  ds_read_b64_tr_b16 v[44:45], v15 offset:0
  v_mfma_f32_16x16x32_bf16 v[140:143], v[48:51], v[28:31], v[140:143]
  ds_read_b64_tr_b16 v[46:47], v15 offset:512
  s_waitcnt lgkmcnt(12)
  v_mfma_f32_16x16x32_bf16 v[144:147], v[48:51], v[32:35], v[144:147]
  ds_read_b64_tr_b16 v[84:85], v15 offset:4096
  v_mfma_f32_16x16x32_bf16 v[144:147], v[88:91], v[72:75], v[144:147]
  ds_read_b64_tr_b16 v[86:87], v15 offset:4608
  v_mfma_f32_16x16x32_bf16 v[160:163], v[92:95], v[72:75], v[160:163]
  ds_read_b32 v22, v5 offset:20
  v_mfma_f32_16x16x32_bf16 v[160:163], v[52:55], v[32:35], v[160:163]
  v_mfma_f32_16x16x32_bf16 v[176:179], v[32:35], v[56:59], v[176:179]
  v_mfma_f32_16x16x32_bf16 v[176:179], v[72:75], v[96:99], v[176:179]
  s_waitcnt lgkmcnt(13)
  v_mfma_f32_16x16x32_bf16 v[180:183], v[76:79], v[96:99], v[180:183]
  v_mfma_f32_16x16x32_bf16 v[180:183], v[36:39], v[56:59], v[180:183]
  v_mfma_f32_16x16x32_bf16 v[164:167], v[52:55], v[36:39], v[164:167]
  v_mfma_f32_16x16x32_bf16 v[164:167], v[92:95], v[76:79], v[164:167]
  v_mfma_f32_16x16x32_bf16 v[148:151], v[88:91], v[76:79], v[148:151]
  v_mfma_f32_16x16x32_bf16 v[148:151], v[48:51], v[36:39], v[148:151]
  s_waitcnt lgkmcnt(9)
  v_mfma_f32_16x16x32_bf16 v[184:187], v[24:27], v[60:63], v[184:187]
  v_mfma_f32_16x16x32_bf16 v[184:187], v[64:67], v[100:103], v[184:187]
  v_mfma_f32_16x16x32_bf16 v[188:191], v[68:71], v[100:103], v[188:191]
  v_mfma_f32_16x16x32_bf16 v[188:191], v[28:31], v[60:63], v[188:191]
  v_mfma_f32_16x16x32_bf16 v[192:195], v[32:35], v[60:63], v[192:195]
  ds_read_b32 v21, v5 offset:72
  v_mfma_f32_16x16x32_bf16 v[192:195], v[72:75], v[100:103], v[192:195]
  v_mfma_f32_16x16x32_bf16 v[196:199], v[76:79], v[100:103], v[196:199]
  v_mfma_f32_16x16x32_bf16 v[196:199], v[36:39], v[60:63], v[196:199]
  s_waitcnt lgkmcnt(0)
  v_readfirstlane_b32 s49, v22
  v_readfirstlane_b32 s7, v21
  s_nop 1
  s_cmp_ge_u32 s7, 4
  s_cbranch_scc0 g1_uw
g1_ub:
  v_lshrrev_b32 v9, 4, v0
  v_and_b32 v8, 15, v0
  v_lshlrev_b32 v8, 4, v8
  v_lshl_add_u32 v8, v9, 12, v8
  v_add_u32 v9, 15360, v8
  v_add_u32 v10, 30720, v8
  v_add_u32 v11, 46080, v8
  s_cmp_eq_u32 s49, 1
  s_cbranch_scc0 du1g
  v_mfma_f32_16x16x32_bf16 v[104:107], v[40:43], v[24:27], v[104:107]
  v_cvt_pk_bf16_f32 v200, v136, v137
  v_cvt_pk_bf16_f32 v201, v138, v139
  v_cvt_pk_bf16_f32 v202, v152, v153
  v_cvt_pk_bf16_f32 v203, v154, v155
  buffer_store_dwordx4 v[200:203], v8, s[20:23], s32 offen offset:0
  v_mfma_f32_16x16x32_bf16 v[104:107], v[80:83], v[64:67], v[104:107]
  v_cvt_pk_bf16_f32 v204, v140, v141
  v_cvt_pk_bf16_f32 v205, v142, v143
  v_cvt_pk_bf16_f32 v206, v156, v157
  v_cvt_pk_bf16_f32 v207, v158, v159
  buffer_store_dwordx4 v[204:207], v9, s[20:23], s32 offen offset:1024
  v_mfma_f32_16x16x32_bf16 v[120:123], v[84:87], v[64:67], v[120:123]
  v_cvt_pk_bf16_f32 v208, v144, v145
  v_cvt_pk_bf16_f32 v209, v146, v147
  v_cvt_pk_bf16_f32 v210, v160, v161
  v_cvt_pk_bf16_f32 v211, v162, v163
  buffer_store_dwordx4 v[208:211], v10, s[20:23], s32 offen offset:2048
  v_mfma_f32_16x16x32_bf16 v[120:123], v[44:47], v[24:27], v[120:123]
  v_cvt_pk_bf16_f32 v212, v148, v149
  v_cvt_pk_bf16_f32 v213, v150, v151
  v_cvt_pk_bf16_f32 v214, v164, v165
  v_cvt_pk_bf16_f32 v215, v166, v167
  buffer_store_dwordx4 v[212:215], v11, s[20:23], s32 offen offset:3072
  v_mfma_f32_16x16x32_bf16 v[124:127], v[44:47], v[28:31], v[124:127]
  v_cvt_pk_bf16_f32 v216, v168, v169
  v_cvt_pk_bf16_f32 v217, v170, v171
  v_cvt_pk_bf16_f32 v218, v172, v173
  v_cvt_pk_bf16_f32 v219, v174, v175
  buffer_store_dwordx4 v[216:219], v2, s[12:15], s34 offen offset:0 sc1
  v_mfma_f32_16x16x32_bf16 v[124:127], v[84:87], v[68:71], v[124:127]
  v_cvt_pk_bf16_f32 v220, v184, v185
  v_cvt_pk_bf16_f32 v221, v186, v187
  v_cvt_pk_bf16_f32 v222, v188, v189
  v_cvt_pk_bf16_f32 v223, v190, v191
  buffer_store_dwordx4 v[220:223], v2, s[12:15], s34 offen offset:1024 sc1
  v_mfma_f32_16x16x32_bf16 v[108:111], v[80:83], v[68:71], v[108:111]
  v_cvt_pk_bf16_f32 v224, v176, v177
  v_cvt_pk_bf16_f32 v225, v178, v179
  v_cvt_pk_bf16_f32 v226, v180, v181
  v_cvt_pk_bf16_f32 v227, v182, v183
  buffer_store_dwordx4 v[224:227], v2, s[12:15], s34 offen offset:2048 sc1
  v_mfma_f32_16x16x32_bf16 v[108:111], v[40:43], v[28:31], v[108:111]
  v_cvt_pk_bf16_f32 v228, v192, v193
  v_cvt_pk_bf16_f32 v229, v194, v195
  v_cvt_pk_bf16_f32 v230, v196, v197
  v_cvt_pk_bf16_f32 v231, v198, v199
  buffer_store_dwordx4 v[228:231], v2, s[12:15], s34 offen offset:3072 sc1
  v_mfma_f32_16x16x32_bf16 v[112:115], v[40:43], v[32:35], v[112:115]
  v_mfma_f32_16x16x32_bf16 v[112:115], v[80:83], v[72:75], v[112:115]
  v_mfma_f32_16x16x32_bf16 v[128:131], v[84:87], v[72:75], v[128:131]
  v_mfma_f32_16x16x32_bf16 v[128:131], v[44:47], v[32:35], v[128:131]
  v_mfma_f32_16x16x32_bf16 v[132:135], v[44:47], v[36:39], v[132:135]
  v_mfma_f32_16x16x32_bf16 v[132:135], v[84:87], v[76:79], v[132:135]
  v_mfma_f32_16x16x32_bf16 v[116:119], v[80:83], v[76:79], v[116:119]
  v_mfma_f32_16x16x32_bf16 v[116:119], v[40:43], v[36:39], v[116:119]
  s_branch du1d
du1g:
  v_mfma_f32_16x16x32_bf16 v[104:107], v[40:43], v[24:27], v[104:107]
  v_cvt_pk_bf16_f32 v200, v136, v137
  v_cvt_pk_bf16_f32 v201, v138, v139
  v_cvt_pk_bf16_f32 v202, v152, v153
  v_cvt_pk_bf16_f32 v203, v154, v155
  buffer_store_dwordx4 v[200:203], v8, s[20:23], s32 offen offset:0 sc1
  v_mfma_f32_16x16x32_bf16 v[104:107], v[80:83], v[64:67], v[104:107]
  v_cvt_pk_bf16_f32 v204, v140, v141
  v_cvt_pk_bf16_f32 v205, v142, v143
  v_cvt_pk_bf16_f32 v206, v156, v157
  v_cvt_pk_bf16_f32 v207, v158, v159
  buffer_store_dwordx4 v[204:207], v9, s[20:23], s32 offen offset:1024 sc1
  v_mfma_f32_16x16x32_bf16 v[120:123], v[84:87], v[64:67], v[120:123]
  v_cvt_pk_bf16_f32 v208, v144, v145
  v_cvt_pk_bf16_f32 v209, v146, v147
  v_cvt_pk_bf16_f32 v210, v160, v161
  v_cvt_pk_bf16_f32 v211, v162, v163
  buffer_store_dwordx4 v[208:211], v10, s[20:23], s32 offen offset:2048 sc1
  v_mfma_f32_16x16x32_bf16 v[120:123], v[44:47], v[24:27], v[120:123]
  v_cvt_pk_bf16_f32 v212, v148, v149
  v_cvt_pk_bf16_f32 v213, v150, v151
  v_cvt_pk_bf16_f32 v214, v164, v165
  v_cvt_pk_bf16_f32 v215, v166, v167
  buffer_store_dwordx4 v[212:215], v11, s[20:23], s32 offen offset:3072 sc1
  v_mfma_f32_16x16x32_bf16 v[124:127], v[44:47], v[28:31], v[124:127]
  v_cvt_pk_bf16_f32 v216, v168, v169
  v_cvt_pk_bf16_f32 v217, v170, v171
  v_cvt_pk_bf16_f32 v218, v172, v173
  v_cvt_pk_bf16_f32 v219, v174, v175
  buffer_store_dwordx4 v[216:219], v2, s[12:15], s34 offen offset:0 sc1
  v_mfma_f32_16x16x32_bf16 v[124:127], v[84:87], v[68:71], v[124:127]
  v_cvt_pk_bf16_f32 v220, v184, v185
  v_cvt_pk_bf16_f32 v221, v186, v187
  v_cvt_pk_bf16_f32 v222, v188, v189
  v_cvt_pk_bf16_f32 v223, v190, v191
  buffer_store_dwordx4 v[220:223], v2, s[12:15], s34 offen offset:1024 sc1
  v_mfma_f32_16x16x32_bf16 v[108:111], v[80:83], v[68:71], v[108:111]
  v_cvt_pk_bf16_f32 v224, v176, v177
  v_cvt_pk_bf16_f32 v225, v178, v179
  v_cvt_pk_bf16_f32 v226, v180, v181
  v_cvt_pk_bf16_f32 v227, v182, v183
  buffer_store_dwordx4 v[224:227], v2, s[12:15], s34 offen offset:2048 sc1
  v_mfma_f32_16x16x32_bf16 v[108:111], v[40:43], v[28:31], v[108:111]
  v_cvt_pk_bf16_f32 v228, v192, v193
  v_cvt_pk_bf16_f32 v229, v194, v195
  v_cvt_pk_bf16_f32 v230, v196, v197
  v_cvt_pk_bf16_f32 v231, v198, v199
  buffer_store_dwordx4 v[228:231], v2, s[12:15], s34 offen offset:3072 sc1
  v_mfma_f32_16x16x32_bf16 v[112:115], v[40:43], v[32:35], v[112:115]
  v_mfma_f32_16x16x32_bf16 v[112:115], v[80:83], v[72:75], v[112:115]
  v_mfma_f32_16x16x32_bf16 v[128:131], v[84:87], v[72:75], v[128:131]
  v_mfma_f32_16x16x32_bf16 v[128:131], v[44:47], v[32:35], v[128:131]
  v_mfma_f32_16x16x32_bf16 v[132:135], v[44:47], v[36:39], v[132:135]
  v_mfma_f32_16x16x32_bf16 v[132:135], v[84:87], v[76:79], v[132:135]
  v_mfma_f32_16x16x32_bf16 v[116:119], v[80:83], v[76:79], v[116:119]
  v_mfma_f32_16x16x32_bf16 v[116:119], v[40:43], v[36:39], v[116:119]
du1d:
  s_cmp_eq_u32 s44, 0
  s_cbranch_scc1 g1_nocopy
  buffer_store_dwordx4 v[200:203], v2, s[12:15], s44 offen offset:0 sc1
  buffer_store_dwordx4 v[204:207], v2, s[12:15], s44 offen offset:1024 sc1
  buffer_store_dwordx4 v[208:211], v2, s[12:15], s44 offen offset:2048 sc1
  buffer_store_dwordx4 v[212:215], v2, s[12:15], s44 offen offset:3072 sc1
  s_mov_b32 s49, 2
g1_nocopy:
  s_lshl_b32 s31, s50, 3
  s_add_u32 s31, s31, s3
  s_and_b32 s31, s31, 127
  s_lshl_b32 s31, s31, 4
  s_lshr_b32 s36, s50, 4
  s_mov_b32 s64, s76
  s_mov_b32 s65, s77
  s_mov_b32 s66, 0x400000
  s_mov_b32 s67, 0x00020000
  s_lshl_b32 s31, s31, 11
  s_lshl_b32 s36, s36, 7
  s_add_u32 s31, s31, s36
  v_lshrrev_b32 v5, 4, v0
  v_lshlrev_b32 v5, 13, v5
  v_and_b32 v6, 15, v0
  v_lshl_add_u32 v5, v6, 3, v5
  s_add_u32 s36, s31, 0
  buffer_load_dwordx2 v[244:245], v5, s[64:67], s36 offen offset:0 nt
  buffer_load_dwordx2 v[246:247], v5, s[64:67], s36 offen offset:2048 nt
  s_add_u32 s36, s31, 4096
  buffer_load_dwordx2 v[248:249], v5, s[64:67], s36 offen offset:0 nt
  buffer_load_dwordx2 v[250:251], v5, s[64:67], s36 offen offset:2048 nt
  s_add_u32 s36, s31, 131072
  buffer_load_dwordx2 v[184:185], v5, s[64:67], s36 offen offset:0 nt
  buffer_load_dwordx2 v[186:187], v5, s[64:67], s36 offen offset:2048 nt
  s_add_u32 s36, s31, 135168
  buffer_load_dwordx2 v[188:189], v5, s[64:67], s36 offen offset:0 nt
  buffer_load_dwordx2 v[190:191], v5, s[64:67], s36 offen offset:2048 nt
  s_mov_b32 s36, 0x3e8293ee
  v_add_u32 v6, s43, v2
  ds_write_b128 v6, v[216:219] offset:24576
  ds_write_b128 v6, v[220:223] offset:25600
  ds_write_b128 v6, v[224:227] offset:26624
  ds_write_b128 v6, v[228:231] offset:27648
  v_add_u32 v6, s46, v2
  s_nop 7
  v_mul_f32 v104, s36, v104
  v_mul_f32 v105, s36, v105
  v_mul_f32 v106, s36, v106
  v_mul_f32 v107, s36, v107
  v_mul_f32 v108, s36, v108
  v_mul_f32 v109, s36, v109
  v_mul_f32 v110, s36, v110
  v_mul_f32 v111, s36, v111
  v_mul_f32 v112, s36, v112
  v_mul_f32 v113, s36, v113
  v_mul_f32 v114, s36, v114
  v_mul_f32 v115, s36, v115
  v_mul_f32 v116, s36, v116
  v_mul_f32 v117, s36, v117
  v_mul_f32 v118, s36, v118
  v_mul_f32 v119, s36, v119
  v_mul_f32 v120, s36, v120
  v_mul_f32 v121, s36, v121
  v_mul_f32 v122, s36, v122
  v_mul_f32 v123, s36, v123
  v_mul_f32 v124, s36, v124
  v_mul_f32 v125, s36, v125
  v_mul_f32 v126, s36, v126
  v_mul_f32 v127, s36, v127
  v_mul_f32 v128, s36, v128
  v_mul_f32 v129, s36, v129
  v_mul_f32 v130, s36, v130
  v_mul_f32 v131, s36, v131
  v_mul_f32 v132, s36, v132
  v_mul_f32 v133, s36, v133
  v_mul_f32 v134, s36, v134
  v_mul_f32 v135, s36, v135
  v_cvt_pk_bf16_f32 v24, v104, v105
  v_cvt_pk_bf16_f32 v25, v106, v107
  v_cvt_pk_bf16_f32 v26, v120, v121
  v_cvt_pk_bf16_f32 v27, v122, v123
  ds_write_b128 v6, v[24:27] offset:0
  v_cvt_pk_bf16_f32 v28, v108, v109
  v_cvt_pk_bf16_f32 v29, v110, v111
  v_cvt_pk_bf16_f32 v30, v124, v125
  v_cvt_pk_bf16_f32 v31, v126, v127
  ds_write_b128 v6, v[28:31] offset:1024
  v_cvt_pk_bf16_f32 v32, v112, v113
  v_cvt_pk_bf16_f32 v33, v114, v115
  v_cvt_pk_bf16_f32 v34, v128, v129
  v_cvt_pk_bf16_f32 v35, v130, v131
  ds_write_b128 v6, v[32:35] offset:2048
  v_cvt_pk_bf16_f32 v36, v116, v117
  v_cvt_pk_bf16_f32 v37, v118, v119
  v_cvt_pk_bf16_f32 v38, v132, v133
  v_cvt_pk_bf16_f32 v39, v134, v135
  ds_write_b128 v6, v[36:39] offset:3072
  s_waitcnt vmcnt(8)
  s_cmp_eq_u32 s49, 1
  s_cbranch_scc0 du2g
  v_mov_b32 v5, 122880
  v_mov_b32 v6, 1
  s_mov_b64 exec, 1
  ds_add_rtn_u32 v5, v5, v6 offset:0
  s_waitcnt lgkmcnt(0)
  v_readfirstlane_b32 s7, v5
  s_nop 1
  s_cmp_lg_u32 s7, 3
  s_cbranch_scc1 sig3
  v_mov_b32 v5, s45
  buffer_store_dword v6, v5, s[68:71], 0 offen
sig3:
  s_mov_b64 exec, -1
  s_branch du2d
du2g:
  v_mov_b32 v5, 122880
  v_mov_b32 v6, 1
  s_mov_b64 exec, 1
  ds_add_rtn_u32 v5, v5, v6 offset:0
  s_waitcnt lgkmcnt(0)
  v_readfirstlane_b32 s7, v5
  s_nop 1
  s_cmp_lg_u32 s7, 3
  s_cbranch_scc1 sig4
  v_mov_b32 v5, s45
  buffer_store_dword v6, v5, s[68:71], 0 offen sc1
sig4:
  s_mov_b64 exec, -1
du2d:
  buffer_load_dword v22, v20, s[68:71], 0 offen sc1
  v_mov_b32 v5, 122880
  s_mov_b32 s6, 1048576
lw5:
  ds_read_b32 v6, v5 offset:0
  s_waitcnt lgkmcnt(0)
  v_readfirstlane_b32 s7, v6
  s_nop 1
  s_cmp_ge_u32 s7, 4
  s_cbranch_scc1 lw5_ok
  s_sub_u32 s6, s6, 1
  s_cmp_eq_u32 s6, 0
  s_cbranch_scc1 lw5_ok
  s_sleep 1
  s_branch lw5
lw5_ok:
  s_waitcnt vmcnt(0)
  s_mov_b32 s6, 131072
  s_branch poll6_chk
poll6:
  buffer_load_dword v22, v20, s[68:71], 0 offen sc1
  s_waitcnt vmcnt(0)
poll6_chk:
  v_cmp_eq_u32 vcc, 0, v22
  s_nop 1
  s_cmp_eq_u64 vcc, 0
  s_cbranch_scc1 poll6_ok
  s_sub_u32 s6, s6, 1
  s_cmp_eq_u32 s6, 0
  s_cbranch_scc1 poll6_ok
  s_sleep 1
  s_branch poll6
poll6_ok:
  s_cmp_eq_u32 s47, 0
  s_cbranch_scc1 g1_kl
  s_add_u32 m0, s42, 0
  s_add_u32 s38, s40, 0
  buffer_load_dwordx4 v2, s[12:15], s38 offen offset:0 lds
  buffer_load_dwordx4 v2, s[12:15], s38 offen offset:1024 lds
  buffer_load_dwordx4 v2, s[12:15], s38 offen offset:2048 lds
  buffer_load_dwordx4 v2, s[12:15], s38 offen offset:3072 lds
  s_add_u32 m0, s42, 4096
  s_add_u32 s38, s40, 4096
  buffer_load_dwordx4 v2, s[12:15], s38 offen offset:0 lds
  buffer_load_dwordx4 v2, s[12:15], s38 offen offset:1024 lds
  buffer_load_dwordx4 v2, s[12:15], s38 offen offset:2048 lds
  buffer_load_dwordx4 v2, s[12:15], s38 offen offset:3072 lds
  s_branch g1_kd
g1_kl:
  s_add_u32 m0, s42, 0
  s_add_u32 s38, s40, 0
  buffer_load_dwordx4 v8, s[20:23], s38 offen offset:0 lds
  buffer_load_dwordx4 v9, s[20:23], s38 offen offset:1024 lds
  buffer_load_dwordx4 v10, s[20:23], s38 offen offset:2048 lds
  buffer_load_dwordx4 v11, s[20:23], s38 offen offset:3072 lds
  s_add_u32 m0, s42, 4096
  s_add_u32 s38, s40, 65536
  buffer_load_dwordx4 v8, s[20:23], s38 offen offset:0 lds
  buffer_load_dwordx4 v9, s[20:23], s38 offen offset:1024 lds
  buffer_load_dwordx4 v10, s[20:23], s38 offen offset:2048 lds
  buffer_load_dwordx4 v11, s[20:23], s38 offen offset:3072 lds
g1_kd:
  s_add_u32 m0, s43, 0
  s_add_u32 s38, s33, 0
  buffer_load_dwordx4 v8, s[20:23], s38 offen offset:0 lds
  buffer_load_dwordx4 v9, s[20:23], s38 offen offset:1024 lds
  buffer_load_dwordx4 v10, s[20:23], s38 offen offset:2048 lds
  buffer_load_dwordx4 v11, s[20:23], s38 offen offset:3072 lds
  s_waitcnt vmcnt(0)
  v_mov_b32 v5, 122880
  v_mov_b32 v6, 1
  s_mov_b64 exec, 1
  ds_add_u32 v5, v6 offset:24
  s_mov_b64 exec, -1
  s_add_u32 m0, s42, 24576
  s_add_u32 s38, s41, 0
  buffer_load_dwordx4 v2, s[12:15], s38 offen offset:0 lds
  buffer_load_dwordx4 v2, s[12:15], s38 offen offset:1024 lds
  buffer_load_dwordx4 v2, s[12:15], s38 offen offset:2048 lds
  buffer_load_dwordx4 v2, s[12:15], s38 offen offset:3072 lds
  s_add_u32 m0, s42, 28672
  s_add_u32 s38, s41, 4096
  buffer_load_dwordx4 v2, s[12:15], s38 offen offset:0 lds
  buffer_load_dwordx4 v2, s[12:15], s38 offen offset:1024 lds
  buffer_load_dwordx4 v2, s[12:15], s38 offen offset:2048 lds
  buffer_load_dwordx4 v2, s[12:15], s38 offen offset:3072 lds
  v_mov_b32 v5, 122880
  s_mov_b32 s6, 1048576
lw7:
  ds_read_b32 v6, v5 offset:24
  s_waitcnt lgkmcnt(0)
  v_readfirstlane_b32 s7, v6
  s_nop 1
  s_cmp_ge_u32 s7, 4
  s_cbranch_scc1 lw7_ok
  s_sub_u32 s6, s6, 1
  s_cmp_eq_u32 s6, 0
  s_cbranch_scc1 lw7_ok
  s_sleep 1
  s_branch lw7
lw7_ok:
  s_cmp_lg_u32 s3, 0
  s_cbranch_scc1 mk_nkd
  v_mov_b32 v5, s45
  v_mov_b32 v6, 2
  s_mov_b64 exec, 1
  s_cmp_eq_u32 s49, 1
  s_cbranch_scc0 du8g
  buffer_store_dword v6, v5, s[68:71], 0 offen
  s_branch du8d
du8g:
  buffer_store_dword v6, v5, s[68:71], 0 offen sc1
du8d:
  s_mov_b64 exec, -1
mk_nkd:
  s_setprio 3
  s_cmp_eq_u32 s54, 0
  s_cbranch_scc1 att_short0
  ds_read_b128 v[8:11], v1
  ds_read_b128 v[12:15], v1 offset:512
  ds_read_b128 v[24:27], v4 offset:14336
  ds_read_b128 v[28:31], v4 offset:14848
  ds_read_b128 v[16:19], v4 offset:16384
  ds_read_b128 v[20:23], v4 offset:16896
  ds_read_b128 v[32:35], v4 offset:12288
  ds_read_b128 v[36:39], v4 offset:12800
  s_waitcnt lgkmcnt(4)
  s_cmp_le_u32 s25, 0
  s_cbranch_scc1 af0_inv7
  v_mfma_f32_32x32x16_bf16 v[80:95], v[24:27], v[8:11], 0
af0_back7:
  v_mfma_f32_32x32x16_bf16 v[80:95], v[28:31], v[12:15], v[80:95]
  ds_read_b128 v[24:27], v4 offset:8192
  ds_read_b128 v[28:31], v4 offset:8704
  s_waitcnt lgkmcnt(4)
  v_mfma_f32_32x32x16_bf16 v[96:111], v[16:19], v[8:11], 0
  v_mfma_f32_32x32x16_bf16 v[96:111], v[20:23], v[12:15], v[96:111]
  ds_read_b128 v[16:19], v4 offset:10240
  ds_read_b128 v[20:23], v4 offset:10752
  s_waitcnt lgkmcnt(4)
  s_cmp_le_u32 s25, 1
  s_cbranch_scc1 af0_inv6
  v_mfma_f32_32x32x16_bf16 v[64:79], v[32:35], v[8:11], 0
af0_back6:
  s_nop 0
  v_exp_f32 v80, v80
  v_exp_f32 v81, v81
  v_exp_f32 v82, v82
  v_exp_f32 v83, v83
  v_exp_f32 v84, v84
  v_exp_f32 v85, v85
  v_exp_f32 v86, v86
  v_exp_f32 v87, v87
  v_exp_f32 v88, v88
  v_exp_f32 v89, v89
  v_mfma_f32_32x32x16_bf16 v[64:79], v[36:39], v[12:15], v[64:79]
  ds_read_b128 v[32:35], v4 offset:6144
  ds_read_b128 v[36:39], v4 offset:6656
  v_exp_f32 v90, v90
  v_exp_f32 v91, v91
  v_exp_f32 v92, v92
  v_exp_f32 v93, v93
  v_exp_f32 v94, v94
  v_exp_f32 v95, v95
  v_cvt_pk_bf16_f32 v112, v80, v81
  v_cvt_pk_bf16_f32 v113, v82, v83
  v_cvt_pk_bf16_f32 v114, v84, v85
  v_cvt_pk_bf16_f32 v115, v86, v87
  v_cvt_pk_bf16_f32 v116, v88, v89
  v_cvt_pk_bf16_f32 v117, v90, v91
  v_cvt_pk_bf16_f32 v118, v92, v93
  v_cvt_pk_bf16_f32 v119, v94, v95
  s_waitcnt lgkmcnt(2)
  s_cmp_le_u32 s25, 2
  s_cbranch_scc1 af0_inv5
  v_mfma_f32_32x32x16_bf16 v[80:95], v[16:19], v[8:11], 0
af0_back5:
  v_exp_f32 v64, v64
  v_exp_f32 v65, v65
  v_exp_f32 v66, v66
  v_exp_f32 v67, v67
  v_exp_f32 v68, v68
  v_exp_f32 v69, v69
  v_exp_f32 v70, v70
  v_mfma_f32_32x32x16_bf16 v[80:95], v[20:23], v[12:15], v[80:95]
  ds_read_b128 v[16:19], v4 offset:4096
  ds_read_b128 v[20:23], v4 offset:4608
  v_exp_f32 v71, v71
  v_exp_f32 v72, v72
  v_exp_f32 v73, v73
  v_exp_f32 v74, v74
  v_exp_f32 v75, v75
  v_exp_f32 v76, v76
  v_exp_f32 v77, v77
  v_mfma_f32_16x16x32_bf16 v[208:211], v[240:243], v[112:115], 0
  v_exp_f32 v78, v78
  v_exp_f32 v79, v79
  v_cvt_pk_bf16_f32 v120, v64, v65
  v_cvt_pk_bf16_f32 v121, v66, v67
  v_mfma_f32_16x16x32_bf16 v[208:211], v[240:243], v[116:119], v[208:211]
  v_cvt_pk_bf16_f32 v122, v68, v69
  v_cvt_pk_bf16_f32 v123, v70, v71
  v_cvt_pk_bf16_f32 v124, v72, v73
  v_cvt_pk_bf16_f32 v125, v74, v75
  v_cvt_pk_bf16_f32 v126, v76, v77
  v_cvt_pk_bf16_f32 v127, v78, v79
  s_cmp_le_u32 s25, 3
  s_cbranch_scc1 af0_inv4
  v_mfma_f32_32x32x16_bf16 v[64:79], v[24:27], v[8:11], 0
af0_back4:
  v_exp_f32 v80, v80
  v_exp_f32 v81, v81
  v_exp_f32 v82, v82
  v_exp_f32 v83, v83
  v_exp_f32 v84, v84
  v_exp_f32 v85, v85
  v_exp_f32 v86, v86
  v_mfma_f32_32x32x16_bf16 v[64:79], v[28:31], v[12:15], v[64:79]
  ds_read_b128 v[24:27], v4 offset:2048
  ds_read_b128 v[28:31], v4 offset:2560
  v_exp_f32 v87, v87
  v_exp_f32 v88, v88
  v_exp_f32 v89, v89
  v_exp_f32 v90, v90
  v_exp_f32 v91, v91
  v_exp_f32 v92, v92
  v_exp_f32 v93, v93
  v_mfma_f32_16x16x32_bf16 v[208:211], v[240:243], v[120:123], v[208:211]
  v_exp_f32 v94, v94
  v_exp_f32 v95, v95
  v_cvt_pk_bf16_f32 v128, v80, v81
  v_cvt_pk_bf16_f32 v129, v82, v83
  v_mfma_f32_16x16x32_bf16 v[208:211], v[240:243], v[124:127], v[208:211]
  v_cvt_pk_bf16_f32 v130, v84, v85
  v_cvt_pk_bf16_f32 v131, v86, v87
  v_cvt_pk_bf16_f32 v132, v88, v89
  v_cvt_pk_bf16_f32 v133, v90, v91
  v_cvt_pk_bf16_f32 v134, v92, v93
  v_cvt_pk_bf16_f32 v135, v94, v95
  s_waitcnt vmcnt(0)
  v_mov_b32 v5, 122880
  v_mov_b32 v6, 1
  s_mov_b64 exec, 1
  ds_add_u32 v5, v6 offset:16
  s_mov_b64 exec, -1
  s_waitcnt lgkmcnt(5)
  s_cmp_le_u32 s25, 4
  s_cbranch_scc1 af0_inv3
  v_mfma_f32_32x32x16_bf16 v[80:95], v[32:35], v[8:11], 0
af0_back3:
  v_exp_f32 v64, v64
  v_exp_f32 v65, v65
  v_exp_f32 v66, v66
  v_exp_f32 v67, v67
  v_exp_f32 v68, v68
  v_exp_f32 v69, v69
  v_exp_f32 v70, v70
  v_mfma_f32_32x32x16_bf16 v[80:95], v[36:39], v[12:15], v[80:95]
  ds_read_b128 v[32:35], v4 offset:0
  ds_read_b128 v[36:39], v4 offset:512
  v_exp_f32 v71, v71
  v_exp_f32 v72, v72
  v_exp_f32 v73, v73
  v_exp_f32 v74, v74
  v_exp_f32 v75, v75
  v_exp_f32 v76, v76
  v_exp_f32 v77, v77
  v_mfma_f32_16x16x32_bf16 v[208:211], v[240:243], v[128:131], v[208:211]
  v_exp_f32 v78, v78
  v_exp_f32 v79, v79
  v_cvt_pk_bf16_f32 v136, v64, v65
  v_cvt_pk_bf16_f32 v137, v66, v67
  v_mfma_f32_16x16x32_bf16 v[208:211], v[240:243], v[132:135], v[208:211]
  v_cvt_pk_bf16_f32 v138, v68, v69
  v_cvt_pk_bf16_f32 v139, v70, v71
  v_cvt_pk_bf16_f32 v140, v72, v73
  v_cvt_pk_bf16_f32 v141, v74, v75
  v_cvt_pk_bf16_f32 v142, v76, v77
  v_cvt_pk_bf16_f32 v143, v78, v79
  v_mov_b32 v5, 122880
  s_mov_b32 s6, 1048576
lw9:
  ds_read_b32 v6, v5 offset:16
  s_waitcnt lgkmcnt(0)
  v_readfirstlane_b32 s7, v6
  s_nop 1
  s_cmp_ge_u32 s7, 4
  s_cbranch_scc1 lw9_ok
  s_sub_u32 s6, s6, 1
  s_cmp_eq_u32 s6, 0
  s_cbranch_scc1 lw9_ok
  s_sleep 1
  s_branch lw9
lw9_ok:
  ds_read_b128 v[40:43], v3 offset:14336
  ds_read_b128 v[44:47], v3 offset:14848
  ds_read_b128 v[48:51], v3 offset:12288
  ds_read_b128 v[52:55], v3 offset:12800
  ds_read_b128 v[56:59], v3 offset:10240
  ds_read_b128 v[60:63], v3 offset:10752
  s_cmp_le_u32 s25, 5
  s_cbranch_scc1 af0_inv2
  v_mfma_f32_32x32x16_bf16 v[64:79], v[16:19], v[8:11], 0
af0_back2:
  v_exp_f32 v80, v80
  v_exp_f32 v81, v81
  v_exp_f32 v82, v82
  v_mfma_f32_32x32x16_bf16 v[64:79], v[20:23], v[12:15], v[64:79]
  v_exp_f32 v83, v83
  v_exp_f32 v84, v84
  v_exp_f32 v85, v85
  s_waitcnt lgkmcnt(4)
  v_mfma_f32_32x32x16_bf16 v[192:207], v[40:43], v[112:115], 0
  v_exp_f32 v86, v86
  v_exp_f32 v87, v87
  v_exp_f32 v88, v88
  v_mfma_f32_16x16x32_bf16 v[208:211], v[240:243], v[136:139], v[208:211]
  v_exp_f32 v89, v89
  v_mfma_f32_32x32x16_bf16 v[192:207], v[44:47], v[116:119], v[192:207]
  ds_read_b128 v[40:43], v3 offset:8192
  ds_read_b128 v[44:47], v3 offset:8704
  v_exp_f32 v90, v90
  v_exp_f32 v91, v91
  v_exp_f32 v92, v92
  v_mfma_f32_16x16x32_bf16 v[208:211], v[240:243], v[140:143], v[208:211]
  v_exp_f32 v93, v93
  v_exp_f32 v94, v94
  s_waitcnt lgkmcnt(4)
  v_mfma_f32_32x32x16_bf16 v[192:207], v[48:51], v[120:123], v[192:207]
  v_exp_f32 v95, v95
  v_cvt_pk_bf16_f32 v144, v80, v81
  v_cvt_pk_bf16_f32 v145, v82, v83
  v_cvt_pk_bf16_f32 v146, v84, v85
  v_mfma_f32_32x32x16_bf16 v[192:207], v[52:55], v[124:127], v[192:207]
  ds_read_b128 v[48:51], v3 offset:6144
  ds_read_b128 v[52:55], v3 offset:6656
  v_cvt_pk_bf16_f32 v147, v86, v87
  v_cvt_pk_bf16_f32 v148, v88, v89
  v_cvt_pk_bf16_f32 v149, v90, v91
  v_cvt_pk_bf16_f32 v150, v92, v93
  v_cvt_pk_bf16_f32 v151, v94, v95
  s_cmp_le_u32 s25, 6
  s_cbranch_scc1 af0_inv1
  v_mfma_f32_32x32x16_bf16 v[80:95], v[24:27], v[8:11], 0
af0_back1:
  v_exp_f32 v64, v64
  v_exp_f32 v65, v65
  v_exp_f32 v66, v66
  v_mfma_f32_32x32x16_bf16 v[80:95], v[28:31], v[12:15], v[80:95]
  v_exp_f32 v67, v67
  v_exp_f32 v68, v68
  v_exp_f32 v69, v69
  s_waitcnt lgkmcnt(4)
  v_mfma_f32_32x32x16_bf16 v[192:207], v[56:59], v[128:131], v[192:207]
  v_exp_f32 v70, v70
  v_exp_f32 v71, v71
  v_exp_f32 v72, v72
  v_mfma_f32_16x16x32_bf16 v[208:211], v[240:243], v[144:147], v[208:211]
  v_exp_f32 v73, v73
  v_mfma_f32_32x32x16_bf16 v[192:207], v[60:63], v[132:135], v[192:207]
  ds_read_b128 v[56:59], v3 offset:4096
  ds_read_b128 v[60:63], v3 offset:4608
  v_exp_f32 v74, v74
  v_exp_f32 v75, v75
  v_exp_f32 v76, v76
  v_mfma_f32_16x16x32_bf16 v[208:211], v[240:243], v[148:151], v[208:211]
  v_exp_f32 v77, v77
  v_exp_f32 v78, v78
  s_waitcnt lgkmcnt(4)
  v_mfma_f32_32x32x16_bf16 v[192:207], v[40:43], v[136:139], v[192:207]
  v_exp_f32 v79, v79
  v_cvt_pk_bf16_f32 v152, v64, v65
  v_cvt_pk_bf16_f32 v153, v66, v67
  v_cvt_pk_bf16_f32 v154, v68, v69
  v_mfma_f32_32x32x16_bf16 v[192:207], v[44:47], v[140:143], v[192:207]
  ds_read_b128 v[40:43], v3 offset:2048
  ds_read_b128 v[44:47], v3 offset:2560
  v_cvt_pk_bf16_f32 v155, v70, v71
  v_cvt_pk_bf16_f32 v156, v72, v73
  v_cvt_pk_bf16_f32 v157, v74, v75
  v_cvt_pk_bf16_f32 v158, v76, v77
  v_cvt_pk_bf16_f32 v159, v78, v79
  s_cmp_le_u32 s25, 7
  s_cbranch_scc1 af0_inv0
  v_mfma_f32_32x32x16_bf16 v[64:79], v[32:35], v[8:11], 0
af0_back0:
  v_exp_f32 v80, v80
  v_exp_f32 v81, v81
  v_exp_f32 v82, v82
  v_mfma_f32_32x32x16_bf16 v[64:79], v[36:39], v[12:15], v[64:79]
  v_exp_f32 v83, v83
  v_exp_f32 v84, v84
  v_exp_f32 v85, v85
  s_waitcnt lgkmcnt(4)
  v_mfma_f32_32x32x16_bf16 v[192:207], v[48:51], v[144:147], v[192:207]
  v_exp_f32 v86, v86
  v_exp_f32 v87, v87
  v_exp_f32 v88, v88
  v_mfma_f32_16x16x32_bf16 v[208:211], v[240:243], v[152:155], v[208:211]
  v_exp_f32 v89, v89
  v_mfma_f32_32x32x16_bf16 v[192:207], v[52:55], v[148:151], v[192:207]
  ds_read_b128 v[48:51], v3 offset:16384
  ds_read_b128 v[52:55], v3 offset:16896
  v_exp_f32 v90, v90
  v_exp_f32 v91, v91
  v_exp_f32 v92, v92
  v_mfma_f32_16x16x32_bf16 v[208:211], v[240:243], v[156:159], v[208:211]
  v_exp_f32 v93, v93
  v_exp_f32 v94, v94
  s_waitcnt lgkmcnt(4)
  v_mfma_f32_32x32x16_bf16 v[192:207], v[56:59], v[152:155], v[192:207]
  v_exp_f32 v95, v95
  v_cvt_pk_bf16_f32 v160, v80, v81
  v_cvt_pk_bf16_f32 v161, v82, v83
  v_cvt_pk_bf16_f32 v162, v84, v85
  v_mfma_f32_32x32x16_bf16 v[192:207], v[60:63], v[156:159], v[192:207]
  ds_read_b128 v[56:59], v3 offset:0
  ds_read_b128 v[60:63], v3 offset:512
  v_cvt_pk_bf16_f32 v163, v86, v87
  v_cvt_pk_bf16_f32 v164, v88, v89
  v_cvt_pk_bf16_f32 v165, v90, v91
  v_cvt_pk_bf16_f32 v166, v92, v93
  v_cvt_pk_bf16_f32 v167, v94, v95
  s_waitcnt lgkmcnt(4)
  v_mfma_f32_32x32x16_bf16 v[192:207], v[40:43], v[160:163], v[192:207]
  s_mov_b32 s28, 0xffffffff
  s_mov_b32 s29, 0xfffffff0
  v_cndmask_b32 v64, v64, v96, s[28:29]
  s_mov_b32 s30, 0xfffffffe
  s_mov_b32 s31, 0xffffffe0
  v_cndmask_b32 v65, v65, v97, s[30:31]
  s_mov_b32 s32, 0xfffffffc
  s_mov_b32 s33, 0xffffffc0
  v_cndmask_b32 v66, v66, v98, s[32:33]
  s_mov_b32 s34, 0xfffffff8
  s_mov_b32 s35, 0xffffff80
  v_cndmask_b32 v67, v67, v99, s[34:35]
  s_mov_b32 s28, 0xffffff00
  s_mov_b32 s29, 0xfffff000
  v_cndmask_b32 v68, v68, v100, s[28:29]
  s_mov_b32 s30, 0xfffffe00
  s_mov_b32 s31, 0xffffe000
  v_cndmask_b32 v69, v69, v101, s[30:31]
  s_mov_b32 s32, 0xfffffc00
  s_mov_b32 s33, 0xffffc000
  v_cndmask_b32 v70, v70, v102, s[32:33]
  s_mov_b32 s34, 0xfffff800
  s_mov_b32 s35, 0xffff8000
  v_cndmask_b32 v71, v71, v103, s[34:35]
  s_mov_b32 s28, 0xffff0000
  s_mov_b32 s29, 0xfff00000
  v_cndmask_b32 v72, v72, v104, s[28:29]
  s_mov_b32 s30, 0xfffe0000
  s_mov_b32 s31, 0xffe00000
  v_cndmask_b32 v73, v73, v105, s[30:31]
  s_mov_b32 s32, 0xfffc0000
  s_mov_b32 s33, 0xffc00000
  v_cndmask_b32 v74, v74, v106, s[32:33]
  s_mov_b32 s34, 0xfff80000
  s_mov_b32 s35, 0xff800000
  v_cndmask_b32 v75, v75, v107, s[34:35]
  s_mov_b32 s28, 0xff000000
  s_mov_b32 s29, 0xf0000000
  v_cndmask_b32 v76, v76, v108, s[28:29]
  s_mov_b32 s30, 0xfe000000
  s_mov_b32 s31, 0xe0000000
  v_cndmask_b32 v77, v77, v109, s[30:31]
  s_mov_b32 s32, 0xfc000000
  s_mov_b32 s33, 0xc0000000
  v_cndmask_b32 v78, v78, v110, s[32:33]
  s_mov_b32 s34, 0xf8000000
  s_mov_b32 s35, 0x80000000
  v_cndmask_b32 v79, v79, v111, s[34:35]
  v_exp_f32 v64, v64
  v_exp_f32 v65, v65
  v_mfma_f32_16x16x32_bf16 v[208:211], v[240:243], v[160:163], v[208:211]
  v_exp_f32 v66, v66
  v_exp_f32 v67, v67
  v_exp_f32 v68, v68
  v_exp_f32 v69, v69
  v_mfma_f32_32x32x16_bf16 v[192:207], v[44:47], v[164:167], v[192:207]
  v_exp_f32 v70, v70
  v_exp_f32 v71, v71
  v_exp_f32 v72, v72
  v_exp_f32 v73, v73
  v_exp_f32 v74, v74
  v_exp_f32 v75, v75
  v_exp_f32 v76, v76
  v_exp_f32 v77, v77
  v_exp_f32 v78, v78
  v_exp_f32 v79, v79
  v_mfma_f32_16x16x32_bf16 v[208:211], v[240:243], v[164:167], v[208:211]
  v_cvt_pk_bf16_f32 v168, v64, v65
  v_cvt_pk_bf16_f32 v169, v66, v67
  v_cvt_pk_bf16_f32 v170, v68, v69
  v_cvt_pk_bf16_f32 v171, v70, v71
  v_cvt_pk_bf16_f32 v172, v72, v73
  v_cvt_pk_bf16_f32 v173, v74, v75
  v_cvt_pk_bf16_f32 v174, v76, v77
  v_cvt_pk_bf16_f32 v175, v78, v79
  v_mfma_f32_16x16x32_bf16 v[208:211], v[240:243], v[168:171], v[208:211]
  v_and_b32 v176, v232, v168
  v_and_b32 v177, v233, v169
  v_and_b32 v178, v234, v170
  v_and_b32 v179, v235, v171
  v_and_b32 v180, v236, v172
  v_and_b32 v181, v237, v173
  v_and_b32 v182, v238, v174
  v_and_b32 v183, v239, v175
  v_mfma_f32_16x16x32_bf16 v[208:211], v[240:243], v[172:175], v[208:211]
  v_bfi_b32 v64, v232, 0, v168
  v_bfi_b32 v65, v233, 0, v169
  v_bfi_b32 v66, v234, 0, v170
  v_bfi_b32 v67, v235, 0, v171
  v_bfi_b32 v68, v236, 0, v172
  v_bfi_b32 v69, v237, 0, v173
  v_bfi_b32 v70, v238, 0, v174
  v_bfi_b32 v71, v239, 0, v175
  s_waitcnt lgkmcnt(2)
  v_mfma_f32_32x32x16_bf16 v[192:207], v[48:51], v[176:179], v[192:207]
  v_mfma_f32_32x32x16_bf16 v[192:207], v[52:55], v[180:183], v[192:207]
  s_waitcnt lgkmcnt(0)
  v_mfma_f32_32x32x16_bf16 v[192:207], v[56:59], v[64:67], v[192:207]
  v_mfma_f32_32x32x16_bf16 v[192:207], v[60:63], v[68:71], v[192:207]
att_chk0:
  v_cmp_lt_f32 vcc, 0x21800000, v208
  s_mov_b32 s30, 0x5d800000
  v_cmp_gt_f32 s[28:29], s30, v208
  s_add_u32 s16, s98, 0xc00000
  s_addc_u32 s17, s99, 0
  s_mov_b32 s18, 0x400000
  s_mov_b32 s19, 0x00020000
  s_lshl_b32 s27, s25, 5
  s_add_u32 s27, s27, s24
  s_lshl_b32 s27, s27, 11
  s_and_b64 vcc, vcc, s[28:29]
  s_cmp_eq_u64 vcc, exec
  s_cbranch_scc0 att_slow
  v_rcp_f32 v212, v208
att_fin0:
  s_nop 0
  v_pk_mul_f32 v[192:193], v[192:193], v[212:213] op_sel_hi:[1,0]
  v_pk_mul_f32 v[194:195], v[194:195], v[212:213] op_sel_hi:[1,0]
  v_pk_mul_f32 v[196:197], v[196:197], v[212:213] op_sel_hi:[1,0]
  v_pk_mul_f32 v[198:199], v[198:199], v[212:213] op_sel_hi:[1,0]
  v_cvt_pk_bf16_f32 v192, v192, v193
  v_cvt_pk_bf16_f32 v193, v194, v195
  v_cvt_pk_bf16_f32 v194, v196, v197
  v_cvt_pk_bf16_f32 v195, v198, v199
  buffer_store_dwordx4 v[192:195], v2, s[16:19], s27 offen offset:0 sc1
  v_pk_mul_f32 v[200:201], v[200:201], v[212:213] op_sel_hi:[1,0]
  v_pk_mul_f32 v[202:203], v[202:203], v[212:213] op_sel_hi:[1,0]
  v_pk_mul_f32 v[204:205], v[204:205], v[212:213] op_sel_hi:[1,0]
  v_pk_mul_f32 v[206:207], v[206:207], v[212:213] op_sel_hi:[1,0]
  v_cvt_pk_bf16_f32 v200, v200, v201
  v_cvt_pk_bf16_f32 v201, v202, v203
  v_cvt_pk_bf16_f32 v202, v204, v205
  v_cvt_pk_bf16_f32 v203, v206, v207
  buffer_store_dwordx4 v[200:203], v2, s[16:19], s27 offen offset:1024 sc1
  s_setprio 1
  v_mov_b32 v4, 122880
  v_mov_b32 v5, 1
  s_mov_b64 exec, 1
  ds_add_u32 v4, v5 offset:64
  s_mov_b64 exec, -1
  s_and_b32 s37, s3, 3
  s_lshl_b32 s33, s37, 10
  s_add_u32 s32, s37, 4
  s_lshl_b32 s35, s56, 2
  s_add_u32 s35, s35, s37
  s_lshl_b32 s35, s35, 16
  s_add_u32 s8, s98, 0xc00000
  s_addc_u32 s9, s99, 0
  s_mov_b32 s10, 0x400000
  s_mov_b32 s11, 0x00020000
  s_mov_b32 s20, s94
  s_mov_b32 s21, s95
  s_mov_b32 s22, 0x800000
  s_mov_b32 s23, 0x00020000
  s_add_u32 s12, s98, 0x1000000
  s_addc_u32 s13, s99, 0
  s_mov_b32 s14, 0x800000
  s_mov_b32 s15, 0x00020000
  v_mov_b32 v4, 122880
  s_mov_b32 s6, 1048576
lw10:
  ds_read_b32 v5, v4 offset:64
  s_waitcnt lgkmcnt(0)
  v_readfirstlane_b32 s7, v5
  s_nop 1
  s_cmp_ge_u32 s7, 4
  s_cbranch_scc1 lw10_ok
  s_sub_u32 s6, s6, 1
  s_cmp_eq_u32 s6, 0
  s_cbranch_scc1 lw10_ok
  s_sleep 1
  s_branch lw10
lw10_ok:
  s_add_u32 s58, s59, 0
  s_and_b32 s58, s58, 15
  s_lshl3_add_u32 s58, s58, s37
  s_add_u32 m0, s33, 49152
  s_lshl_b32 s58, s58, 14
  buffer_load_dwordx4 v252, s[60:63], s58 offen lds
  s_add_u32 s58, s59, 1
  s_and_b32 s58, s58, 15
  s_lshl3_add_u32 s58, s58, s37
  s_add_u32 m0, s33, 53248
  s_lshl_b32 s58, s58, 14
  buffer_load_dwordx4 v252, s[60:63], s58 offen lds
  s_add_u32 s58, s59, 2
  s_and_b32 s58, s58, 15
  s_lshl3_add_u32 s58, s58, s37
  s_add_u32 m0, s33, 57344
  s_lshl_b32 s58, s58, 14
  buffer_load_dwordx4 v252, s[60:63], s58 offen lds
  s_add_u32 s58, s59, 3
  s_and_b32 s58, s58, 15
  s_lshl3_add_u32 s58, s58, s37
  s_add_u32 m0, s33, 61440
  s_lshl_b32 s58, s58, 14
  buffer_load_dwordx4 v252, s[60:63], s58 offen lds
  s_lshl_b32 s38, s25, 4
  s_add_u32 s38, s38, s55
  s_lshl_b32 s38, s38, 2
  s_add_u32 s38, s38, 3072
  v_mov_b32 v4, s38
  v_mov_b32 v5, 1
  s_mov_b64 exec, 1
  s_waitcnt vmcnt(4)
  buffer_store_dword v5, v4, s[68:71], 0 offen sc1
  s_mov_b64 exec, -1
  s_add_u32 s58, s59, 4
  s_and_b32 s58, s58, 15
  s_lshl3_add_u32 s58, s58, s37
  s_add_u32 m0, s33, 65536
  s_lshl_b32 s58, s58, 14
  buffer_load_dwordx4 v252, s[60:63], s58 offen lds
  s_add_u32 s58, s59, 5
  s_and_b32 s58, s58, 15
  s_lshl3_add_u32 s58, s58, s37
  s_add_u32 m0, s33, 69632
  s_lshl_b32 s58, s58, 14
  buffer_load_dwordx4 v252, s[60:63], s58 offen lds
  s_add_u32 s58, s59, 6
  s_and_b32 s58, s58, 15
  s_lshl3_add_u32 s58, s58, s37
  s_add_u32 m0, s33, 73728
  s_lshl_b32 s58, s58, 14
  buffer_load_dwordx4 v252, s[60:63], s58 offen lds
  s_add_u32 s58, s59, 7
  s_and_b32 s58, s58, 15
  s_lshl3_add_u32 s58, s58, s37
  s_add_u32 m0, s33, 77824
  s_lshl_b32 s58, s58, 14
  buffer_load_dwordx4 v252, s[60:63], s58 offen lds
  s_add_u32 s58, s59, 8
  s_and_b32 s58, s58, 15
  s_lshl3_add_u32 s58, s58, s37
  s_add_u32 m0, s33, 81920
  s_lshl_b32 s58, s58, 14
  buffer_load_dwordx4 v252, s[60:63], s58 offen lds
  s_add_u32 s58, s59, 9
  s_and_b32 s58, s58, 15
  s_lshl3_add_u32 s58, s58, s37
  s_add_u32 m0, s33, 86016
  s_lshl_b32 s58, s58, 14
  buffer_load_dwordx4 v252, s[60:63], s58 offen lds
  s_add_u32 s58, s59, 10
  s_and_b32 s58, s58, 15
  s_lshl3_add_u32 s58, s58, s37
  s_add_u32 m0, s33, 90112
  s_lshl_b32 s58, s58, 14
  buffer_load_dwordx4 v252, s[60:63], s58 offen lds
  s_add_u32 s58, s59, 11
  s_and_b32 s58, s58, 15
  s_lshl3_add_u32 s58, s58, s37
  s_add_u32 m0, s33, 94208
  s_lshl_b32 s58, s58, 14
  buffer_load_dwordx4 v252, s[60:63], s58 offen lds
  s_add_u32 s58, s59, 12
  s_and_b32 s58, s58, 15
  s_lshl3_add_u32 s58, s58, s37
  s_add_u32 m0, s33, 98304
  s_lshl_b32 s58, s58, 14
  buffer_load_dwordx4 v252, s[60:63], s58 offen lds
  s_add_u32 s58, s59, 13
  s_and_b32 s58, s58, 15
  s_lshl3_add_u32 s58, s58, s37
  s_add_u32 m0, s33, 102400
  s_lshl_b32 s58, s58, 14
  buffer_load_dwordx4 v252, s[60:63], s58 offen lds
  v_mov_b32 v4, 122880
  s_mov_b32 s6, 1048576
lw11:
  ds_read_b32 v5, v4 offset:4
  s_waitcnt lgkmcnt(0)
  v_readfirstlane_b32 s7, v5
  s_nop 1
  s_cmp_ge_u32 s7, 4
  s_cbranch_scc1 lw11_ok
  s_sub_u32 s6, s6, 1
  s_cmp_eq_u32 s6, 0
  s_cbranch_scc1 lw11_ok
  s_sleep 1
  s_branch lw11
lw11_ok:
  s_add_u32 s58, s59, 14
  s_and_b32 s58, s58, 15
  s_lshl3_add_u32 s58, s58, s37
  s_add_u32 m0, s33, 106496
  s_lshl_b32 s58, s58, 14
  buffer_load_dwordx4 v252, s[60:63], s58 offen lds
  s_add_u32 s58, s59, 15
  s_and_b32 s58, s58, 15
  s_lshl3_add_u32 s58, s58, s37
  s_add_u32 m0, s33, 110592
  s_lshl_b32 s58, s58, 14
  buffer_load_dwordx4 v252, s[60:63], s58 offen lds
  s_add_u32 s58, s59, 0
  s_and_b32 s58, s58, 15
  s_lshl3_add_u32 s58, s58, s32
  s_add_u32 m0, s33, 114688
  s_lshl_b32 s58, s58, 14
  buffer_load_dwordx4 v252, s[60:63], s58 offen lds
  s_add_u32 s58, s59, 1
  s_and_b32 s58, s58, 15
  s_lshl3_add_u32 s58, s58, s32
  s_add_u32 m0, s33, 118784
  s_lshl_b32 s58, s58, 14
  buffer_load_dwordx4 v252, s[60:63], s58 offen lds
  v_and_b32 v17, 15, v0
  v_lshrrev_b32 v12, 4, v0
  s_lshl_b32 s38, s50, 3
  s_add_u32 s38, s38, s3
  s_and_b32 s38, s38, 127
  s_lshl_b32 s38, s38, 4
  s_lshr_b32 s39, s50, 4
  s_lshl_b32 s30, s39, 6
  s_add_u32 s31, s30, 0
  v_lshl_add_u32 v225, v17, 2, s31
  s_lshl_b32 s31, s38, 3
  s_add_u32 s31, s31, 4194304
  s_lshr_b32 s28, s38, 5
  s_lshl_b32 s28, s28, 12
  s_and_b32 s29, s38, 16
  s_lshl3_add_u32 s28, s29, s28
  s_cmp_lt_u32 s38, 1024
  s_cselect_b32 s31, s28, s31
  s_cselect_b32 s34, 13, 9
  s_cselect_b32 s28, 8, 14
  s_lshl_b32 s34, 1, s34
  s_lshl_b32 s29, s39, 18
  s_add_u32 s31, s31, s29
  v_lshlrev_b32 v16, s28, v17
  v_lshl_add_u32 v16, v12, 5, v16
  v_add_u32 v226, s31, v16
  s_lshl_b32 s31, s38, 12
  s_lshl1_add_u32 s31, s30, s31
  v_lshlrev_b32 v16, 14, v12
  v_lshl_add_u32 v16, v17, 3, v16
  v_add_u32 v227, s31, v16
  s_and_b32 s28, s3, 3
  v_lshlrev_b32 v16, 9, v12
  v_lshl_add_u32 v216, v17, 4, v16
  v_lshrrev_b32 v13, 1, v12
  v_and_b32 v12, 1, v12
  v_bfe_u32 v14, v0, 2, 2
  v_lshlrev_b32 v15, 4, v13
  v_lshl_add_u32 v15, v12, 2, v15
  v_add_u32 v15, v15, v14
  v_lshlrev_b32 v15, 7, v15
  v_bfe_u32 v16, v0, 1, 1
  v_lshrrev_b32 v14, 1, v14
  v_lshl_add_u32 v16, v14, 2, v16
  v_lshl_add_u32 v16, v12, 1, v16
  v_lshl_add_u32 v15, v16, 4, v15
  v_and_b32 v16, 1, v0
  v_lshl_add_u32 v15, v16, 3, v15
  v_add_u32 v218, 49152, v15
  v_xor_b32 v219, 32, v218
  v_xor_b32 v220, 64, v218
  v_xor_b32 v221, 96, v218
  s_lshl_b32 s31, s28, 13
  s_add_u32 s31, s31, 49152
  v_lshl_add_u32 v222, v0, 4, s31
  v_mov_b32 v4, 122880
  s_mov_b32 s6, 1048576
lw12:
  ds_read_b32 v5, v4 offset:40
  s_waitcnt lgkmcnt(0)
  v_readfirstlane_b32 s7, v5
  s_nop 1
  s_cmp_ge_u32 s7, 4
  s_cbranch_scc1 lw12_ok
  s_sub_u32 s6, s6, 1
  s_cmp_eq_u32 s6, 0
  s_cbranch_scc1 lw12_ok
  s_sleep 1
  s_branch lw12
lw12_ok:
  s_add_u32 s58, s59, 11
  s_and_b32 s58, s58, 15
  s_lshl3_add_u32 s58, s58, s32
  s_add_u32 m0, s33, 28672
  s_lshl_b32 s58, s58, 14
  buffer_load_dwordx4 v252, s[60:63], s58 offen lds
  s_add_u32 s58, s59, 12
  s_and_b32 s58, s58, 15
  s_lshl3_add_u32 s58, s58, s32
  s_add_u32 m0, s33, 32768
  s_lshl_b32 s58, s58, 14
  buffer_load_dwordx4 v252, s[60:63], s58 offen lds
  s_add_u32 s58, s59, 13
  s_and_b32 s58, s58, 15
  s_lshl3_add_u32 s58, s58, s32
  s_add_u32 m0, s33, 36864
  s_lshl_b32 s58, s58, 14
  buffer_load_dwordx4 v252, s[60:63], s58 offen lds
  s_add_u32 s58, s59, 14
  s_and_b32 s58, s58, 15
  s_lshl3_add_u32 s58, s58, s32
  s_add_u32 m0, s33, 40960
  s_lshl_b32 s58, s58, 14
  buffer_load_dwordx4 v252, s[60:63], s58 offen lds
  s_add_u32 s58, s59, 15
  s_and_b32 s58, s58, 15
  s_lshl3_add_u32 s58, s58, s32
  s_add_u32 m0, s33, 45056
  s_lshl_b32 s58, s58, 14
  buffer_load_dwordx4 v252, s[60:63], s58 offen lds
  s_add_u32 s58, s59, 2
  s_and_b32 s58, s58, 15
  s_lshl3_add_u32 s58, s58, s32
  s_add_u32 m0, s33, 126976
  s_lshl_b32 s58, s58, 14
  buffer_load_dwordx4 v252, s[60:63], s58 offen lds
  s_lshl2_add_u32 s39, s56, s3
  s_lshl_b32 s39, s39, 6
  s_add_u32 s39, s39, 3072
  s_load_dwordx16 s[76:91], s[68:69], s39 glc
  s_add_u32 s58, s59, 3
  s_and_b32 s58, s58, 15
  s_lshl3_add_u32 s58, s58, s32
  s_add_u32 m0, s33, 131072
  s_lshl_b32 s58, s58, 14
  buffer_load_dwordx4 v252, s[60:63], s58 offen lds
  s_add_u32 s58, s59, 4
  s_and_b32 s58, s58, 15
  s_lshl3_add_u32 s58, s58, s32
  s_add_u32 m0, s33, 135168
  s_lshl_b32 s58, s58, 14
  buffer_load_dwordx4 v252, s[60:63], s58 offen lds
  s_add_u32 s58, s59, 5
  s_and_b32 s58, s58, 15
  s_lshl3_add_u32 s58, s58, s32
  s_add_u32 m0, s33, 139264
  s_lshl_b32 s58, s58, 14
  buffer_load_dwordx4 v252, s[60:63], s58 offen lds
  s_add_u32 s58, s59, 6
  s_and_b32 s58, s58, 15
  s_lshl3_add_u32 s58, s58, s32
  s_add_u32 m0, s33, 143360
  s_lshl_b32 s58, s58, 14
  buffer_load_dwordx4 v252, s[60:63], s58 offen lds
  s_add_u32 s58, s59, 7
  s_and_b32 s58, s58, 15
  s_lshl3_add_u32 s58, s58, s32
  s_add_u32 m0, s33, 147456
  s_lshl_b32 s58, s58, 14
  buffer_load_dwordx4 v252, s[60:63], s58 offen lds
  s_add_u32 s58, s59, 8
  s_and_b32 s58, s58, 15
  s_lshl3_add_u32 s58, s58, s32
  s_add_u32 m0, s33, 151552
  s_lshl_b32 s58, s58, 14
  buffer_load_dwordx4 v252, s[60:63], s58 offen lds
  s_add_u32 s58, s59, 9
  s_and_b32 s58, s58, 15
  s_lshl3_add_u32 s58, s58, s32
  s_add_u32 m0, s33, 155648
  s_lshl_b32 s58, s58, 14
  buffer_load_dwordx4 v252, s[60:63], s58 offen lds
  s_add_u32 s58, s59, 10
  s_and_b32 s58, s58, 15
  s_lshl3_add_u32 s58, s58, s32
  s_add_u32 m0, s33, 159744
  s_lshl_b32 s58, s58, 14
  buffer_load_dwordx4 v252, s[60:63], s58 offen lds
  s_mov_b32 s6, 131072
  s_branch sp13_chk
sp13:
  s_load_dwordx16 s[76:91], s[68:69], s39 glc
sp13_chk:
  s_waitcnt lgkmcnt(0)
  s_and_b64 s[76:77], s[76:77], s[84:85]
  s_and_b64 s[78:79], s[78:79], s[86:87]
  s_and_b64 s[80:81], s[80:81], s[88:89]
  s_and_b64 s[82:83], s[82:83], s[90:91]
  s_and_b64 s[76:77], s[76:77], s[80:81]
  s_and_b64 s[78:79], s[78:79], s[82:83]
  s_and_b64 s[76:77], s[76:77], s[78:79]
  s_and_b32 s76, s76, s77
  s_cbranch_scc1 sp13_ok
  s_sub_u32 s6, s6, 1
  s_cmp_eq_u32 s6, 0
  s_cbranch_scc1 sp13_ok
  s_sleep 2
  s_branch sp13
sp13_ok:
  s_add_u32 s38, s59, 0
  s_and_b32 s38, s38, 15
  s_lshl_b32 s38, s38, 12
  s_add_u32 s38, s38, s35
  buffer_load_dwordx4 v[80:83], v216, s[8:11], s38 offen offset:0
  buffer_load_dwordx4 v[84:87], v216, s[8:11], s38 offen offset:256
  s_add_u32 s38, s59, 1
  s_and_b32 s38, s38, 15
  s_lshl_b32 s38, s38, 12
  s_add_u32 s38, s38, s35
  buffer_load_dwordx4 v[88:91], v216, s[8:11], s38 offen offset:0
  buffer_load_dwordx4 v[92:95], v216, s[8:11], s38 offen offset:256
  s_add_u32 s38, s59, 2
  s_and_b32 s38, s38, 15
  s_lshl_b32 s38, s38, 12
  s_add_u32 s38, s38, s35
  buffer_load_dwordx4 v[96:99], v216, s[8:11], s38 offen offset:0
  buffer_load_dwordx4 v[100:103], v216, s[8:11], s38 offen offset:256
  s_add_u32 s38, s59, 3
  s_and_b32 s38, s38, 15
  s_lshl_b32 s38, s38, 12
  s_add_u32 s38, s38, s35
  buffer_load_dwordx4 v[104:107], v216, s[8:11], s38 offen offset:0
  buffer_load_dwordx4 v[108:111], v216, s[8:11], s38 offen offset:256
  s_waitcnt vmcnt(8)
  v_mov_b32 v4, 122880
  v_mov_b32 v5, 1
  s_mov_b64 exec, 1
  ds_add_u32 v4, v5 offset:44
  s_mov_b64 exec, -1
  v_mov_b32 v4, 122880
  s_mov_b32 s6, 1048576
lw14:
  ds_read_b32 v5, v4 offset:44
  s_waitcnt lgkmcnt(0)
  v_readfirstlane_b32 s7, v5
  s_nop 1
  s_cmp_ge_u32 s7, 4
  s_cbranch_scc1 lw14_ok
  s_sub_u32 s6, s6, 1
  s_cmp_eq_u32 s6, 0
  s_cbranch_scc1 lw14_ok
  s_sleep 1
  s_branch lw14
lw14_ok:
  ds_read_b64_tr_b16 v[16:17], v218 offset:0
  ds_read_b64_tr_b16 v[18:19], v218 offset:1024
  ds_read_b64_tr_b16 v[20:21], v219 offset:0
  ds_read_b64_tr_b16 v[22:23], v219 offset:1024
  ds_read_b64_tr_b16 v[24:25], v220 offset:0
  ds_read_b64_tr_b16 v[26:27], v220 offset:1024
  ds_read_b64_tr_b16 v[28:29], v221 offset:0
  ds_read_b64_tr_b16 v[30:31], v221 offset:1024
  s_waitcnt vmcnt(6)
  s_waitcnt lgkmcnt(6)
  v_mfma_f32_16x16x32_bf16 v[48:51], v[16:19], v[80:83], 0
  ds_read_b64_tr_b16 v[32:33], v218 offset:4096
  v_mfma_f32_16x16x32_bf16 v[64:67], v[16:19], v[84:87], 0
  ds_read_b64_tr_b16 v[34:35], v218 offset:5120
  s_waitcnt lgkmcnt(6)
  v_mfma_f32_16x16x32_bf16 v[52:55], v[20:23], v[80:83], 0
  ds_read_b64_tr_b16 v[36:37], v219 offset:4096
  v_mfma_f32_16x16x32_bf16 v[68:71], v[20:23], v[84:87], 0
  ds_read_b64_tr_b16 v[38:39], v219 offset:5120
  s_waitcnt lgkmcnt(6)
  v_mfma_f32_16x16x32_bf16 v[56:59], v[24:27], v[80:83], 0
  ds_read_b64_tr_b16 v[40:41], v220 offset:4096
  v_mfma_f32_16x16x32_bf16 v[72:75], v[24:27], v[84:87], 0
  ds_read_b64_tr_b16 v[42:43], v220 offset:5120
  s_waitcnt lgkmcnt(6)
  v_mfma_f32_16x16x32_bf16 v[60:63], v[28:31], v[80:83], 0
  ds_read_b64_tr_b16 v[44:45], v221 offset:4096
  v_mfma_f32_16x16x32_bf16 v[76:79], v[28:31], v[84:87], 0
  ds_read_b64_tr_b16 v[46:47], v221 offset:5120
  s_add_u32 s38, s59, 4
  s_and_b32 s38, s38, 15
  s_lshl_b32 s38, s38, 12
  s_add_u32 s38, s38, s35
  buffer_load_dwordx4 v[112:115], v216, s[8:11], s38 offen offset:0
  buffer_load_dwordx4 v[116:119], v216, s[8:11], s38 offen offset:256
  s_waitcnt vmcnt(6)
  s_waitcnt lgkmcnt(6)
  v_mfma_f32_16x16x32_bf16 v[48:51], v[32:35], v[88:91], v[48:51]
  ds_read_b64_tr_b16 v[16:17], v218 offset:8192
  v_mfma_f32_16x16x32_bf16 v[64:67], v[32:35], v[92:95], v[64:67]
  ds_read_b64_tr_b16 v[18:19], v218 offset:9216
  s_waitcnt lgkmcnt(6)
  v_mfma_f32_16x16x32_bf16 v[52:55], v[36:39], v[88:91], v[52:55]
  ds_read_b64_tr_b16 v[20:21], v219 offset:8192
  v_mfma_f32_16x16x32_bf16 v[68:71], v[36:39], v[92:95], v[68:71]
  ds_read_b64_tr_b16 v[22:23], v219 offset:9216
  s_waitcnt lgkmcnt(6)
  v_mfma_f32_16x16x32_bf16 v[56:59], v[40:43], v[88:91], v[56:59]
  ds_read_b64_tr_b16 v[24:25], v220 offset:8192
  v_mfma_f32_16x16x32_bf16 v[72:75], v[40:43], v[92:95], v[72:75]
  ds_read_b64_tr_b16 v[26:27], v220 offset:9216
  s_waitcnt lgkmcnt(6)
  v_mfma_f32_16x16x32_bf16 v[60:63], v[44:47], v[88:91], v[60:63]
  ds_read_b64_tr_b16 v[28:29], v221 offset:8192
  v_mfma_f32_16x16x32_bf16 v[76:79], v[44:47], v[92:95], v[76:79]
  ds_read_b64_tr_b16 v[30:31], v221 offset:9216
  s_add_u32 s38, s59, 5
  s_and_b32 s38, s38, 15
  s_lshl_b32 s38, s38, 12
  s_add_u32 s38, s38, s35
  buffer_load_dwordx4 v[120:123], v216, s[8:11], s38 offen offset:0
  buffer_load_dwordx4 v[124:127], v216, s[8:11], s38 offen offset:256
  s_waitcnt vmcnt(6)
  s_waitcnt lgkmcnt(6)
  v_mfma_f32_16x16x32_bf16 v[48:51], v[16:19], v[96:99], v[48:51]
  ds_read_b64_tr_b16 v[32:33], v218 offset:12288
  v_mfma_f32_16x16x32_bf16 v[64:67], v[16:19], v[100:103], v[64:67]
  ds_read_b64_tr_b16 v[34:35], v218 offset:13312
  s_waitcnt lgkmcnt(6)
  v_mfma_f32_16x16x32_bf16 v[52:55], v[20:23], v[96:99], v[52:55]
  ds_read_b64_tr_b16 v[36:37], v219 offset:12288
  v_mfma_f32_16x16x32_bf16 v[68:71], v[20:23], v[100:103], v[68:71]
  ds_read_b64_tr_b16 v[38:39], v219 offset:13312
  s_waitcnt lgkmcnt(6)
  v_mfma_f32_16x16x32_bf16 v[56:59], v[24:27], v[96:99], v[56:59]
  ds_read_b64_tr_b16 v[40:41], v220 offset:12288
  v_mfma_f32_16x16x32_bf16 v[72:75], v[24:27], v[100:103], v[72:75]
  ds_read_b64_tr_b16 v[42:43], v220 offset:13312
  s_waitcnt lgkmcnt(6)
  v_mfma_f32_16x16x32_bf16 v[60:63], v[28:31], v[96:99], v[60:63]
  ds_read_b64_tr_b16 v[44:45], v221 offset:12288
  v_mfma_f32_16x16x32_bf16 v[76:79], v[28:31], v[100:103], v[76:79]
  ds_read_b64_tr_b16 v[46:47], v221 offset:13312
  s_add_u32 s38, s59, 6
  s_and_b32 s38, s38, 15
  s_lshl_b32 s38, s38, 12
  s_add_u32 s38, s38, s35
  buffer_load_dwordx4 v[128:131], v216, s[8:11], s38 offen offset:0
  buffer_load_dwordx4 v[132:135], v216, s[8:11], s38 offen offset:256
  s_waitcnt vmcnt(6)
  s_waitcnt lgkmcnt(6)
  v_mfma_f32_16x16x32_bf16 v[48:51], v[32:35], v[104:107], v[48:51]
  ds_read_b64_tr_b16 v[16:17], v218 offset:16384
  v_mfma_f32_16x16x32_bf16 v[64:67], v[32:35], v[108:111], v[64:67]
  ds_read_b64_tr_b16 v[18:19], v218 offset:17408
  s_waitcnt lgkmcnt(6)
  v_mfma_f32_16x16x32_bf16 v[52:55], v[36:39], v[104:107], v[52:55]
  ds_read_b64_tr_b16 v[20:21], v219 offset:16384
  v_mfma_f32_16x16x32_bf16 v[68:71], v[36:39], v[108:111], v[68:71]
  ds_read_b64_tr_b16 v[22:23], v219 offset:17408
  s_waitcnt lgkmcnt(6)
  v_mfma_f32_16x16x32_bf16 v[56:59], v[40:43], v[104:107], v[56:59]
  ds_read_b64_tr_b16 v[24:25], v220 offset:16384
  v_mfma_f32_16x16x32_bf16 v[72:75], v[40:43], v[108:111], v[72:75]
  ds_read_b64_tr_b16 v[26:27], v220 offset:17408
  s_waitcnt lgkmcnt(6)
  v_mfma_f32_16x16x32_bf16 v[60:63], v[44:47], v[104:107], v[60:63]
  ds_read_b64_tr_b16 v[28:29], v221 offset:16384
  v_mfma_f32_16x16x32_bf16 v[76:79], v[44:47], v[108:111], v[76:79]
  ds_read_b64_tr_b16 v[30:31], v221 offset:17408
  s_add_u32 s38, s59, 7
  s_and_b32 s38, s38, 15
  s_lshl_b32 s38, s38, 12
  s_add_u32 s38, s38, s35
  buffer_load_dwordx4 v[136:139], v216, s[8:11], s38 offen offset:0
  buffer_load_dwordx4 v[140:143], v216, s[8:11], s38 offen offset:256
  s_waitcnt vmcnt(6)
  s_waitcnt lgkmcnt(6)
  v_mfma_f32_16x16x32_bf16 v[48:51], v[16:19], v[112:115], v[48:51]
  ds_read_b64_tr_b16 v[32:33], v218 offset:20480
  v_mfma_f32_16x16x32_bf16 v[64:67], v[16:19], v[116:119], v[64:67]
  ds_read_b64_tr_b16 v[34:35], v218 offset:21504
  s_waitcnt lgkmcnt(6)
  v_mfma_f32_16x16x32_bf16 v[52:55], v[20:23], v[112:115], v[52:55]
  ds_read_b64_tr_b16 v[36:37], v219 offset:20480
  v_mfma_f32_16x16x32_bf16 v[68:71], v[20:23], v[116:119], v[68:71]
  ds_read_b64_tr_b16 v[38:39], v219 offset:21504
  s_waitcnt lgkmcnt(6)
  v_mfma_f32_16x16x32_bf16 v[56:59], v[24:27], v[112:115], v[56:59]
  ds_read_b64_tr_b16 v[40:41], v220 offset:20480
  v_mfma_f32_16x16x32_bf16 v[72:75], v[24:27], v[116:119], v[72:75]
  ds_read_b64_tr_b16 v[42:43], v220 offset:21504
  s_waitcnt lgkmcnt(6)
  v_mfma_f32_16x16x32_bf16 v[60:63], v[28:31], v[112:115], v[60:63]
  ds_read_b64_tr_b16 v[44:45], v221 offset:20480
  v_mfma_f32_16x16x32_bf16 v[76:79], v[28:31], v[116:119], v[76:79]
  ds_read_b64_tr_b16 v[46:47], v221 offset:21504
  s_add_u32 s38, s59, 8
  s_and_b32 s38, s38, 15
  s_lshl_b32 s38, s38, 12
  s_add_u32 s38, s38, s35
  buffer_load_dwordx4 v[80:83], v216, s[8:11], s38 offen offset:0
  buffer_load_dwordx4 v[84:87], v216, s[8:11], s38 offen offset:256
  s_waitcnt vmcnt(6)
  s_waitcnt lgkmcnt(6)
  v_mfma_f32_16x16x32_bf16 v[48:51], v[32:35], v[120:123], v[48:51]
  ds_read_b64_tr_b16 v[16:17], v218 offset:24576
  v_mfma_f32_16x16x32_bf16 v[64:67], v[32:35], v[124:127], v[64:67]
  ds_read_b64_tr_b16 v[18:19], v218 offset:25600
  s_waitcnt lgkmcnt(6)
  v_mfma_f32_16x16x32_bf16 v[52:55], v[36:39], v[120:123], v[52:55]
  ds_read_b64_tr_b16 v[20:21], v219 offset:24576
  v_mfma_f32_16x16x32_bf16 v[68:71], v[36:39], v[124:127], v[68:71]
  ds_read_b64_tr_b16 v[22:23], v219 offset:25600
  s_waitcnt lgkmcnt(6)
  v_mfma_f32_16x16x32_bf16 v[56:59], v[40:43], v[120:123], v[56:59]
  ds_read_b64_tr_b16 v[24:25], v220 offset:24576
  v_mfma_f32_16x16x32_bf16 v[72:75], v[40:43], v[124:127], v[72:75]
  ds_read_b64_tr_b16 v[26:27], v220 offset:25600
  s_waitcnt lgkmcnt(6)
  v_mfma_f32_16x16x32_bf16 v[60:63], v[44:47], v[120:123], v[60:63]
  ds_read_b64_tr_b16 v[28:29], v221 offset:24576
  v_mfma_f32_16x16x32_bf16 v[76:79], v[44:47], v[124:127], v[76:79]
  ds_read_b64_tr_b16 v[30:31], v221 offset:25600
  s_add_u32 s38, s59, 9
  s_and_b32 s38, s38, 15
  s_lshl_b32 s38, s38, 12
  s_add_u32 s38, s38, s35
  buffer_load_dwordx4 v[88:91], v216, s[8:11], s38 offen offset:0
  buffer_load_dwordx4 v[92:95], v216, s[8:11], s38 offen offset:256
  s_waitcnt vmcnt(6)
  s_waitcnt lgkmcnt(6)
  v_mfma_f32_16x16x32_bf16 v[48:51], v[16:19], v[128:131], v[48:51]
  ds_read_b64_tr_b16 v[32:33], v218 offset:28672
  v_mfma_f32_16x16x32_bf16 v[64:67], v[16:19], v[132:135], v[64:67]
  ds_read_b64_tr_b16 v[34:35], v218 offset:29696
  s_waitcnt lgkmcnt(6)
  v_mfma_f32_16x16x32_bf16 v[52:55], v[20:23], v[128:131], v[52:55]
  ds_read_b64_tr_b16 v[36:37], v219 offset:28672
  v_mfma_f32_16x16x32_bf16 v[68:71], v[20:23], v[132:135], v[68:71]
  ds_read_b64_tr_b16 v[38:39], v219 offset:29696
  s_waitcnt lgkmcnt(6)
  v_mfma_f32_16x16x32_bf16 v[56:59], v[24:27], v[128:131], v[56:59]
  ds_read_b64_tr_b16 v[40:41], v220 offset:28672
  v_mfma_f32_16x16x32_bf16 v[72:75], v[24:27], v[132:135], v[72:75]
  ds_read_b64_tr_b16 v[42:43], v220 offset:29696
  s_waitcnt lgkmcnt(6)
  v_mfma_f32_16x16x32_bf16 v[60:63], v[28:31], v[128:131], v[60:63]
  ds_read_b64_tr_b16 v[44:45], v221 offset:28672
  v_mfma_f32_16x16x32_bf16 v[76:79], v[28:31], v[132:135], v[76:79]
  ds_read_b64_tr_b16 v[46:47], v221 offset:29696
  s_add_u32 s38, s59, 10
  s_and_b32 s38, s38, 15
  s_lshl_b32 s38, s38, 12
  s_add_u32 s38, s38, s35
  buffer_load_dwordx4 v[96:99], v216, s[8:11], s38 offen offset:0
  buffer_load_dwordx4 v[100:103], v216, s[8:11], s38 offen offset:256
  s_waitcnt vmcnt(6)
  s_waitcnt lgkmcnt(6)
  v_mfma_f32_16x16x32_bf16 v[48:51], v[32:35], v[136:139], v[48:51]
  ds_read_b64_tr_b16 v[16:17], v218 offset:32768
  v_mfma_f32_16x16x32_bf16 v[64:67], v[32:35], v[140:143], v[64:67]
  ds_read_b64_tr_b16 v[18:19], v218 offset:33792
  s_waitcnt lgkmcnt(6)
  v_mfma_f32_16x16x32_bf16 v[52:55], v[36:39], v[136:139], v[52:55]
  ds_read_b64_tr_b16 v[20:21], v219 offset:32768
  v_mfma_f32_16x16x32_bf16 v[68:71], v[36:39], v[140:143], v[68:71]
  ds_read_b64_tr_b16 v[22:23], v219 offset:33792
  s_waitcnt lgkmcnt(6)
  v_mfma_f32_16x16x32_bf16 v[56:59], v[40:43], v[136:139], v[56:59]
  ds_read_b64_tr_b16 v[24:25], v220 offset:32768
  v_mfma_f32_16x16x32_bf16 v[72:75], v[40:43], v[140:143], v[72:75]
  ds_read_b64_tr_b16 v[26:27], v220 offset:33792
  s_waitcnt lgkmcnt(6)
  v_mfma_f32_16x16x32_bf16 v[60:63], v[44:47], v[136:139], v[60:63]
  ds_read_b64_tr_b16 v[28:29], v221 offset:32768
  v_mfma_f32_16x16x32_bf16 v[76:79], v[44:47], v[140:143], v[76:79]
  ds_read_b64_tr_b16 v[30:31], v221 offset:33792
  s_add_u32 s38, s59, 11
  s_and_b32 s38, s38, 15
  s_lshl_b32 s38, s38, 12
  s_add_u32 s38, s38, s35
  buffer_load_dwordx4 v[104:107], v216, s[8:11], s38 offen offset:0
  buffer_load_dwordx4 v[108:111], v216, s[8:11], s38 offen offset:256
  v_mov_b32 v4, 122880
  v_mov_b32 v5, 1
  s_mov_b64 exec, 1
  ds_add_u32 v4, v5 offset:56
  s_mov_b64 exec, -1
  s_waitcnt vmcnt(6)
  s_waitcnt lgkmcnt(7)
  v_mfma_f32_16x16x32_bf16 v[48:51], v[16:19], v[80:83], v[48:51]
  ds_read_b64_tr_b16 v[32:33], v218 offset:36864
  v_mfma_f32_16x16x32_bf16 v[64:67], v[16:19], v[84:87], v[64:67]
  ds_read_b64_tr_b16 v[34:35], v218 offset:37888
  s_waitcnt lgkmcnt(7)
  v_mfma_f32_16x16x32_bf16 v[52:55], v[20:23], v[80:83], v[52:55]
  ds_read_b64_tr_b16 v[36:37], v219 offset:36864
  v_mfma_f32_16x16x32_bf16 v[68:71], v[20:23], v[84:87], v[68:71]
  ds_read_b64_tr_b16 v[38:39], v219 offset:37888
  s_waitcnt lgkmcnt(7)
  v_mfma_f32_16x16x32_bf16 v[56:59], v[24:27], v[80:83], v[56:59]
  ds_read_b64_tr_b16 v[40:41], v220 offset:36864
  v_mfma_f32_16x16x32_bf16 v[72:75], v[24:27], v[84:87], v[72:75]
  ds_read_b64_tr_b16 v[42:43], v220 offset:37888
  s_waitcnt lgkmcnt(7)
  v_mfma_f32_16x16x32_bf16 v[60:63], v[28:31], v[80:83], v[60:63]
  ds_read_b64_tr_b16 v[44:45], v221 offset:36864
  v_mfma_f32_16x16x32_bf16 v[76:79], v[28:31], v[84:87], v[76:79]
  ds_read_b64_tr_b16 v[46:47], v221 offset:37888
  s_add_u32 s38, s59, 12
  s_and_b32 s38, s38, 15
  s_lshl_b32 s38, s38, 12
  s_add_u32 s38, s38, s35
  buffer_load_dwordx4 v[112:115], v216, s[8:11], s38 offen offset:0
  buffer_load_dwordx4 v[116:119], v216, s[8:11], s38 offen offset:256
  s_waitcnt vmcnt(6)
  s_waitcnt lgkmcnt(6)
  v_mfma_f32_16x16x32_bf16 v[48:51], v[32:35], v[88:91], v[48:51]
  ds_read_b64_tr_b16 v[16:17], v218 offset:40960
  v_mfma_f32_16x16x32_bf16 v[64:67], v[32:35], v[92:95], v[64:67]
  ds_read_b64_tr_b16 v[18:19], v218 offset:41984
  s_waitcnt lgkmcnt(6)
  v_mfma_f32_16x16x32_bf16 v[52:55], v[36:39], v[88:91], v[52:55]
  ds_read_b64_tr_b16 v[20:21], v219 offset:40960
  v_mfma_f32_16x16x32_bf16 v[68:71], v[36:39], v[92:95], v[68:71]
  ds_read_b64_tr_b16 v[22:23], v219 offset:41984
  s_waitcnt lgkmcnt(6)
  v_mfma_f32_16x16x32_bf16 v[56:59], v[40:43], v[88:91], v[56:59]
  ds_read_b64_tr_b16 v[24:25], v220 offset:40960
  v_mfma_f32_16x16x32_bf16 v[72:75], v[40:43], v[92:95], v[72:75]
  ds_read_b64_tr_b16 v[26:27], v220 offset:41984
  s_waitcnt lgkmcnt(6)
  v_mfma_f32_16x16x32_bf16 v[60:63], v[44:47], v[88:91], v[60:63]
  ds_read_b64_tr_b16 v[28:29], v221 offset:40960
  v_mfma_f32_16x16x32_bf16 v[76:79], v[44:47], v[92:95], v[76:79]
  ds_read_b64_tr_b16 v[30:31], v221 offset:41984
  s_add_u32 s38, s59, 13
  s_and_b32 s38, s38, 15
  s_lshl_b32 s38, s38, 12
  s_add_u32 s38, s38, s35
  buffer_load_dwordx4 v[120:123], v216, s[8:11], s38 offen offset:0
  buffer_load_dwordx4 v[124:127], v216, s[8:11], s38 offen offset:256
  buffer_load_dword v232, v225, s[68:71], 0 offen sc1
  s_waitcnt vmcnt(7)
  s_waitcnt lgkmcnt(6)
  v_mfma_f32_16x16x32_bf16 v[48:51], v[16:19], v[96:99], v[48:51]
  ds_read_b64_tr_b16 v[32:33], v218 offset:45056
  v_mfma_f32_16x16x32_bf16 v[64:67], v[16:19], v[100:103], v[64:67]
  ds_read_b64_tr_b16 v[34:35], v218 offset:46080
  s_waitcnt lgkmcnt(6)
  v_mfma_f32_16x16x32_bf16 v[52:55], v[20:23], v[96:99], v[52:55]
  ds_read_b64_tr_b16 v[36:37], v219 offset:45056
  v_mfma_f32_16x16x32_bf16 v[68:71], v[20:23], v[100:103], v[68:71]
  ds_read_b64_tr_b16 v[38:39], v219 offset:46080
  s_waitcnt lgkmcnt(6)
  v_mfma_f32_16x16x32_bf16 v[56:59], v[24:27], v[96:99], v[56:59]
  ds_read_b64_tr_b16 v[40:41], v220 offset:45056
  v_mfma_f32_16x16x32_bf16 v[72:75], v[24:27], v[100:103], v[72:75]
  ds_read_b64_tr_b16 v[42:43], v220 offset:46080
  s_waitcnt lgkmcnt(6)
  v_mfma_f32_16x16x32_bf16 v[60:63], v[28:31], v[96:99], v[60:63]
  ds_read_b64_tr_b16 v[44:45], v221 offset:45056
  v_mfma_f32_16x16x32_bf16 v[76:79], v[28:31], v[100:103], v[76:79]
  ds_read_b64_tr_b16 v[46:47], v221 offset:46080
  s_add_u32 s38, s59, 14
  s_and_b32 s38, s38, 15
  s_lshl_b32 s38, s38, 12
  s_add_u32 s38, s38, s35
  buffer_load_dwordx4 v[128:131], v216, s[8:11], s38 offen offset:0
  buffer_load_dwordx4 v[132:135], v216, s[8:11], s38 offen offset:256
  s_waitcnt vmcnt(7)
  s_waitcnt lgkmcnt(6)
  v_mfma_f32_16x16x32_bf16 v[48:51], v[32:35], v[104:107], v[48:51]
  ds_read_b64_tr_b16 v[16:17], v218 offset:49152
  v_mfma_f32_16x16x32_bf16 v[64:67], v[32:35], v[108:111], v[64:67]
  ds_read_b64_tr_b16 v[18:19], v218 offset:50176
  s_waitcnt lgkmcnt(6)
  v_mfma_f32_16x16x32_bf16 v[52:55], v[36:39], v[104:107], v[52:55]
  ds_read_b64_tr_b16 v[20:21], v219 offset:49152
  v_mfma_f32_16x16x32_bf16 v[68:71], v[36:39], v[108:111], v[68:71]
  ds_read_b64_tr_b16 v[22:23], v219 offset:50176
  s_waitcnt lgkmcnt(6)
  v_mfma_f32_16x16x32_bf16 v[56:59], v[40:43], v[104:107], v[56:59]
  ds_read_b64_tr_b16 v[24:25], v220 offset:49152
  v_mfma_f32_16x16x32_bf16 v[72:75], v[40:43], v[108:111], v[72:75]
  ds_read_b64_tr_b16 v[26:27], v220 offset:50176
  s_waitcnt lgkmcnt(6)
  v_mfma_f32_16x16x32_bf16 v[60:63], v[44:47], v[104:107], v[60:63]
  ds_read_b64_tr_b16 v[28:29], v221 offset:49152
  v_mfma_f32_16x16x32_bf16 v[76:79], v[44:47], v[108:111], v[76:79]
  ds_read_b64_tr_b16 v[30:31], v221 offset:50176
  s_add_u32 s38, s59, 15
  s_and_b32 s38, s38, 15
  s_lshl_b32 s38, s38, 12
  s_add_u32 s38, s38, s35
  buffer_load_dwordx4 v[136:139], v216, s[8:11], s38 offen offset:0
  buffer_load_dwordx4 v[140:143], v216, s[8:11], s38 offen offset:256
  s_waitcnt vmcnt(7)
  s_waitcnt lgkmcnt(6)
  v_mfma_f32_16x16x32_bf16 v[48:51], v[16:19], v[112:115], v[48:51]
  ds_read_b64_tr_b16 v[32:33], v218 offset:53248
  v_mfma_f32_16x16x32_bf16 v[64:67], v[16:19], v[116:119], v[64:67]
  ds_read_b64_tr_b16 v[34:35], v218 offset:54272
  s_waitcnt lgkmcnt(6)
  v_mfma_f32_16x16x32_bf16 v[52:55], v[20:23], v[112:115], v[52:55]
  ds_read_b64_tr_b16 v[36:37], v219 offset:53248
  v_mfma_f32_16x16x32_bf16 v[68:71], v[20:23], v[116:119], v[68:71]
  ds_read_b64_tr_b16 v[38:39], v219 offset:54272
  s_waitcnt lgkmcnt(6)
  v_mfma_f32_16x16x32_bf16 v[56:59], v[24:27], v[112:115], v[56:59]
  ds_read_b64_tr_b16 v[40:41], v220 offset:53248
  v_mfma_f32_16x16x32_bf16 v[72:75], v[24:27], v[116:119], v[72:75]
  ds_read_b64_tr_b16 v[42:43], v220 offset:54272
  s_waitcnt lgkmcnt(6)
  v_mfma_f32_16x16x32_bf16 v[60:63], v[28:31], v[112:115], v[60:63]
  ds_read_b64_tr_b16 v[44:45], v221 offset:53248
  v_mfma_f32_16x16x32_bf16 v[76:79], v[28:31], v[116:119], v[76:79]
  ds_read_b64_tr_b16 v[46:47], v221 offset:54272
  s_waitcnt vmcnt(5)
  s_waitcnt lgkmcnt(6)
  v_mfma_f32_16x16x32_bf16 v[48:51], v[32:35], v[120:123], v[48:51]
  ds_read_b64_tr_b16 v[16:17], v218 offset:57344
  v_mfma_f32_16x16x32_bf16 v[64:67], v[32:35], v[124:127], v[64:67]
  ds_read_b64_tr_b16 v[18:19], v218 offset:58368
  s_waitcnt lgkmcnt(6)
  v_mfma_f32_16x16x32_bf16 v[52:55], v[36:39], v[120:123], v[52:55]
  ds_read_b64_tr_b16 v[20:21], v219 offset:57344
  v_mfma_f32_16x16x32_bf16 v[68:71], v[36:39], v[124:127], v[68:71]
  ds_read_b64_tr_b16 v[22:23], v219 offset:58368
  s_waitcnt lgkmcnt(6)
  v_mfma_f32_16x16x32_bf16 v[56:59], v[40:43], v[120:123], v[56:59]
  ds_read_b64_tr_b16 v[24:25], v220 offset:57344
  v_mfma_f32_16x16x32_bf16 v[72:75], v[40:43], v[124:127], v[72:75]
  ds_read_b64_tr_b16 v[26:27], v220 offset:58368
  s_waitcnt lgkmcnt(6)
  v_mfma_f32_16x16x32_bf16 v[60:63], v[44:47], v[120:123], v[60:63]
  ds_read_b64_tr_b16 v[28:29], v221 offset:57344
  v_mfma_f32_16x16x32_bf16 v[76:79], v[44:47], v[124:127], v[76:79]
  ds_read_b64_tr_b16 v[30:31], v221 offset:58368
  s_waitcnt vmcnt(4)
  s_mov_b32 s6, 131072
  s_branch poll15_chk
poll15:
  buffer_load_dword v232, v225, s[68:71], 0 offen sc1
  s_waitcnt vmcnt(0)
poll15_chk:
  v_cmp_gt_u32 vcc, 3, v232
  s_nop 1
  s_cmp_eq_u64 vcc, 0
  s_cbranch_scc1 poll15_ok
  s_sub_u32 s6, s6, 1
  s_cmp_eq_u32 s6, 0
  s_cbranch_scc1 poll15_ok
  s_sleep 1
  s_branch poll15
poll15_ok:
  buffer_load_dwordx4 v[192:195], v226, s[12:15], 0 offen offset:0 sc1
  buffer_load_dwordx4 v[196:199], v226, s[12:15], 0 offen offset:16 sc1
  buffer_load_dwordx4 v[200:203], v226, s[12:15], s34 offen offset:0 sc1
  buffer_load_dwordx4 v[204:207], v226, s[12:15], s34 offen offset:16 sc1
  s_waitcnt vmcnt(6)
  s_waitcnt lgkmcnt(6)
  v_mfma_f32_16x16x32_bf16 v[48:51], v[16:19], v[128:131], v[48:51]
  ds_read_b64_tr_b16 v[32:33], v218 offset:61440
  v_mfma_f32_16x16x32_bf16 v[64:67], v[16:19], v[132:135], v[64:67]
  ds_read_b64_tr_b16 v[34:35], v218 offset:62464
  s_waitcnt lgkmcnt(6)
  v_mfma_f32_16x16x32_bf16 v[52:55], v[20:23], v[128:131], v[52:55]
  ds_read_b64_tr_b16 v[36:37], v219 offset:61440
  v_mfma_f32_16x16x32_bf16 v[68:71], v[20:23], v[132:135], v[68:71]
  ds_read_b64_tr_b16 v[38:39], v219 offset:62464
  s_waitcnt lgkmcnt(6)
  v_mfma_f32_16x16x32_bf16 v[56:59], v[24:27], v[128:131], v[56:59]
  ds_read_b64_tr_b16 v[40:41], v220 offset:61440
  v_mfma_f32_16x16x32_bf16 v[72:75], v[24:27], v[132:135], v[72:75]
  ds_read_b64_tr_b16 v[42:43], v220 offset:62464
  s_waitcnt lgkmcnt(6)
  v_mfma_f32_16x16x32_bf16 v[60:63], v[28:31], v[128:131], v[60:63]
  ds_read_b64_tr_b16 v[44:45], v221 offset:61440
  v_mfma_f32_16x16x32_bf16 v[76:79], v[28:31], v[132:135], v[76:79]
  ds_read_b64_tr_b16 v[46:47], v221 offset:62464
  s_waitcnt vmcnt(4)
  s_waitcnt lgkmcnt(6)
  v_mfma_f32_16x16x32_bf16 v[48:51], v[32:35], v[136:139], v[48:51]
  v_mfma_f32_16x16x32_bf16 v[64:67], v[32:35], v[140:143], v[64:67]
  s_waitcnt lgkmcnt(4)
  v_mfma_f32_16x16x32_bf16 v[52:55], v[36:39], v[136:139], v[52:55]
  v_mfma_f32_16x16x32_bf16 v[68:71], v[36:39], v[140:143], v[68:71]
  s_waitcnt lgkmcnt(2)
  v_mfma_f32_16x16x32_bf16 v[56:59], v[40:43], v[136:139], v[56:59]
  v_mfma_f32_16x16x32_bf16 v[72:75], v[40:43], v[140:143], v[72:75]
  s_waitcnt lgkmcnt(0)
  v_mfma_f32_16x16x32_bf16 v[60:63], v[44:47], v[136:139], v[60:63]
  v_mfma_f32_16x16x32_bf16 v[76:79], v[44:47], v[140:143], v[76:79]
  v_mov_b32 v4, 122880
  s_mov_b32 s6, 1048576
lw16:
  ds_read_b32 v5, v4 offset:56
  s_waitcnt lgkmcnt(0)
  v_readfirstlane_b32 s7, v5
  s_nop 1
  s_cmp_ge_u32 s7, 4
  s_cbranch_scc1 lw16_ok
  s_sub_u32 s6, s6, 1
  s_cmp_eq_u32 s6, 0
  s_cbranch_scc1 lw16_ok
  s_sleep 1
  s_branch lw16
lw16_ok:
  ds_write_b128 v222, v[48:51] offset:0
  ds_write_b128 v222, v[52:55] offset:1024
  ds_write_b128 v222, v[56:59] offset:2048
  ds_write_b128 v222, v[60:63] offset:3072
  ds_write_b128 v222, v[64:67] offset:4096
  ds_write_b128 v222, v[68:71] offset:5120
  ds_write_b128 v222, v[72:75] offset:6144
  ds_write_b128 v222, v[76:79] offset:7168
  v_mov_b32 v4, 122880
  v_mov_b32 v5, 1
  s_mov_b64 exec, 1
  ds_add_u32 v4, v5 offset:60
  s_mov_b64 exec, -1
  s_waitcnt vmcnt(0)
  v_lshlrev_b32 v232, 16, v244
  v_lshlrev_b32 v236, 16, v192
  v_and_b32 v233, 0xffff0000, v244
  v_and_b32 v237, 0xffff0000, v192
  v_lshlrev_b32 v234, 16, v245
  v_lshlrev_b32 v238, 16, v193
  v_and_b32 v235, 0xffff0000, v245
  v_and_b32 v239, 0xffff0000, v193
  v_mul_f32 v232, v232, v236
  v_mul_f32 v233, v233, v237
  v_mul_f32 v234, v234, v238
  v_mul_f32 v235, v235, v239
  v_cvt_pk_bf16_f32 v8, v232, v233
  v_cvt_pk_bf16_f32 v9, v234, v235
  s_mov_b32 s31, 0
  buffer_store_dwordx2 v[8:9], v227, s[20:23], s31 offen nt
  v_lshlrev_b32 v232, 16, v246
  v_lshlrev_b32 v236, 16, v194
  v_and_b32 v233, 0xffff0000, v246
  v_and_b32 v237, 0xffff0000, v194
  v_lshlrev_b32 v234, 16, v247
  v_lshlrev_b32 v238, 16, v195
  v_and_b32 v235, 0xffff0000, v247
  v_and_b32 v239, 0xffff0000, v195
  v_mul_f32 v232, v232, v236
  v_mul_f32 v233, v233, v237
  v_mul_f32 v234, v234, v238
  v_mul_f32 v235, v235, v239
  v_cvt_pk_bf16_f32 v10, v232, v233
  v_cvt_pk_bf16_f32 v11, v234, v235
  s_mov_b32 s31, 4096
  buffer_store_dwordx2 v[10:11], v227, s[20:23], s31 offen nt
  v_lshlrev_b32 v232, 16, v248
  v_lshlrev_b32 v236, 16, v196
  v_and_b32 v233, 0xffff0000, v248
  v_and_b32 v237, 0xffff0000, v196
  v_lshlrev_b32 v234, 16, v249
  v_lshlrev_b32 v238, 16, v197
  v_and_b32 v235, 0xffff0000, v249
  v_and_b32 v239, 0xffff0000, v197
  v_mul_f32 v232, v232, v236
  v_mul_f32 v233, v233, v237
  v_mul_f32 v234, v234, v238
  v_mul_f32 v235, v235, v239
  v_cvt_pk_bf16_f32 v12, v232, v233
  v_cvt_pk_bf16_f32 v13, v234, v235
  s_mov_b32 s31, 8192
  buffer_store_dwordx2 v[12:13], v227, s[20:23], s31 offen nt
  v_lshlrev_b32 v232, 16, v250
  v_lshlrev_b32 v236, 16, v198
  v_and_b32 v233, 0xffff0000, v250
  v_and_b32 v237, 0xffff0000, v198
  v_lshlrev_b32 v234, 16, v251
  v_lshlrev_b32 v238, 16, v199
  v_and_b32 v235, 0xffff0000, v251
  v_and_b32 v239, 0xffff0000, v199
  v_mul_f32 v232, v232, v236
  v_mul_f32 v233, v233, v237
  v_mul_f32 v234, v234, v238
  v_mul_f32 v235, v235, v239
  v_cvt_pk_bf16_f32 v14, v232, v233
  v_cvt_pk_bf16_f32 v15, v234, v235
  s_mov_b32 s31, 12288
  buffer_store_dwordx2 v[14:15], v227, s[20:23], s31 offen nt
  v_lshlrev_b32 v232, 16, v184
  v_lshlrev_b32 v236, 16, v200
  v_and_b32 v233, 0xffff0000, v184
  v_and_b32 v237, 0xffff0000, v200
  v_lshlrev_b32 v234, 16, v185
  v_lshlrev_b32 v238, 16, v201
  v_and_b32 v235, 0xffff0000, v185
  v_and_b32 v239, 0xffff0000, v201
  v_mul_f32 v232, v232, v236
  v_mul_f32 v233, v233, v237
  v_mul_f32 v234, v234, v238
  v_mul_f32 v235, v235, v239
  v_cvt_pk_bf16_f32 v8, v232, v233
  v_cvt_pk_bf16_f32 v9, v234, v235
  s_mov_b32 s31, 262144
  buffer_store_dwordx2 v[8:9], v227, s[20:23], s31 offen nt
  v_lshlrev_b32 v232, 16, v186
  v_lshlrev_b32 v236, 16, v202
  v_and_b32 v233, 0xffff0000, v186
  v_and_b32 v237, 0xffff0000, v202
  v_lshlrev_b32 v234, 16, v187
  v_lshlrev_b32 v238, 16, v203
  v_and_b32 v235, 0xffff0000, v187
  v_and_b32 v239, 0xffff0000, v203
  v_mul_f32 v232, v232, v236
  v_mul_f32 v233, v233, v237
  v_mul_f32 v234, v234, v238
  v_mul_f32 v235, v235, v239
  v_cvt_pk_bf16_f32 v10, v232, v233
  v_cvt_pk_bf16_f32 v11, v234, v235
  s_mov_b32 s31, 266240
  buffer_store_dwordx2 v[10:11], v227, s[20:23], s31 offen nt
  v_lshlrev_b32 v232, 16, v188
  v_lshlrev_b32 v236, 16, v204
  v_and_b32 v233, 0xffff0000, v188
  v_and_b32 v237, 0xffff0000, v204
  v_lshlrev_b32 v234, 16, v189
  v_lshlrev_b32 v238, 16, v205
  v_and_b32 v235, 0xffff0000, v189
  v_and_b32 v239, 0xffff0000, v205
  v_mul_f32 v232, v232, v236
  v_mul_f32 v233, v233, v237
  v_mul_f32 v234, v234, v238
  v_mul_f32 v235, v235, v239
  v_cvt_pk_bf16_f32 v12, v232, v233
  v_cvt_pk_bf16_f32 v13, v234, v235
  s_mov_b32 s31, 270336
  buffer_store_dwordx2 v[12:13], v227, s[20:23], s31 offen nt
  v_lshlrev_b32 v232, 16, v190
  v_lshlrev_b32 v236, 16, v206
  v_and_b32 v233, 0xffff0000, v190
  v_and_b32 v237, 0xffff0000, v206
  v_lshlrev_b32 v234, 16, v191
  v_lshlrev_b32 v238, 16, v207
  v_and_b32 v235, 0xffff0000, v191
  v_and_b32 v239, 0xffff0000, v207
  v_mul_f32 v232, v232, v236
  v_mul_f32 v233, v233, v237
  v_mul_f32 v234, v234, v238
  v_mul_f32 v235, v235, v239
  v_cvt_pk_bf16_f32 v14, v232, v233
  v_cvt_pk_bf16_f32 v15, v234, v235
  s_mov_b32 s31, 274432
  buffer_store_dwordx2 v[14:15], v227, s[20:23], s31 offen nt
  s_branch mk_fin
mk_ld:
  s_and_b32 s52, s2, 7
  s_lshr_b32 s53, s2, 3
  s_lshr_b32 s54, s53, 1
  s_and_b32 s59, s53, 1
  s_lshl_b32 s56, s52, 1
  s_add_u32 s55, s56, s59
  s_lshl_b32 s51, s52, 5
  s_add_u32 s50, s51, s53
  s_lshl_b32 s51, s50, 2
  s_and_b32 s56, s52, 3
  s_lshl_b32 s56, s56, 2
  s_and_b32 s58, s53, 3
  s_add_u32 s56, s56, s58
  s_lshr_b32 s57, s52, 2
  s_lshl_b32 s57, s57, 3
  s_lshr_b32 s59, s53, 2
  s_add_u32 s57, s57, s59
  s_mul_i32 s58, s58, 4
  s_mul_i32 s59, s59, 2
  s_add_u32 s59, s59, s58
  s_and_b32 s59, s59, 15
  s_xor_b32 s28, s3, 5
  s_or_b32 s28, s28, s2
  s_cbranch_scc0 mk_clr
mk_clb:
  s_sub_u32 s26, s3, 4
  v_lshrrev_b32 v2, 3, v0
  v_and_b32 v3, 7, v0
  v_lshrrev_b32 v4, 4, v0
  v_xor_b32 v5, v3, v4
  v_lshlrev_b32 v6, 11, v2
  v_lshl_add_u32 v8, v5, 4, v6
  v_xor_b32 v9, 64, v8
  v_and_b32 v4, 1, v4
  v_lshlrev_b32 v4, 2, v4
  v_xor_b32 v5, v3, v4
  v_mul_u32_u24 v6, 6144, v2
  v_lshl_add_u32 v10, v5, 4, v6
  v_xor_b32 v11, 32, v10
  v_add_u32 v16, 0, v8
  v_add_u32 v17, 15360, v8
  v_add_u32 v18, 30720, v9
  v_add_u32 v19, 46080, v9
  s_lshl_b32 s27, s54, 2
  s_add_u32 s27, s27, s26
  s_lshl_b32 s27, s27, 16
  s_lshl_b32 s28, s26, 12
  s_add_u32 s28, s28, 0
  s_mul_i32 s29, s26, 6
  s_lshl_b32 s30, s29, 10
  s_add_u32 s30, s30, 16384
  s_add_u32 s31, s29, 0
  s_lshr_b32 s32, s31, 3
  s_and_b32 s31, s31, 7
  s_mul_i32 s31, s31, 49152
  s_and_b32 s34, s32, 1
  s_xor_b32 s34, s34, s55
  s_lshl_b32 s34, s34, 7
  s_lshl_b32 s32, s32, 11
  s_add_u32 s31, s31, s32
  s_add_u32 s31, s31, s34
  v_add_u32 v20, s31, v10
  s_add_u32 s31, s29, 1
  s_lshr_b32 s32, s31, 3
  s_and_b32 s31, s31, 7
  s_mul_i32 s31, s31, 49152
  s_and_b32 s34, s32, 1
  s_xor_b32 s34, s34, s55
  s_lshl_b32 s34, s34, 7
  s_lshl_b32 s32, s32, 11
  s_add_u32 s31, s31, s32
  s_add_u32 s31, s31, s34
  s_sub_u32 s31, s31, 1024
  v_add_u32 v21, s31, v11
  s_add_u32 s31, s29, 2
  s_lshr_b32 s32, s31, 3
  s_and_b32 s31, s31, 7
  s_mul_i32 s31, s31, 49152
  s_and_b32 s34, s32, 1
  s_xor_b32 s34, s34, s55
  s_lshl_b32 s34, s34, 7
  s_lshl_b32 s32, s32, 11
  s_add_u32 s31, s31, s32
  s_add_u32 s31, s31, s34
  s_sub_u32 s31, s31, 2048
  v_add_u32 v22, s31, v10
  s_add_u32 s31, s29, 3
  s_lshr_b32 s32, s31, 3
  s_and_b32 s31, s31, 7
  s_mul_i32 s31, s31, 49152
  s_and_b32 s34, s32, 1
  s_xor_b32 s34, s34, s55
  s_lshl_b32 s34, s34, 7
  s_lshl_b32 s32, s32, 11
  s_add_u32 s31, s31, s32
  s_add_u32 s31, s31, s34
  s_sub_u32 s31, s31, 3072
  v_add_u32 v23, s31, v11
  s_add_u32 s31, s29, 4
  s_lshr_b32 s32, s31, 3
  s_and_b32 s31, s31, 7
  s_mul_i32 s31, s31, 49152
  s_and_b32 s34, s32, 1
  s_xor_b32 s34, s34, s55
  s_lshl_b32 s34, s34, 7
  s_lshl_b32 s32, s32, 11
  s_add_u32 s31, s31, s32
  s_add_u32 s31, s31, s34
  v_add_u32 v24, s31, v10
  s_add_u32 s31, s29, 5
  s_lshr_b32 s32, s31, 3
  s_and_b32 s31, s31, 7
  s_mul_i32 s31, s31, 49152
  s_and_b32 s34, s32, 1
  s_xor_b32 s34, s34, s55
  s_lshl_b32 s34, s34, 7
  s_lshl_b32 s32, s32, 11
  s_add_u32 s31, s31, s32
  s_add_u32 s31, s31, s34
  s_sub_u32 s31, s31, 1024
  v_add_u32 v25, s31, v11
  s_and_b32 s46, s53, 1
  s_mul_i32 s46, s46, 2
  s_mul_i32 s47, s52, 1
  s_add_u32 s46, s46, s47
  s_lshr_b32 s47, s54, 0
  s_mul_i32 s47, s47, 1
  s_add_u32 s46, s46, s47
  s_and_b32 s46, s46, 3
  s_mov_b32 s10, 0x400000
  s_mov_b32 s11, 0x00020000
  s_mov_b32 s14, 0x600000
  s_mov_b32 s15, 0x00020000
  s_waitcnt lgkmcnt(0)
  s_mov_b64 s[8:9], s[88:89]
  s_mov_b64 s[12:13], s[90:91]
  s_add_u32 s47, s46, 0
  s_and_b32 s47, s47, 3
  s_add_u32 s47, s47, 0
  s_lshl_b32 s37, s47, 7
  s_add_u32 s37, s37, s27
  s_mul_i32 s47, s47, 393216
  s_add_u32 m0, s28, 0
  s_nop 0
  buffer_load_dwordx4 v16, s[8:11], s37 offen offset:0  lds
  buffer_load_dwordx4 v17, s[8:11], s37 offen offset:1024  lds
  buffer_load_dwordx4 v18, s[8:11], s37 offen offset:2048  lds
  buffer_load_dwordx4 v19, s[8:11], s37 offen offset:3072  lds
  s_add_u32 m0, s30, 0
  s_nop 0
  buffer_load_dwordx4 v20, s[12:15], s47 offen offset:0  lds
  buffer_load_dwordx4 v21, s[12:15], s47 offen offset:1024  lds
  buffer_load_dwordx4 v22, s[12:15], s47 offen offset:2048  lds
  buffer_load_dwordx4 v23, s[12:15], s47 offen offset:3072  lds
  s_add_u32 m0, s30, 4096
  s_nop 0
  buffer_load_dwordx4 v24, s[12:15], s47 offen offset:0  lds
  buffer_load_dwordx4 v25, s[12:15], s47 offen offset:1024  lds
  s_add_u32 s68, s98, 0x1800000
  s_addc_u32 s69, s99, 0
  s_mov_b32 s70, 0x2c00
  s_mov_b32 s71, 0x00020000
  s_mov_b32 s72, s96
  s_mov_b32 s73, s97
  s_mov_b32 s74, 0x100
  s_mov_b32 s75, 0x00020000
  s_xor_b32 s31, s3, 5
  s_or_b32 s31, s31, s2
  s_cbranch_scc1 ld_nogo
  v_mov_b32 v12, 1
  v_mov_b32 v13, 0
  s_waitcnt vmcnt(10)
  buffer_store_dword v12, v13, s[72:75], 0 offen sc1
ld_nogo:
  v_and_b32 v2, 15, v0
  s_mul_i32 s44, s26, 9216
  s_add_u32 s44, s44, 126976
  s_add_u32 s45, s51, s26
  s_lshl_b32 s31, s45, 1
  v_mov_b32 v230, s31
  s_lshl_b32 s45, s45, 12
  v_mov_b32 v231, s45
  s_lshr_b32 s43, s50, 4
  s_lshl_b32 s43, s43, 18
  s_and_b32 s31, s50, 15
  s_lshl_b32 s31, s31, 8
  s_add_u32 s43, s43, s31
  s_lshl_b32 s31, s26, 6
  s_add_u32 s43, s43, s31
  v_lshrrev_b32 v4, 2, v0
  v_lshlrev_b32 v4, 12, v4
  v_and_b32 v5, 3, v0
  v_lshl_add_u32 v120, v5, 4, v4
  v_mov_b32 v14, 0
  v_lshrrev_b32 v254, 0, v0
  v_lshlrev_b32 v254, 11, v254
  s_and_b32 s35, s53, 3
  s_lshl_b32 s35, s35, 2
  s_add_u32 s35, s35, s26
  s_lshl_b32 s35, s35, 17
  s_lshl_b32 s31, s57, 7
  s_add_u32 s35, s35, s31
  v_lshlrev_b32 v4, 2, v0
  v_add_u32 v15, 122880, v4
  ds_write_b32 v15, v14
  v_add_u32 v4, s44, v4
  ds_write_b32 v4, v14
  v_lshl_add_u32 v4, v2, 2, s44
  ds_write_b32 v4, v14 offset:4352
  s_add_u32 s20, s98, 0x1000000
  s_addc_u32 s21, s99, 0
  s_mov_b32 s22, 0x400000
  s_mov_b32 s23, 0x00020000
  s_mov_b32 s16, s84
  s_mov_b32 s17, s85
  s_mov_b32 s18, 0x400000
  s_mov_b32 s19, 0x00020000
  s_mov_b32 s64, s86
  s_mov_b32 s65, s87
  s_mov_b32 s66, 0x800
  s_mov_b32 s67, 0x00020000
  v_lshrrev_b32 v12, 4, v0
  v_bfe_u32 v5, v0, 2, 2
  v_and_b32 v6, 3, v0
  v_lshlrev_b32 v13, 2, v6
  v_sub_u32 v13, v13, v5
  v_lshlrev_b32 v8, 3, v12
  v_sub_u32 v13, v13, v8
  v_lshlrev_b32 v13, 3, v13
  s_add_u32 s31, s44, 248
  v_add_u32 v228, s31, v13
  v_add3_u32 v13, v8, v5, v6
  v_lshlrev_b32 v13, 3, v13
  s_add_u32 s31, s44, 4392
  v_add_u32 v229, s31, v13
  v_and_b32 v212, 7, v0
  v_bfe_u32 v213, v0, 4, 1
  v_lshlrev_b32 v213, 2, v213
  v_xor_b32 v212, v212, v213
  v_bfe_u32 v213, v0, 5, 1
  v_lshlrev_b32 v213, 1, v213
  v_xor_b32 v212, v212, v213
  v_lshrrev_b32 v213, 3, v0
  v_lshlrev_b32 v213, 11, v213
  v_lshl_add_u32 v252, v212, 4, v213
  s_lshl_b32 s58, s57, 7
  v_add_u32 v252, s58, v252
  s_mov_b32 s60, s92
  s_mov_b32 s61, s93
  s_mov_b32 s62, 0x200000
  s_mov_b32 s63, 0x00020000
  s_lshr_b32 s38, s3, 2
  s_and_b32 s39, s3, 3
  s_lshl_b32 s24, s55, 1
  s_add_u32 s24, s24, s38
  s_lshl_b32 s25, s54, 2
  s_add_u32 s25, s25, s39
  v_lshlrev_b32 v2, 4, v0
  v_bfe_u32 v1, v0, 3, 1
  v_lshlrev_b32 v1, 10, v1
  v_lshrrev_b32 v6, 5, v0
  v_lshl_add_u32 v1, v6, 8, v1
  v_bfe_u32 v5, v0, 4, 1
  v_lshl_add_u32 v1, v5, 7, v1
  v_and_b32 v7, 7, v0
  v_lshl_add_u32 v1, v7, 4, v1
  v_lshlrev_b32 v3, 10, v5
  v_lshl_add_u32 v3, v6, 8, v3
  v_and_b32 v7, 15, v0
  v_lshl_add_u32 v3, v7, 4, v3
  v_and_b32 v5, 31, v0
  v_lshlrev_b32 v7, 2, v6
  v_sub_u32 v7, v5, v7
  s_xor_b32 s32, s38, 1
  s_mul_i32 s32, s32, 49152
  s_lshl_b32 s33, s39, 11
  s_add_u32 s32, s32, s33
  s_add_u32 s33, s32, 0
  v_add_u32 v4, s33, v1
  s_add_u32 s33, s32, 24576
  v_add_u32 v3, s33, v3
  s_lshl_b32 s33, s3, 11
  s_add_u32 s33, s33, 98304
  v_add_u32 v1, s33, v1
  v_mov_b32 v5, 0xffff
  v_mov_b32 v6, 0xffff0000
  v_cmp_le_i32 vcc, 0, v7
  s_nop 1
  v_cndmask_b32 v232, 0, v5, vcc
  v_cmp_le_i32 vcc, 1, v7
  s_nop 1
  v_cndmask_b32 v212, 0, v6, vcc
  v_or_b32 v232, v232, v212
  v_cmp_le_i32 vcc, 2, v7
  s_nop 1
  v_cndmask_b32 v233, 0, v5, vcc
  v_cmp_le_i32 vcc, 3, v7
  s_nop 1
  v_cndmask_b32 v212, 0, v6, vcc
  v_or_b32 v233, v233, v212
  v_cmp_le_i32 vcc, 8, v7
  s_nop 1
  v_cndmask_b32 v234, 0, v5, vcc
  v_cmp_le_i32 vcc, 9, v7
  s_nop 1
  v_cndmask_b32 v212, 0, v6, vcc
  v_or_b32 v234, v234, v212
  v_cmp_le_i32 vcc, 10, v7
  s_nop 1
  v_cndmask_b32 v235, 0, v5, vcc
  v_cmp_le_i32 vcc, 11, v7
  s_nop 1
  v_cndmask_b32 v212, 0, v6, vcc
  v_or_b32 v235, v235, v212
  v_cmp_le_i32 vcc, 16, v7
  s_nop 1
  v_cndmask_b32 v236, 0, v5, vcc
  v_cmp_le_i32 vcc, 17, v7
  s_nop 1
  v_cndmask_b32 v212, 0, v6, vcc
  v_or_b32 v236, v236, v212
  v_cmp_le_i32 vcc, 18, v7
  s_nop 1
  v_cndmask_b32 v237, 0, v5, vcc
  v_cmp_le_i32 vcc, 19, v7
  s_nop 1
  v_cndmask_b32 v212, 0, v6, vcc
  v_or_b32 v237, v237, v212
  v_cmp_le_i32 vcc, 24, v7
  s_nop 1
  v_cndmask_b32 v238, 0, v5, vcc
  v_cmp_le_i32 vcc, 25, v7
  s_nop 1
  v_cndmask_b32 v212, 0, v6, vcc
  v_or_b32 v238, v238, v212
  v_cmp_le_i32 vcc, 26, v7
  s_nop 1
  v_cndmask_b32 v239, 0, v5, vcc
  v_cmp_le_i32 vcc, 27, v7
  s_nop 1
  v_cndmask_b32 v212, 0, v6, vcc
  v_or_b32 v239, v239, v212
  v_lshrrev_b32 v212, 4, v0
  v_lshrrev_b32 v213, 2, v0
  v_xor_b32 v212, v212, v213
  v_and_b32 v212, 1, v212
  v_cmp_eq_u32 vcc, 0, v212
  v_mov_b32 v213, 0x3f803f80
  s_nop 0
  v_cndmask_b32 v240, 0, v213, vcc
  v_cndmask_b32 v241, 0, v213, vcc
  v_cndmask_b32 v242, 0, v213, vcc
  v_cndmask_b32 v243, 0, v213, vcc
  s_add_u32 s47, s46, 1
  s_and_b32 s47, s47, 3
  s_add_u32 s47, s47, 0
  s_lshl_b32 s37, s47, 7
  s_add_u32 s37, s37, s27
  s_mul_i32 s47, s47, 393216
  s_add_u32 m0, s28, 40960
  s_nop 0
  buffer_load_dwordx4 v16, s[8:11], s37 offen offset:0  lds
  buffer_load_dwordx4 v17, s[8:11], s37 offen offset:1024  lds
  buffer_load_dwordx4 v18, s[8:11], s37 offen offset:2048  lds
  buffer_load_dwordx4 v19, s[8:11], s37 offen offset:3072  lds
  s_add_u32 m0, s30, 40960
  s_nop 0
  buffer_load_dwordx4 v20, s[12:15], s47 offen offset:0  lds
  buffer_load_dwordx4 v21, s[12:15], s47 offen offset:1024  lds
  buffer_load_dwordx4 v22, s[12:15], s47 offen offset:2048  lds
  buffer_load_dwordx4 v23, s[12:15], s47 offen offset:3072  lds
  s_add_u32 m0, s30, 45056
  s_nop 0
  buffer_load_dwordx4 v24, s[12:15], s47 offen offset:0  lds
  buffer_load_dwordx4 v25, s[12:15], s47 offen offset:1024  lds
  s_waitcnt lgkmcnt(0)
  s_waitcnt vmcnt(10)
  s_barrier
  s_add_u32 s47, s46, 2
  s_and_b32 s47, s47, 3
  s_add_u32 s47, s47, 0
  s_lshl_b32 s37, s47, 7
  s_add_u32 s37, s37, s27
  s_mul_i32 s47, s47, 393216
  s_add_u32 m0, s28, 81920
  s_nop 0
  buffer_load_dwordx4 v16, s[8:11], s37 offen offset:0  lds
  buffer_load_dwordx4 v17, s[8:11], s37 offen offset:1024  lds
  buffer_load_dwordx4 v18, s[8:11], s37 offen offset:2048  lds
  buffer_load_dwordx4 v19, s[8:11], s37 offen offset:3072  lds
  s_add_u32 m0, s30, 81920
  s_nop 0
  buffer_load_dwordx4 v20, s[12:15], s47 offen offset:0  lds
  buffer_load_dwordx4 v21, s[12:15], s47 offen offset:1024  lds
  buffer_load_dwordx4 v22, s[12:15], s47 offen offset:2048  lds
  buffer_load_dwordx4 v23, s[12:15], s47 offen offset:3072  lds
  s_add_u32 m0, s30, 86016
  s_nop 0
  buffer_load_dwordx4 v24, s[12:15], s47 offen offset:0  lds
  buffer_load_dwordx4 v25, s[12:15], s47 offen offset:1024  lds
  s_waitcnt vmcnt(10)
  s_barrier
  s_add_u32 s47, s46, 3
  s_and_b32 s47, s47, 3
  s_add_u32 s47, s47, 0
  s_lshl_b32 s37, s47, 7
  s_add_u32 s37, s37, s27
  s_mul_i32 s47, s47, 393216
  s_add_u32 m0, s28, 0
  s_nop 0
  buffer_load_dwordx4 v16, s[8:11], s37 offen offset:0  lds
  buffer_load_dwordx4 v17, s[8:11], s37 offen offset:1024  lds
  buffer_load_dwordx4 v18, s[8:11], s37 offen offset:2048  lds
  buffer_load_dwordx4 v19, s[8:11], s37 offen offset:3072  lds
  s_add_u32 m0, s30, 0
  s_nop 0
  buffer_load_dwordx4 v20, s[12:15], s47 offen offset:0  lds
  buffer_load_dwordx4 v21, s[12:15], s47 offen offset:1024  lds
  buffer_load_dwordx4 v22, s[12:15], s47 offen offset:2048  lds
  buffer_load_dwordx4 v23, s[12:15], s47 offen offset:3072  lds
  s_add_u32 m0, s30, 4096
  s_nop 0
  buffer_load_dwordx4 v24, s[12:15], s47 offen offset:0  lds
  buffer_load_dwordx4 v25, s[12:15], s47 offen offset:1024  lds
  s_waitcnt vmcnt(10)
  s_barrier
  s_add_u32 s47, s46, 0
  s_and_b32 s47, s47, 3
  s_add_u32 s47, s47, 4
  s_lshl_b32 s37, s47, 7
  s_add_u32 s37, s37, s27
  s_mul_i32 s47, s47, 393216
  s_add_u32 m0, s28, 40960
  s_nop 0
  buffer_load_dwordx4 v16, s[8:11], s37 offen offset:0  lds
  buffer_load_dwordx4 v17, s[8:11], s37 offen offset:1024  lds
  buffer_load_dwordx4 v18, s[8:11], s37 offen offset:2048  lds
  buffer_load_dwordx4 v19, s[8:11], s37 offen offset:3072  lds
  s_add_u32 m0, s30, 40960
  s_nop 0
  buffer_load_dwordx4 v20, s[12:15], s47 offen offset:0  lds
  buffer_load_dwordx4 v21, s[12:15], s47 offen offset:1024  lds
  buffer_load_dwordx4 v22, s[12:15], s47 offen offset:2048  lds
  buffer_load_dwordx4 v23, s[12:15], s47 offen offset:3072  lds
  s_add_u32 m0, s30, 45056
  s_nop 0
  buffer_load_dwordx4 v24, s[12:15], s47 offen offset:0  lds
  buffer_load_dwordx4 v25, s[12:15], s47 offen offset:1024  lds
  s_waitcnt vmcnt(10)
  s_barrier
  s_add_u32 s47, s46, 1
  s_and_b32 s47, s47, 3
  s_add_u32 s47, s47, 4
  s_lshl_b32 s37, s47, 7
  s_add_u32 s37, s37, s27
  s_mul_i32 s47, s47, 393216
  s_add_u32 m0, s28, 81920
  s_nop 0
  buffer_load_dwordx4 v16, s[8:11], s37 offen offset:0  lds
  buffer_load_dwordx4 v17, s[8:11], s37 offen offset:1024  lds
  buffer_load_dwordx4 v18, s[8:11], s37 offen offset:2048  lds
  buffer_load_dwordx4 v19, s[8:11], s37 offen offset:3072  lds
  s_add_u32 m0, s30, 81920
  s_nop 0
  buffer_load_dwordx4 v20, s[12:15], s47 offen offset:0  lds
  buffer_load_dwordx4 v21, s[12:15], s47 offen offset:1024  lds
  buffer_load_dwordx4 v22, s[12:15], s47 offen offset:2048  lds
  buffer_load_dwordx4 v23, s[12:15], s47 offen offset:3072  lds
  s_add_u32 m0, s30, 86016
  s_nop 0
  buffer_load_dwordx4 v24, s[12:15], s47 offen offset:0  lds
  buffer_load_dwordx4 v25, s[12:15], s47 offen offset:1024  lds
  s_waitcnt vmcnt(10)
  s_barrier
  s_add_u32 s47, s46, 2
  s_and_b32 s47, s47, 3
  s_add_u32 s47, s47, 4
  s_lshl_b32 s37, s47, 7
  s_add_u32 s37, s37, s27
  s_mul_i32 s47, s47, 393216
  s_add_u32 m0, s28, 0
  s_nop 0
  buffer_load_dwordx4 v16, s[8:11], s37 offen offset:0  lds
  buffer_load_dwordx4 v17, s[8:11], s37 offen offset:1024  lds
  buffer_load_dwordx4 v18, s[8:11], s37 offen offset:2048  lds
  buffer_load_dwordx4 v19, s[8:11], s37 offen offset:3072  lds
  s_add_u32 m0, s30, 0
  s_nop 0
  buffer_load_dwordx4 v20, s[12:15], s47 offen offset:0  lds
  buffer_load_dwordx4 v21, s[12:15], s47 offen offset:1024  lds
  buffer_load_dwordx4 v22, s[12:15], s47 offen offset:2048  lds
  buffer_load_dwordx4 v23, s[12:15], s47 offen offset:3072  lds
  s_add_u32 m0, s30, 4096
  s_nop 0
  buffer_load_dwordx4 v24, s[12:15], s47 offen offset:0  lds
  buffer_load_dwordx4 v25, s[12:15], s47 offen offset:1024  lds
  s_waitcnt vmcnt(10)
  s_barrier
  s_add_u32 s47, s46, 3
  s_and_b32 s47, s47, 3
  s_add_u32 s47, s47, 4
  s_lshl_b32 s37, s47, 7
  s_add_u32 s37, s37, s27
  s_mul_i32 s47, s47, 393216
  s_add_u32 m0, s28, 40960
  s_nop 0
  buffer_load_dwordx4 v16, s[8:11], s37 offen offset:0  lds
  buffer_load_dwordx4 v17, s[8:11], s37 offen offset:1024  lds
  buffer_load_dwordx4 v18, s[8:11], s37 offen offset:2048  lds
  buffer_load_dwordx4 v19, s[8:11], s37 offen offset:3072  lds
  s_add_u32 m0, s30, 40960
  s_nop 0
  buffer_load_dwordx4 v20, s[12:15], s47 offen offset:0  lds
  buffer_load_dwordx4 v21, s[12:15], s47 offen offset:1024  lds
  buffer_load_dwordx4 v22, s[12:15], s47 offen offset:2048  lds
  buffer_load_dwordx4 v23, s[12:15], s47 offen offset:3072  lds
  s_add_u32 m0, s30, 45056
  s_nop 0
  buffer_load_dwordx4 v24, s[12:15], s47 offen offset:0  lds
  buffer_load_dwordx4 v25, s[12:15], s47 offen offset:1024  lds
  s_waitcnt vmcnt(10)
  s_barrier
  s_add_u32 s47, s46, 0
  s_and_b32 s47, s47, 3
  s_add_u32 s47, s47, 8
  s_lshl_b32 s37, s47, 7
  s_add_u32 s37, s37, s27
  s_mul_i32 s47, s47, 393216
  s_add_u32 m0, s28, 81920
  s_nop 0
  buffer_load_dwordx4 v16, s[8:11], s37 offen offset:0  lds
  buffer_load_dwordx4 v17, s[8:11], s37 offen offset:1024  lds
  buffer_load_dwordx4 v18, s[8:11], s37 offen offset:2048  lds
  buffer_load_dwordx4 v19, s[8:11], s37 offen offset:3072  lds
  s_add_u32 m0, s30, 81920
  s_nop 0
  buffer_load_dwordx4 v20, s[12:15], s47 offen offset:0  lds
  buffer_load_dwordx4 v21, s[12:15], s47 offen offset:1024  lds
  buffer_load_dwordx4 v22, s[12:15], s47 offen offset:2048  lds
  buffer_load_dwordx4 v23, s[12:15], s47 offen offset:3072  lds
  s_add_u32 m0, s30, 86016
  s_nop 0
  buffer_load_dwordx4 v24, s[12:15], s47 offen offset:0  lds
  buffer_load_dwordx4 v25, s[12:15], s47 offen offset:1024  lds
  s_waitcnt vmcnt(10)
  s_barrier
  s_add_u32 s47, s46, 1
  s_and_b32 s47, s47, 3
  s_add_u32 s47, s47, 8
  s_lshl_b32 s37, s47, 7
  s_add_u32 s37, s37, s27
  s_mul_i32 s47, s47, 393216
  s_add_u32 m0, s28, 0
  s_nop 0
  buffer_load_dwordx4 v16, s[8:11], s37 offen offset:0  lds
  buffer_load_dwordx4 v17, s[8:11], s37 offen offset:1024  lds
  buffer_load_dwordx4 v18, s[8:11], s37 offen offset:2048  lds
  buffer_load_dwordx4 v19, s[8:11], s37 offen offset:3072  lds
  s_add_u32 m0, s30, 0
  s_nop 0
  buffer_load_dwordx4 v20, s[12:15], s47 offen offset:0  lds
  buffer_load_dwordx4 v21, s[12:15], s47 offen offset:1024  lds
  buffer_load_dwordx4 v22, s[12:15], s47 offen offset:2048  lds
  buffer_load_dwordx4 v23, s[12:15], s47 offen offset:3072  lds
  s_add_u32 m0, s30, 4096
  s_nop 0
  buffer_load_dwordx4 v24, s[12:15], s47 offen offset:0  lds
  buffer_load_dwordx4 v25, s[12:15], s47 offen offset:1024  lds
  s_waitcnt vmcnt(10)
  s_barrier
  s_add_u32 s47, s46, 2
  s_and_b32 s47, s47, 3
  s_add_u32 s47, s47, 8
  s_lshl_b32 s37, s47, 7
  s_add_u32 s37, s37, s27
  s_mul_i32 s47, s47, 393216
  s_add_u32 m0, s28, 40960
  s_nop 0
  buffer_load_dwordx4 v16, s[8:11], s37 offen offset:0  lds
  buffer_load_dwordx4 v17, s[8:11], s37 offen offset:1024  lds
  buffer_load_dwordx4 v18, s[8:11], s37 offen offset:2048  lds
  buffer_load_dwordx4 v19, s[8:11], s37 offen offset:3072  lds
  s_add_u32 m0, s30, 40960
  s_nop 0
  buffer_load_dwordx4 v20, s[12:15], s47 offen offset:0  lds
  buffer_load_dwordx4 v21, s[12:15], s47 offen offset:1024  lds
  buffer_load_dwordx4 v22, s[12:15], s47 offen offset:2048  lds
  buffer_load_dwordx4 v23, s[12:15], s47 offen offset:3072  lds
  s_add_u32 m0, s30, 45056
  s_nop 0
  buffer_load_dwordx4 v24, s[12:15], s47 offen offset:0  lds
  buffer_load_dwordx4 v25, s[12:15], s47 offen offset:1024  lds
  s_waitcnt vmcnt(10)
  s_barrier
  s_add_u32 s47, s46, 3
  s_and_b32 s47, s47, 3
  s_add_u32 s47, s47, 8
  s_lshl_b32 s37, s47, 7
  s_add_u32 s37, s37, s27
  s_mul_i32 s47, s47, 393216
  s_add_u32 m0, s28, 81920
  s_nop 0
  buffer_load_dwordx4 v16, s[8:11], s37 offen offset:0  lds
  buffer_load_dwordx4 v17, s[8:11], s37 offen offset:1024  lds
  buffer_load_dwordx4 v18, s[8:11], s37 offen offset:2048  lds
  buffer_load_dwordx4 v19, s[8:11], s37 offen offset:3072  lds
  s_add_u32 m0, s30, 81920
  s_nop 0
  buffer_load_dwordx4 v20, s[12:15], s47 offen offset:0  lds
  buffer_load_dwordx4 v21, s[12:15], s47 offen offset:1024  lds
  buffer_load_dwordx4 v22, s[12:15], s47 offen offset:2048  lds
  buffer_load_dwordx4 v23, s[12:15], s47 offen offset:3072  lds
  s_add_u32 m0, s30, 86016
  s_nop 0
  buffer_load_dwordx4 v24, s[12:15], s47 offen offset:0  lds
  buffer_load_dwordx4 v25, s[12:15], s47 offen offset:1024  lds
  s_waitcnt vmcnt(10)
  s_barrier
  s_add_u32 s47, s46, 0
  s_and_b32 s47, s47, 3
  s_add_u32 s47, s47, 12
  s_lshl_b32 s37, s47, 7
  s_add_u32 s37, s37, s27
  s_mul_i32 s47, s47, 393216
  s_add_u32 m0, s28, 0
  s_nop 0
  buffer_load_dwordx4 v16, s[8:11], s37 offen offset:0  lds
  buffer_load_dwordx4 v17, s[8:11], s37 offen offset:1024  lds
  buffer_load_dwordx4 v18, s[8:11], s37 offen offset:2048  lds
  buffer_load_dwordx4 v19, s[8:11], s37 offen offset:3072  lds
  s_add_u32 m0, s30, 0
  s_nop 0
  buffer_load_dwordx4 v20, s[12:15], s47 offen offset:0  lds
  buffer_load_dwordx4 v21, s[12:15], s47 offen offset:1024  lds
  buffer_load_dwordx4 v22, s[12:15], s47 offen offset:2048  lds
  buffer_load_dwordx4 v23, s[12:15], s47 offen offset:3072  lds
  s_add_u32 m0, s30, 4096
  s_nop 0
  buffer_load_dwordx4 v24, s[12:15], s47 offen offset:0  lds
  buffer_load_dwordx4 v25, s[12:15], s47 offen offset:1024  lds
  s_getpc_b64 s[4:5]
ld_pc:
  s_sub_u32 s4, s4, (ld_pc - concat_heads__ssm_conv_h3__sliding_block__prompt_kernel)
  s_subb_u32 s5, s5, 0
  s_lshl2_add_u32 s6, s53, s26
  s_min_u32 s6, s6, ((mk_code_end - concat_heads__ssm_conv_h3__sliding_block__prompt_kernel - 512) >> 9)
  s_lshl_b32 s6, s6, 9
  v_lshl_add_u32 v12, v0, 3, s6
  global_load_dwordx2 v[246:247], v12, s[4:5]
  s_waitcnt vmcnt(11)
  s_barrier
  s_add_u32 s47, s46, 1
  s_and_b32 s47, s47, 3
  s_add_u32 s47, s47, 12
  s_lshl_b32 s37, s47, 7
  s_add_u32 s37, s37, s27
  s_mul_i32 s47, s47, 393216
  s_add_u32 m0, s28, 40960
  s_nop 0
  buffer_load_dwordx4 v16, s[8:11], s37 offen offset:0  lds
  buffer_load_dwordx4 v17, s[8:11], s37 offen offset:1024  lds
  buffer_load_dwordx4 v18, s[8:11], s37 offen offset:2048  lds
  buffer_load_dwordx4 v19, s[8:11], s37 offen offset:3072  lds
  s_add_u32 m0, s30, 40960
  s_nop 0
  buffer_load_dwordx4 v20, s[12:15], s47 offen offset:0  lds
  buffer_load_dwordx4 v21, s[12:15], s47 offen offset:1024  lds
  buffer_load_dwordx4 v22, s[12:15], s47 offen offset:2048  lds
  buffer_load_dwordx4 v23, s[12:15], s47 offen offset:3072  lds
  s_add_u32 m0, s30, 45056
  s_nop 0
  buffer_load_dwordx4 v24, s[12:15], s47 offen offset:0  lds
  buffer_load_dwordx4 v25, s[12:15], s47 offen offset:1024  lds
  s_waitcnt vmcnt(11)
  s_barrier
  s_add_u32 s47, s46, 2
  s_and_b32 s47, s47, 3
  s_add_u32 s47, s47, 12
  s_lshl_b32 s37, s47, 7
  s_add_u32 s37, s37, s27
  s_mul_i32 s47, s47, 393216
  s_add_u32 m0, s28, 81920
  s_nop 0
  buffer_load_dwordx4 v16, s[8:11], s37 offen offset:0  lds
  buffer_load_dwordx4 v17, s[8:11], s37 offen offset:1024  lds
  buffer_load_dwordx4 v18, s[8:11], s37 offen offset:2048  lds
  buffer_load_dwordx4 v19, s[8:11], s37 offen offset:3072  lds
  s_add_u32 m0, s30, 81920
  s_nop 0
  buffer_load_dwordx4 v20, s[12:15], s47 offen offset:0  lds
  buffer_load_dwordx4 v21, s[12:15], s47 offen offset:1024  lds
  buffer_load_dwordx4 v22, s[12:15], s47 offen offset:2048  lds
  buffer_load_dwordx4 v23, s[12:15], s47 offen offset:3072  lds
  s_add_u32 m0, s30, 86016
  s_nop 0
  buffer_load_dwordx4 v24, s[12:15], s47 offen offset:0  lds
  buffer_load_dwordx4 v25, s[12:15], s47 offen offset:1024  lds
  ds_read_b32 v13, v15 offset:256
  v_and_b32 v12, 31, v0
  s_lshl_b32 s31, s52, 7
  s_add_u32 s31, s31, 1024
  v_lshl_add_u32 v12, v12, 2, s31
  s_waitcnt lgkmcnt(0)
  s_mov_b32 s6, 131072
  s_branch poll17_chk
poll17:
  buffer_load_dword v13, v12, s[68:71], 0 offen sc1
  s_waitcnt vmcnt(0)
poll17_chk:
  v_cmp_eq_u32 vcc, 0, v13
  s_nop 1
  s_cmp_eq_u64 vcc, 0
  s_cbranch_scc1 poll17_ok
  s_sub_u32 s6, s6, 1
  s_cmp_eq_u32 s6, 0
  s_cbranch_scc1 poll17_ok
  s_sleep 1
  s_branch poll17
poll17_ok:
  v_readfirstlane_b32 s7, v13
  s_nop 1
  v_cmp_ne_u32 vcc, s7, v13
  s_nop 1
  s_cmp_eq_u64 vcc, 0
  s_cselect_b32 s49, 1, 2
  v_mov_b32 v12, s49
  v_mov_b32 v15, 122880
  ds_write_b32 v15, v12 offset:20
  s_waitcnt lgkmcnt(0)
  s_waitcnt vmcnt(10)
  s_barrier
  s_add_u32 s47, s46, 3
  s_and_b32 s47, s47, 3
  s_add_u32 s47, s47, 12
  s_lshl_b32 s37, s47, 7
  s_add_u32 s37, s37, s27
  s_mul_i32 s47, s47, 393216
  s_add_u32 m0, s28, 0
  s_nop 0
  buffer_load_dwordx4 v16, s[8:11], s37 offen offset:0  lds
  buffer_load_dwordx4 v17, s[8:11], s37 offen offset:1024  lds
  buffer_load_dwordx4 v18, s[8:11], s37 offen offset:2048  lds
  buffer_load_dwordx4 v19, s[8:11], s37 offen offset:3072  lds
  s_add_u32 m0, s30, 0
  s_nop 0
  buffer_load_dwordx4 v20, s[12:15], s47 offen offset:0  lds
  buffer_load_dwordx4 v21, s[12:15], s47 offen offset:1024  lds
  buffer_load_dwordx4 v22, s[12:15], s47 offen offset:2048  lds
  buffer_load_dwordx4 v23, s[12:15], s47 offen offset:3072  lds
  s_add_u32 m0, s30, 4096
  s_nop 0
  buffer_load_dwordx4 v24, s[12:15], s47 offen offset:0  lds
  buffer_load_dwordx4 v25, s[12:15], s47 offen offset:1024  lds
  s_add_u32 m0, s44, 256
  s_add_u32 s31, s43, 0
  buffer_load_dwordx4 v120, s[20:23], s31 offen lds
  s_add_u32 m0, s44, 1280
  s_add_u32 s31, s43, 65536
  buffer_load_dwordx4 v120, s[20:23], s31 offen lds
  s_add_u32 m0, s44, 2304
  s_add_u32 s31, s43, 131072
  buffer_load_dwordx4 v120, s[20:23], s31 offen lds
  s_add_u32 m0, s44, 3328
  s_add_u32 s31, s43, 196608
  buffer_load_dwordx4 v120, s[20:23], s31 offen lds
  s_add_u32 m0, s44, 4416
  s_nop 0
  buffer_load_dwordx4 v2, s[16:19], s45 offen offset:0 nt lds
  buffer_load_dwordx4 v2, s[16:19], s45 offen offset:1024 nt lds
  buffer_load_dwordx4 v2, s[16:19], s45 offen offset:2048 nt lds
  buffer_load_dwordx4 v2, s[16:19], s45 offen offset:3072 nt lds
  buffer_load_ushort v230, v230, s[64:67], 0 offen
  buffer_load_ushort v231, v231, s[16:19], 0 offen
  s_waitcnt vmcnt(20)
  s_barrier
  s_waitcnt vmcnt(10)
  s_barrier
  s_waitcnt vmcnt(6)
  v_mov_b32 v12, 122880
  v_mov_b32 v13, 1
  s_mov_b64 exec, 1
  ds_add_u32 v12, v13 offset:72
  s_mov_b64 exec, -1
  s_waitcnt vmcnt(0)
  v_mov_b32 v9, s44
  s_add_u32 s20, s98, 0x1400000
  s_addc_u32 s21, s99, 0
  s_mov_b32 s22, 0x400000
  s_mov_b32 s23, 0x00020000
  v_lshlrev_b32 v12, 16, v230
  v_lshlrev_b32 v13, 16, v231
  v_add_f32 v12, v12, v13
  v_cvt_pk_bf16_f32 v12, v12, v12
  ds_write_b16 v9, v12 offset:4416
  s_and_b32 s31, s3, 3
  s_lshl_b32 s31, s31, 1
  s_add_u32 s31, s31, 114688
  ds_read_b64_tr_b16 v[68:69], v228 offset:1696
  ds_read_b64_tr_b16 v[70:71], v228 offset:1664
  ds_read_b64_tr_b16 v[148:149], v229 offset:256
  ds_read_b64_tr_b16 v[150:151], v229 offset:288
  ds_read_b64_tr_b16 v[60:61], v228 offset:1440
  ds_read_b64_tr_b16 v[62:63], v228 offset:1408
  ds_read_b64_tr_b16 v[152:153], v229 offset:512
  ds_read_b64_tr_b16 v[154:155], v229 offset:544
  ds_read_b64_tr_b16 v[52:53], v228 offset:1184
  ds_read_b64_tr_b16 v[54:55], v228 offset:1152
  ds_read_b64_tr_b16 v[156:157], v229 offset:768
  ds_read_b64_tr_b16 v[158:159], v229 offset:800
  v_lshl_add_u32 v9, v0, 3, s31
  v_mov_b32 v14, 0
  s_mov_b32 s40, 0
  s_mov_b32 s41, 0x80000000
  s_waitcnt lgkmcnt(8)
  v_mfma_f32_16x16x32_bf16 v[208:211], v[68:71], v[148:151], 0
  ds_read_b64_tr_b16 v[44:45], v228 offset:928
  ds_read_b64_tr_b16 v[46:47], v228 offset:896
  ds_read_b64_tr_b16 v[160:161], v229 offset:1024
  ds_read_b64_tr_b16 v[162:163], v229 offset:1056
  s_waitcnt lgkmcnt(8)
  v_mfma_f32_16x16x32_bf16 v[208:211], v[60:63], v[152:155], v[208:211]
  ds_read_b64_tr_b16 v[36:37], v228 offset:672
  ds_read_b64_tr_b16 v[38:39], v228 offset:640
  ds_read_b64_tr_b16 v[164:165], v229 offset:1280
  ds_read_b64_tr_b16 v[166:167], v229 offset:1312
  s_waitcnt lgkmcnt(8)
  v_mfma_f32_16x16x32_bf16 v[208:211], v[52:55], v[156:159], v[208:211]
  ds_read_b64_tr_b16 v[28:29], v228 offset:416
  ds_read_b64_tr_b16 v[30:31], v228 offset:384
  ds_read_b64_tr_b16 v[168:169], v229 offset:1536
  ds_read_b64_tr_b16 v[170:171], v229 offset:1568
  s_waitcnt lgkmcnt(8)
  v_mfma_f32_16x16x32_bf16 v[208:211], v[44:47], v[160:163], v[208:211]
  ds_read_b64_tr_b16 v[20:21], v228 offset:160
  ds_read_b64_tr_b16 v[22:23], v228 offset:128
  ds_read_b64_tr_b16 v[172:173], v229 offset:1792
  ds_read_b64_tr_b16 v[174:175], v229 offset:1824
  s_waitcnt lgkmcnt(8)
  v_mfma_f32_16x16x32_bf16 v[208:211], v[36:39], v[164:167], v[208:211]
  ds_read_b64_tr_b16 v[76:77], v228 offset:1952
  ds_read_b64_tr_b16 v[78:79], v228 offset:1920
  ds_read_b64_tr_b16 v[144:145], v229 offset:0
  ds_read_b64_tr_b16 v[146:147], v229 offset:32
  s_waitcnt lgkmcnt(8)
  v_mfma_f32_16x16x32_bf16 v[208:211], v[28:31], v[168:171], v[208:211]
  ds_read_b64_tr_b16 v[72:73], v228 offset:1824
  ds_read_b64_tr_b16 v[74:75], v228 offset:1792
  ds_read_b64_tr_b16 v[64:65], v228 offset:1568
  ds_read_b64_tr_b16 v[66:67], v228 offset:1536
  s_waitcnt lgkmcnt(8)
  v_mfma_f32_16x16x32_bf16 v[208:211], v[20:23], v[172:175], v[208:211]
  ds_read_b64_tr_b16 v[56:57], v228 offset:1312
  ds_read_b64_tr_b16 v[58:59], v228 offset:1280
  ds_read_b64_tr_b16 v[48:49], v228 offset:1056
  ds_read_b64_tr_b16 v[50:51], v228 offset:1024
  s_waitcnt lgkmcnt(8)
  v_mfma_f32_16x16x32_bf16 v[208:211], v[76:79], v[144:147], v[208:211]
  ds_read_b64_tr_b16 v[40:41], v228 offset:800
  ds_read_b64_tr_b16 v[42:43], v228 offset:768
  ds_read_b64_tr_b16 v[32:33], v228 offset:544
  ds_read_b64_tr_b16 v[34:35], v228 offset:512
  s_waitcnt lgkmcnt(10)
  v_mfma_f32_16x16x32_bf16 v[212:215], v[72:75], v[148:151], 0
  ds_read_b64_tr_b16 v[24:25], v228 offset:288
  ds_read_b64_tr_b16 v[26:27], v228 offset:256
  ds_read_b64_tr_b16 v[16:17], v228 offset:32
  ds_read_b64_tr_b16 v[18:19], v228 offset:0
  v_add_f32_dpp v210, v211, v210 wave_ror:1 row_mask:0xf bank_mask:0xf
  s_waitcnt lgkmcnt(12)
  v_mfma_f32_16x16x32_bf16 v[212:215], v[64:67], v[152:155], v[212:215]
  ds_read_b64_tr_b16 v[176:177], v229 offset:2048
  ds_read_b64_tr_b16 v[178:179], v229 offset:2080
  v_add_f32_dpp v209, v210, v209 wave_ror:1 row_mask:0xf bank_mask:0xf
  s_waitcnt lgkmcnt(12)
  v_mfma_f32_16x16x32_bf16 v[212:215], v[56:59], v[156:159], v[212:215]
  ds_read_b64_tr_b16 v[80:81], v228 offset:2080
  ds_read_b64_tr_b16 v[82:83], v228 offset:2048
  s_waitcnt lgkmcnt(12)
  v_mfma_f32_16x16x32_bf16 v[212:215], v[48:51], v[160:163], v[212:215]
  ds_read_b64_tr_b16 v[84:85], v228 offset:2208
  ds_read_b64_tr_b16 v[86:87], v228 offset:2176
  s_waitcnt lgkmcnt(12)
  v_mfma_f32_16x16x32_bf16 v[212:215], v[40:43], v[164:167], v[212:215]
  ds_read_b64_tr_b16 v[180:181], v229 offset:2304
  ds_read_b64_tr_b16 v[182:183], v229 offset:2336
  s_waitcnt lgkmcnt(12)
  v_mfma_f32_16x16x32_bf16 v[212:215], v[32:35], v[168:171], v[212:215]
  ds_read_b64_tr_b16 v[88:89], v228 offset:2336
  ds_read_b64_tr_b16 v[90:91], v228 offset:2304
  s_waitcnt lgkmcnt(12)
  v_mfma_f32_16x16x32_bf16 v[212:215], v[24:27], v[172:175], v[212:215]
  ds_read_b64_tr_b16 v[92:93], v228 offset:2464
  ds_read_b64_tr_b16 v[94:95], v228 offset:2432
  s_waitcnt lgkmcnt(10)
  v_mfma_f32_16x16x32_bf16 v[212:215], v[16:19], v[176:179], v[212:215]
  ds_read_b64_tr_b16 v[184:185], v229 offset:2560
  ds_read_b64_tr_b16 v[186:187], v229 offset:2592
  ds_read_b64_tr_b16 v[96:97], v228 offset:2592
  ds_read_b64_tr_b16 v[98:99], v228 offset:2560
  s_waitcnt lgkmcnt(12)
  v_mfma_f32_16x16x32_bf16 v[212:215], v[80:83], v[144:147], v[212:215]
  ds_read_b64_tr_b16 v[100:101], v228 offset:2720
  ds_read_b64_tr_b16 v[102:103], v228 offset:2688
  v_mfma_f32_16x16x32_bf16 v[216:219], v[76:79], v[148:151], 0
  v_mfma_f32_16x16x32_bf16 v[216:219], v[68:71], v[152:155], v[216:219]
  v_mfma_f32_16x16x32_bf16 v[216:219], v[60:63], v[156:159], v[216:219]
  v_mfma_f32_16x16x32_bf16 v[216:219], v[52:55], v[160:163], v[216:219]
  v_mfma_f32_16x16x32_bf16 v[216:219], v[44:47], v[164:167], v[216:219]
  v_mfma_f32_16x16x32_bf16 v[216:219], v[36:39], v[168:171], v[216:219]
  v_cndmask_b32 v6, v215, v211, s[40:41]
  v_mfma_f32_16x16x32_bf16 v[216:219], v[28:31], v[172:175], v[216:219]
  v_mfma_f32_16x16x32_bf16 v[216:219], v[20:23], v[176:179], v[216:219]
  v_add_f32_dpp v214, v6, v214 wave_ror:1 row_mask:0xf bank_mask:0xf
  s_waitcnt lgkmcnt(12)
  v_mfma_f32_16x16x32_bf16 v[216:219], v[84:87], v[144:147], v[216:219]
  ds_read_b64_tr_b16 v[188:189], v229 offset:2816
  ds_read_b64_tr_b16 v[190:191], v229 offset:2848
  v_cndmask_b32 v6, v214, v210, s[40:41]
  v_mfma_f32_16x16x32_bf16 v[220:223], v[80:83], v[148:151], 0
  v_mfma_f32_16x16x32_bf16 v[220:223], v[72:75], v[152:155], v[220:223]
  v_add_f32_dpp v213, v6, v213 wave_ror:1 row_mask:0xf bank_mask:0xf
  v_cndmask_b32 v6, v213, v209, s[40:41]
  v_mfma_f32_16x16x32_bf16 v[220:223], v[64:67], v[156:159], v[220:223]
  v_cndmask_b32 v8, v219, v215, s[40:41]
  v_add_f32_dpp v212, v6, v212 wave_ror:1 row_mask:0xf bank_mask:0xf
  v_mfma_f32_16x16x32_bf16 v[220:223], v[56:59], v[160:163], v[220:223]
  v_add_f32_dpp v218, v8, v218 wave_ror:1 row_mask:0xf bank_mask:0xf
  v_mfma_f32_16x16x32_bf16 v[220:223], v[48:51], v[164:167], v[220:223]
  v_cndmask_b32 v8, v218, v214, s[40:41]
  v_mfma_f32_16x16x32_bf16 v[220:223], v[40:43], v[168:171], v[220:223]
  v_mfma_f32_16x16x32_bf16 v[220:223], v[32:35], v[172:175], v[220:223]
  v_add_f32_dpp v217, v8, v217 wave_ror:1 row_mask:0xf bank_mask:0xf
  v_mfma_f32_16x16x32_bf16 v[220:223], v[24:27], v[176:179], v[220:223]
  v_cndmask_b32 v8, v217, v213, s[40:41]
  s_waitcnt lgkmcnt(12)
  v_mfma_f32_16x16x32_bf16 v[220:223], v[16:19], v[180:183], v[220:223]
  ds_read_b64_tr_b16 v[104:105], v228 offset:2848
  ds_read_b64_tr_b16 v[106:107], v228 offset:2816
  v_add_f32_dpp v216, v8, v216 wave_ror:1 row_mask:0xf bank_mask:0xf
  s_waitcnt lgkmcnt(12)
  v_mfma_f32_16x16x32_bf16 v[220:223], v[88:91], v[144:147], v[220:223]
  ds_read_b64_tr_b16 v[108:109], v228 offset:2976
  ds_read_b64_tr_b16 v[110:111], v228 offset:2944
  v_cvt_pk_bf16_f32 v15, v212, v216
  ds_write_b16 v9, v15 offset:0
  s_waitcnt lgkmcnt(10)
  ds_write_b16_d16_hi v9, v15 offset:512
  v_mfma_f32_16x16x32_bf16 v[224:227], v[84:87], v[148:151], 0
  ds_read_b64_tr_b16 v[192:193], v229 offset:3072
  ds_read_b64_tr_b16 v[194:195], v229 offset:3104
  v_cndmask_b32 v5, v223, v219, s[40:41]
  v_mfma_f32_16x16x32_bf16 v[224:227], v[76:79], v[152:155], v[224:227]
  v_mfma_f32_16x16x32_bf16 v[224:227], v[68:71], v[156:159], v[224:227]
  v_add_f32_dpp v222, v5, v222 wave_ror:1 row_mask:0xf bank_mask:0xf
  v_mfma_f32_16x16x32_bf16 v[224:227], v[60:63], v[160:163], v[224:227]
  v_cndmask_b32 v5, v222, v218, s[40:41]
  v_mfma_f32_16x16x32_bf16 v[224:227], v[52:55], v[164:167], v[224:227]
  s_setprio 2
  v_add_f32_dpp v221, v5, v221 wave_ror:1 row_mask:0xf bank_mask:0xf
  v_mfma_f32_16x16x32_bf16 v[224:227], v[44:47], v[168:171], v[224:227]
  v_cndmask_b32 v5, v221, v217, s[40:41]
  v_mfma_f32_16x16x32_bf16 v[224:227], v[36:39], v[172:175], v[224:227]
  v_mfma_f32_16x16x32_bf16 v[224:227], v[28:31], v[176:179], v[224:227]
  v_add_f32_dpp v220, v5, v220 wave_ror:1 row_mask:0xf bank_mask:0xf
  v_mfma_f32_16x16x32_bf16 v[224:227], v[20:23], v[180:183], v[224:227]
  v_mfma_f32_16x16x32_bf16 v[224:227], v[92:95], v[144:147], v[224:227]
  v_mfma_f32_16x16x32_bf16 v[208:211], v[88:91], v[148:151], 0
  v_mfma_f32_16x16x32_bf16 v[208:211], v[80:83], v[152:155], v[208:211]
  v_mfma_f32_16x16x32_bf16 v[208:211], v[72:75], v[156:159], v[208:211]
  v_mfma_f32_16x16x32_bf16 v[208:211], v[64:67], v[160:163], v[208:211]
  v_mfma_f32_16x16x32_bf16 v[208:211], v[56:59], v[164:167], v[208:211]
  v_mfma_f32_16x16x32_bf16 v[208:211], v[48:51], v[168:171], v[208:211]
  v_mfma_f32_16x16x32_bf16 v[208:211], v[40:43], v[172:175], v[208:211]
  v_mfma_f32_16x16x32_bf16 v[208:211], v[32:35], v[176:179], v[208:211]
  v_cndmask_b32 v6, v227, v223, s[40:41]
  v_mfma_f32_16x16x32_bf16 v[208:211], v[24:27], v[180:183], v[208:211]
  v_mfma_f32_16x16x32_bf16 v[208:211], v[16:19], v[184:187], v[208:211]
  v_add_f32_dpp v226, v6, v226 wave_ror:1 row_mask:0xf bank_mask:0xf
  s_waitcnt lgkmcnt(12)
  v_mfma_f32_16x16x32_bf16 v[208:211], v[96:99], v[144:147], v[208:211]
  ds_read_b64_tr_b16 v[112:113], v228 offset:3104
  ds_read_b64_tr_b16 v[114:115], v228 offset:3072
  v_cndmask_b32 v6, v226, v222, s[40:41]
  v_mfma_f32_16x16x32_bf16 v[212:215], v[92:95], v[148:151], 0
  v_mfma_f32_16x16x32_bf16 v[212:215], v[84:87], v[152:155], v[212:215]
  v_add_f32_dpp v225, v6, v225 wave_ror:1 row_mask:0xf bank_mask:0xf
  v_cndmask_b32 v6, v225, v221, s[40:41]
  v_mfma_f32_16x16x32_bf16 v[212:215], v[76:79], v[156:159], v[212:215]
  v_cndmask_b32 v8, v211, v227, s[40:41]
  v_add_f32_dpp v224, v6, v224 wave_ror:1 row_mask:0xf bank_mask:0xf
  v_mfma_f32_16x16x32_bf16 v[212:215], v[68:71], v[160:163], v[212:215]
  v_cvt_pk_bf16_f32 v15, v220, v224
  ds_write_b16 v9, v15 offset:1024
  s_waitcnt lgkmcnt(10)
  ds_write_b16_d16_hi v9, v15 offset:1536
  v_mfma_f32_16x16x32_bf16 v[212:215], v[60:63], v[164:167], v[212:215]
  ds_read_b64_tr_b16 v[116:117], v228 offset:3232
  ds_read_b64_tr_b16 v[118:119], v228 offset:3200
  v_add_f32_dpp v210, v8, v210 wave_ror:1 row_mask:0xf bank_mask:0xf
  v_mfma_f32_16x16x32_bf16 v[212:215], v[52:55], v[168:171], v[212:215]
  v_cndmask_b32 v8, v210, v226, s[40:41]
  v_mfma_f32_16x16x32_bf16 v[212:215], v[44:47], v[172:175], v[212:215]
  v_mfma_f32_16x16x32_bf16 v[212:215], v[36:39], v[176:179], v[212:215]
  v_add_f32_dpp v209, v8, v209 wave_ror:1 row_mask:0xf bank_mask:0xf
  v_mfma_f32_16x16x32_bf16 v[212:215], v[28:31], v[180:183], v[212:215]
  v_cndmask_b32 v8, v209, v225, s[40:41]
  v_mfma_f32_16x16x32_bf16 v[212:215], v[20:23], v[184:187], v[212:215]
  v_mfma_f32_16x16x32_bf16 v[212:215], v[100:103], v[144:147], v[212:215]
  v_add_f32_dpp v208, v8, v208 wave_ror:1 row_mask:0xf bank_mask:0xf
  v_mfma_f32_16x16x32_bf16 v[216:219], v[96:99], v[148:151], 0
  v_mfma_f32_16x16x32_bf16 v[216:219], v[88:91], v[152:155], v[216:219]
  v_mfma_f32_16x16x32_bf16 v[216:219], v[80:83], v[156:159], v[216:219]
  v_mfma_f32_16x16x32_bf16 v[216:219], v[72:75], v[160:163], v[216:219]
  v_mfma_f32_16x16x32_bf16 v[216:219], v[64:67], v[164:167], v[216:219]
  v_mfma_f32_16x16x32_bf16 v[216:219], v[56:59], v[168:171], v[216:219]
  v_mfma_f32_16x16x32_bf16 v[216:219], v[48:51], v[172:175], v[216:219]
  v_cndmask_b32 v5, v215, v211, s[40:41]
  v_mfma_f32_16x16x32_bf16 v[216:219], v[40:43], v[176:179], v[216:219]
  v_mfma_f32_16x16x32_bf16 v[216:219], v[32:35], v[180:183], v[216:219]
  v_add_f32_dpp v214, v5, v214 wave_ror:1 row_mask:0xf bank_mask:0xf
  v_mfma_f32_16x16x32_bf16 v[216:219], v[24:27], v[184:187], v[216:219]
  v_cndmask_b32 v5, v214, v210, s[40:41]
  v_mfma_f32_16x16x32_bf16 v[216:219], v[16:19], v[188:191], v[216:219]
  s_waitcnt lgkmcnt(12)
  v_mfma_f32_16x16x32_bf16 v[216:219], v[104:107], v[144:147], v[216:219]
  ds_read_b64_tr_b16 v[196:197], v229 offset:3328
  ds_read_b64_tr_b16 v[198:199], v229 offset:3360
  v_add_f32_dpp v213, v5, v213 wave_ror:1 row_mask:0xf bank_mask:0xf
  v_cndmask_b32 v5, v213, v209, s[40:41]
  v_mfma_f32_16x16x32_bf16 v[220:223], v[100:103], v[148:151], 0
  v_mfma_f32_16x16x32_bf16 v[220:223], v[92:95], v[152:155], v[220:223]
  v_add_f32_dpp v212, v5, v212 wave_ror:1 row_mask:0xf bank_mask:0xf
  v_cvt_pk_bf16_f32 v15, v208, v212
  ds_write_b16 v9, v15 offset:2048
  s_waitcnt lgkmcnt(10)
  ds_write_b16_d16_hi v9, v15 offset:2560
  v_mfma_f32_16x16x32_bf16 v[220:223], v[84:87], v[156:159], v[220:223]
  ds_read_b64_tr_b16 v[120:121], v228 offset:3360
  ds_read_b64_tr_b16 v[122:123], v228 offset:3328
  v_cndmask_b32 v6, v219, v215, s[40:41]
  v_mfma_f32_16x16x32_bf16 v[220:223], v[76:79], v[160:163], v[220:223]
  v_mfma_f32_16x16x32_bf16 v[220:223], v[68:71], v[164:167], v[220:223]
  v_add_f32_dpp v218, v6, v218 wave_ror:1 row_mask:0xf bank_mask:0xf
  v_mfma_f32_16x16x32_bf16 v[220:223], v[60:63], v[168:171], v[220:223]
  v_cndmask_b32 v6, v218, v214, s[40:41]
  v_mfma_f32_16x16x32_bf16 v[220:223], v[52:55], v[172:175], v[220:223]
  v_mfma_f32_16x16x32_bf16 v[220:223], v[44:47], v[176:179], v[220:223]
  v_add_f32_dpp v217, v6, v217 wave_ror:1 row_mask:0xf bank_mask:0xf
  v_mfma_f32_16x16x32_bf16 v[220:223], v[36:39], v[180:183], v[220:223]
  v_cndmask_b32 v6, v217, v213, s[40:41]
  v_mfma_f32_16x16x32_bf16 v[220:223], v[28:31], v[184:187], v[220:223]
  v_mfma_f32_16x16x32_bf16 v[220:223], v[20:23], v[188:191], v[220:223]
  v_add_f32_dpp v216, v6, v216 wave_ror:1 row_mask:0xf bank_mask:0xf
  v_mfma_f32_16x16x32_bf16 v[220:223], v[108:111], v[144:147], v[220:223]
  v_mfma_f32_16x16x32_bf16 v[224:227], v[104:107], v[148:151], 0
  v_mfma_f32_16x16x32_bf16 v[224:227], v[96:99], v[152:155], v[224:227]
  v_mfma_f32_16x16x32_bf16 v[224:227], v[88:91], v[156:159], v[224:227]
  v_mfma_f32_16x16x32_bf16 v[224:227], v[80:83], v[160:163], v[224:227]
  v_mfma_f32_16x16x32_bf16 v[224:227], v[72:75], v[164:167], v[224:227]
  v_mfma_f32_16x16x32_bf16 v[224:227], v[64:67], v[168:171], v[224:227]
  v_mfma_f32_16x16x32_bf16 v[224:227], v[56:59], v[172:175], v[224:227]
  v_mfma_f32_16x16x32_bf16 v[224:227], v[48:51], v[176:179], v[224:227]
  v_cndmask_b32 v8, v223, v219, s[40:41]
  v_mfma_f32_16x16x32_bf16 v[224:227], v[40:43], v[180:183], v[224:227]
  v_mfma_f32_16x16x32_bf16 v[224:227], v[32:35], v[184:187], v[224:227]
  v_add_f32_dpp v222, v8, v222 wave_ror:1 row_mask:0xf bank_mask:0xf
  v_mfma_f32_16x16x32_bf16 v[224:227], v[24:27], v[188:191], v[224:227]
  v_cndmask_b32 v8, v222, v218, s[40:41]
  s_waitcnt lgkmcnt(12)
  v_mfma_f32_16x16x32_bf16 v[224:227], v[16:19], v[192:195], v[224:227]
  ds_read_b64_tr_b16 v[124:125], v228 offset:3488
  ds_read_b64_tr_b16 v[126:127], v228 offset:3456
  v_add_f32_dpp v221, v8, v221 wave_ror:1 row_mask:0xf bank_mask:0xf
  s_waitcnt lgkmcnt(12)
  v_mfma_f32_16x16x32_bf16 v[224:227], v[112:115], v[144:147], v[224:227]
  ds_read_b64_tr_b16 v[200:201], v229 offset:3584
  ds_read_b64_tr_b16 v[202:203], v229 offset:3616
  v_cndmask_b32 v8, v221, v217, s[40:41]
  v_mfma_f32_16x16x32_bf16 v[208:211], v[108:111], v[148:151], 0
  v_mfma_f32_16x16x32_bf16 v[208:211], v[100:103], v[152:155], v[208:211]
  v_add_f32_dpp v220, v8, v220 wave_ror:1 row_mask:0xf bank_mask:0xf
  v_cvt_pk_bf16_f32 v15, v216, v220
  ds_write_b16 v9, v15 offset:3072
  s_waitcnt lgkmcnt(10)
  ds_write_b16_d16_hi v9, v15 offset:3584
  v_mfma_f32_16x16x32_bf16 v[208:211], v[92:95], v[156:159], v[208:211]
  ds_read_b64_tr_b16 v[128:129], v228 offset:3616
  ds_read_b64_tr_b16 v[130:131], v228 offset:3584
  v_cndmask_b32 v5, v227, v223, s[40:41]
  v_mfma_f32_16x16x32_bf16 v[208:211], v[84:87], v[160:163], v[208:211]
  v_mfma_f32_16x16x32_bf16 v[208:211], v[76:79], v[164:167], v[208:211]
  v_add_f32_dpp v226, v5, v226 wave_ror:1 row_mask:0xf bank_mask:0xf
  v_mfma_f32_16x16x32_bf16 v[208:211], v[68:71], v[168:171], v[208:211]
  v_cndmask_b32 v5, v226, v222, s[40:41]
  v_mfma_f32_16x16x32_bf16 v[208:211], v[60:63], v[172:175], v[208:211]
  v_mfma_f32_16x16x32_bf16 v[208:211], v[52:55], v[176:179], v[208:211]
  v_add_f32_dpp v225, v5, v225 wave_ror:1 row_mask:0xf bank_mask:0xf
  v_mfma_f32_16x16x32_bf16 v[208:211], v[44:47], v[180:183], v[208:211]
  v_cndmask_b32 v5, v225, v221, s[40:41]
  v_mfma_f32_16x16x32_bf16 v[208:211], v[36:39], v[184:187], v[208:211]
  v_mfma_f32_16x16x32_bf16 v[208:211], v[28:31], v[188:191], v[208:211]
  v_add_f32_dpp v224, v5, v224 wave_ror:1 row_mask:0xf bank_mask:0xf
  v_mfma_f32_16x16x32_bf16 v[208:211], v[20:23], v[192:195], v[208:211]
  v_mfma_f32_16x16x32_bf16 v[208:211], v[116:119], v[144:147], v[208:211]
  v_mfma_f32_16x16x32_bf16 v[212:215], v[112:115], v[148:151], 0
  v_mfma_f32_16x16x32_bf16 v[212:215], v[104:107], v[152:155], v[212:215]
  v_mfma_f32_16x16x32_bf16 v[212:215], v[96:99], v[156:159], v[212:215]
  v_mfma_f32_16x16x32_bf16 v[212:215], v[88:91], v[160:163], v[212:215]
  v_mfma_f32_16x16x32_bf16 v[212:215], v[80:83], v[164:167], v[212:215]
  v_mfma_f32_16x16x32_bf16 v[212:215], v[72:75], v[168:171], v[212:215]
  v_mfma_f32_16x16x32_bf16 v[212:215], v[64:67], v[172:175], v[212:215]
  v_mfma_f32_16x16x32_bf16 v[212:215], v[56:59], v[176:179], v[212:215]
  v_cndmask_b32 v6, v211, v227, s[40:41]
  v_mfma_f32_16x16x32_bf16 v[212:215], v[48:51], v[180:183], v[212:215]
  v_mfma_f32_16x16x32_bf16 v[212:215], v[40:43], v[184:187], v[212:215]
  v_add_f32_dpp v210, v6, v210 wave_ror:1 row_mask:0xf bank_mask:0xf
  v_mfma_f32_16x16x32_bf16 v[212:215], v[32:35], v[188:191], v[212:215]
  v_cndmask_b32 v6, v210, v226, s[40:41]
  v_mfma_f32_16x16x32_bf16 v[212:215], v[24:27], v[192:195], v[212:215]
  s_waitcnt lgkmcnt(12)
  v_mfma_f32_16x16x32_bf16 v[212:215], v[16:19], v[196:199], v[212:215]
  ds_read_b64_tr_b16 v[132:133], v228 offset:3744
  ds_read_b64_tr_b16 v[134:135], v228 offset:3712
  v_add_f32_dpp v209, v6, v209 wave_ror:1 row_mask:0xf bank_mask:0xf
  s_waitcnt lgkmcnt(10)
  v_mfma_f32_16x16x32_bf16 v[212:215], v[120:123], v[144:147], v[212:215]
  ds_read_b64_tr_b16 v[204:205], v229 offset:3840
  ds_read_b64_tr_b16 v[206:207], v229 offset:3872
  ds_read_b64_tr_b16 v[136:137], v228 offset:3872
  ds_read_b64_tr_b16 v[138:139], v228 offset:3840
  v_cndmask_b32 v6, v209, v225, s[40:41]
  v_mfma_f32_16x16x32_bf16 v[216:219], v[116:119], v[148:151], 0
  v_mfma_f32_16x16x32_bf16 v[216:219], v[108:111], v[152:155], v[216:219]
  v_add_f32_dpp v208, v6, v208 wave_ror:1 row_mask:0xf bank_mask:0xf
  v_cvt_pk_bf16_f32 v15, v224, v208
  ds_write_b16 v9, v15 offset:4096
  s_waitcnt lgkmcnt(10)
  ds_write_b16_d16_hi v9, v15 offset:4608
  v_mfma_f32_16x16x32_bf16 v[216:219], v[100:103], v[156:159], v[216:219]
  ds_read_b64_tr_b16 v[140:141], v228 offset:4000
  ds_read_b64_tr_b16 v[142:143], v228 offset:3968
  v_cndmask_b32 v8, v215, v211, s[40:41]
  v_mfma_f32_16x16x32_bf16 v[216:219], v[92:95], v[160:163], v[216:219]
  v_mfma_f32_16x16x32_bf16 v[216:219], v[84:87], v[164:167], v[216:219]
  v_add_f32_dpp v214, v8, v214 wave_ror:1 row_mask:0xf bank_mask:0xf
  v_mfma_f32_16x16x32_bf16 v[216:219], v[76:79], v[168:171], v[216:219]
  v_cndmask_b32 v8, v214, v210, s[40:41]
  v_mfma_f32_16x16x32_bf16 v[216:219], v[68:71], v[172:175], v[216:219]
  v_mfma_f32_16x16x32_bf16 v[216:219], v[60:63], v[176:179], v[216:219]
  v_add_f32_dpp v213, v8, v213 wave_ror:1 row_mask:0xf bank_mask:0xf
  v_mfma_f32_16x16x32_bf16 v[216:219], v[52:55], v[180:183], v[216:219]
  v_cndmask_b32 v8, v213, v209, s[40:41]
  v_mfma_f32_16x16x32_bf16 v[216:219], v[44:47], v[184:187], v[216:219]
  v_mfma_f32_16x16x32_bf16 v[216:219], v[36:39], v[188:191], v[216:219]
  v_add_f32_dpp v212, v8, v212 wave_ror:1 row_mask:0xf bank_mask:0xf
  v_mfma_f32_16x16x32_bf16 v[216:219], v[28:31], v[192:195], v[216:219]
  v_mfma_f32_16x16x32_bf16 v[216:219], v[20:23], v[196:199], v[216:219]
  v_mfma_f32_16x16x32_bf16 v[216:219], v[124:127], v[144:147], v[216:219]
  v_mfma_f32_16x16x32_bf16 v[220:223], v[120:123], v[148:151], 0
  v_mfma_f32_16x16x32_bf16 v[220:223], v[112:115], v[152:155], v[220:223]
  v_mfma_f32_16x16x32_bf16 v[220:223], v[104:107], v[156:159], v[220:223]
  v_mfma_f32_16x16x32_bf16 v[220:223], v[96:99], v[160:163], v[220:223]
  v_mfma_f32_16x16x32_bf16 v[220:223], v[88:91], v[164:167], v[220:223]
  v_mfma_f32_16x16x32_bf16 v[220:223], v[80:83], v[168:171], v[220:223]
  v_mfma_f32_16x16x32_bf16 v[220:223], v[72:75], v[172:175], v[220:223]
  v_mfma_f32_16x16x32_bf16 v[220:223], v[64:67], v[176:179], v[220:223]
  v_cndmask_b32 v5, v219, v215, s[40:41]
  v_mfma_f32_16x16x32_bf16 v[220:223], v[56:59], v[180:183], v[220:223]
  v_mfma_f32_16x16x32_bf16 v[220:223], v[48:51], v[184:187], v[220:223]
  v_add_f32_dpp v218, v5, v218 wave_ror:1 row_mask:0xf bank_mask:0xf
  v_mfma_f32_16x16x32_bf16 v[220:223], v[40:43], v[188:191], v[220:223]
  v_cndmask_b32 v5, v218, v214, s[40:41]
  v_mfma_f32_16x16x32_bf16 v[220:223], v[32:35], v[192:195], v[220:223]
  v_mfma_f32_16x16x32_bf16 v[220:223], v[24:27], v[196:199], v[220:223]
  v_add_f32_dpp v217, v5, v217 wave_ror:1 row_mask:0xf bank_mask:0xf
  v_mfma_f32_16x16x32_bf16 v[220:223], v[16:19], v[200:203], v[220:223]
  v_cndmask_b32 v5, v217, v213, s[40:41]
  s_waitcnt lgkmcnt(10)
  v_mfma_f32_16x16x32_bf16 v[220:223], v[128:131], v[144:147], v[220:223]
  v_add_f32_dpp v216, v5, v216 wave_ror:1 row_mask:0xf bank_mask:0xf
  v_cvt_pk_bf16_f32 v15, v212, v216
  ds_write_b16 v9, v15 offset:5120
  ds_write_b16_d16_hi v9, v15 offset:5632
  v_mfma_f32_16x16x32_bf16 v[224:227], v[124:127], v[148:151], 0
  v_mfma_f32_16x16x32_bf16 v[224:227], v[116:119], v[152:155], v[224:227]
  v_mfma_f32_16x16x32_bf16 v[224:227], v[108:111], v[156:159], v[224:227]
  v_mfma_f32_16x16x32_bf16 v[224:227], v[100:103], v[160:163], v[224:227]
  v_cndmask_b32 v6, v223, v219, s[40:41]
  v_mfma_f32_16x16x32_bf16 v[224:227], v[92:95], v[164:167], v[224:227]
  v_mfma_f32_16x16x32_bf16 v[224:227], v[84:87], v[168:171], v[224:227]
  v_add_f32_dpp v222, v6, v222 wave_ror:1 row_mask:0xf bank_mask:0xf
  v_mfma_f32_16x16x32_bf16 v[224:227], v[76:79], v[172:175], v[224:227]
  v_cndmask_b32 v6, v222, v218, s[40:41]
  v_mfma_f32_16x16x32_bf16 v[224:227], v[68:71], v[176:179], v[224:227]
  v_mfma_f32_16x16x32_bf16 v[224:227], v[60:63], v[180:183], v[224:227]
  v_add_f32_dpp v221, v6, v221 wave_ror:1 row_mask:0xf bank_mask:0xf
  v_mfma_f32_16x16x32_bf16 v[224:227], v[52:55], v[184:187], v[224:227]
  v_cndmask_b32 v6, v221, v217, s[40:41]
  v_mfma_f32_16x16x32_bf16 v[224:227], v[44:47], v[188:191], v[224:227]
  v_mfma_f32_16x16x32_bf16 v[224:227], v[36:39], v[192:195], v[224:227]
  v_add_f32_dpp v220, v6, v220 wave_ror:1 row_mask:0xf bank_mask:0xf
  v_mfma_f32_16x16x32_bf16 v[224:227], v[28:31], v[196:199], v[224:227]
  v_mfma_f32_16x16x32_bf16 v[224:227], v[20:23], v[200:203], v[224:227]
  s_waitcnt lgkmcnt(10)
  v_mfma_f32_16x16x32_bf16 v[224:227], v[132:135], v[144:147], v[224:227]
  v_mfma_f32_16x16x32_bf16 v[208:211], v[128:131], v[148:151], 0
  v_mfma_f32_16x16x32_bf16 v[208:211], v[120:123], v[152:155], v[208:211]
  v_mfma_f32_16x16x32_bf16 v[208:211], v[112:115], v[156:159], v[208:211]
  v_mfma_f32_16x16x32_bf16 v[208:211], v[104:107], v[160:163], v[208:211]
  v_mfma_f32_16x16x32_bf16 v[208:211], v[96:99], v[164:167], v[208:211]
  v_mfma_f32_16x16x32_bf16 v[208:211], v[88:91], v[168:171], v[208:211]
  v_mfma_f32_16x16x32_bf16 v[208:211], v[80:83], v[172:175], v[208:211]
  v_mfma_f32_16x16x32_bf16 v[208:211], v[72:75], v[176:179], v[208:211]
  v_cndmask_b32 v8, v227, v223, s[40:41]
  v_mfma_f32_16x16x32_bf16 v[208:211], v[64:67], v[180:183], v[208:211]
  v_mfma_f32_16x16x32_bf16 v[208:211], v[56:59], v[184:187], v[208:211]
  v_add_f32_dpp v226, v8, v226 wave_ror:1 row_mask:0xf bank_mask:0xf
  v_mfma_f32_16x16x32_bf16 v[208:211], v[48:51], v[188:191], v[208:211]
  v_cndmask_b32 v8, v226, v222, s[40:41]
  v_mfma_f32_16x16x32_bf16 v[208:211], v[40:43], v[192:195], v[208:211]
  v_mfma_f32_16x16x32_bf16 v[208:211], v[32:35], v[196:199], v[208:211]
  v_add_f32_dpp v225, v8, v225 wave_ror:1 row_mask:0xf bank_mask:0xf
  v_mfma_f32_16x16x32_bf16 v[208:211], v[24:27], v[200:203], v[208:211]
  v_cndmask_b32 v8, v225, v221, s[40:41]
  s_waitcnt lgkmcnt(8)
  v_mfma_f32_16x16x32_bf16 v[208:211], v[16:19], v[204:207], v[208:211]
  v_add_f32_dpp v224, v8, v224 wave_ror:1 row_mask:0xf bank_mask:0xf
  s_waitcnt lgkmcnt(6)
  v_mfma_f32_16x16x32_bf16 v[208:211], v[136:139], v[144:147], v[208:211]
  v_cvt_pk_bf16_f32 v15, v220, v224
  ds_write_b16 v9, v15 offset:6144
  ds_write_b16_d16_hi v9, v15 offset:6656
  v_mfma_f32_16x16x32_bf16 v[212:215], v[132:135], v[148:151], 0
  v_mfma_f32_16x16x32_bf16 v[212:215], v[124:127], v[152:155], v[212:215]
  v_mfma_f32_16x16x32_bf16 v[212:215], v[116:119], v[156:159], v[212:215]
  v_mfma_f32_16x16x32_bf16 v[212:215], v[108:111], v[160:163], v[212:215]
  v_mfma_f32_16x16x32_bf16 v[212:215], v[100:103], v[164:167], v[212:215]
  v_cndmask_b32 v5, v211, v227, s[40:41]
  v_mfma_f32_16x16x32_bf16 v[212:215], v[92:95], v[168:171], v[212:215]
  v_mfma_f32_16x16x32_bf16 v[212:215], v[84:87], v[172:175], v[212:215]
  v_add_f32_dpp v210, v5, v210 wave_ror:1 row_mask:0xf bank_mask:0xf
  v_mfma_f32_16x16x32_bf16 v[212:215], v[76:79], v[176:179], v[212:215]
  v_cndmask_b32 v5, v210, v226, s[40:41]
  v_mfma_f32_16x16x32_bf16 v[212:215], v[68:71], v[180:183], v[212:215]
  v_mfma_f32_16x16x32_bf16 v[212:215], v[60:63], v[184:187], v[212:215]
  v_add_f32_dpp v209, v5, v209 wave_ror:1 row_mask:0xf bank_mask:0xf
  v_mfma_f32_16x16x32_bf16 v[212:215], v[52:55], v[188:191], v[212:215]
  v_cndmask_b32 v5, v209, v225, s[40:41]
  v_mfma_f32_16x16x32_bf16 v[212:215], v[44:47], v[192:195], v[212:215]
  v_mfma_f32_16x16x32_bf16 v[212:215], v[36:39], v[196:199], v[212:215]
  v_add_f32_dpp v208, v5, v208 wave_ror:1 row_mask:0xf bank_mask:0xf
  v_mfma_f32_16x16x32_bf16 v[212:215], v[28:31], v[200:203], v[212:215]
  v_mfma_f32_16x16x32_bf16 v[212:215], v[20:23], v[204:207], v[212:215]
  s_waitcnt lgkmcnt(4)
  v_mfma_f32_16x16x32_bf16 v[212:215], v[140:143], v[144:147], v[212:215]
  s_nop 7
  v_cndmask_b32 v6, v215, v211, s[40:41]
  s_nop 1
  v_add_f32_dpp v214, v6, v214 wave_ror:1 row_mask:0xf bank_mask:0xf
  v_cndmask_b32 v6, v214, v210, s[40:41]
  s_nop 1
  v_add_f32_dpp v213, v6, v213 wave_ror:1 row_mask:0xf bank_mask:0xf
  v_cndmask_b32 v6, v213, v209, s[40:41]
  s_nop 1
  v_add_f32_dpp v212, v6, v212 wave_ror:1 row_mask:0xf bank_mask:0xf
  v_cvt_pk_bf16_f32 v15, v208, v212
  ds_write_b16 v9, v15 offset:7168
  ds_write_b16_d16_hi v9, v15 offset:7680
  v_mov_b32 v5, 122880
  v_mov_b32 v6, 1
  s_mov_b64 exec, 1
  ds_add_u32 v5, v6 offset:28
  s_mov_b64 exec, -1
  v_mov_b32 v5, 122880
  s_mov_b32 s6, 1048576
lw18:
  ds_read_b32 v6, v5 offset:24
  s_waitcnt lgkmcnt(0)
  v_readfirstlane_b32 s7, v6
  s_nop 1
  s_cmp_ge_u32 s7, 4
  s_cbranch_scc1 lw18_ok
  s_sub_u32 s6, s6, 1
  s_cmp_eq_u32 s6, 0
  s_cbranch_scc1 lw18_ok
  s_sleep 1
  s_branch lw18
lw18_ok:
  s_setprio 2
  s_cmp_eq_u32 s54, 0
  s_cbranch_scc1 att_short1
  ds_read_b128 v[8:11], v1
  ds_read_b128 v[12:15], v1 offset:512
  ds_read_b128 v[24:27], v4 offset:14336
  ds_read_b128 v[28:31], v4 offset:14848
  ds_read_b128 v[16:19], v4 offset:16384
  ds_read_b128 v[20:23], v4 offset:16896
  ds_read_b128 v[32:35], v4 offset:12288
  ds_read_b128 v[36:39], v4 offset:12800
  s_lshl2_add_u32 s31, s53, s26
  s_lshl_b32 s31, s31, 14
  s_and_b32 s30, s57, 8
  s_lshl_b32 s30, s30, 7
  s_add_u32 s31, s31, s30
  v_and_b32 v231, 14336, v254
  buffer_load_dword v231, v231, s[60:63], s31 offen offset:384
  s_waitcnt lgkmcnt(4)
  s_cmp_le_u32 s25, 0
  s_cbranch_scc1 af1_inv7
  v_mfma_f32_32x32x16_bf16 v[80:95], v[24:27], v[8:11], 0
af1_back7:
  v_mfma_f32_32x32x16_bf16 v[80:95], v[28:31], v[12:15], v[80:95]
  ds_read_b128 v[24:27], v4 offset:8192
  ds_read_b128 v[28:31], v4 offset:8704
  s_waitcnt lgkmcnt(4)
  v_mfma_f32_32x32x16_bf16 v[96:111], v[16:19], v[8:11], 0
  v_mfma_f32_32x32x16_bf16 v[96:111], v[20:23], v[12:15], v[96:111]
  ds_read_b128 v[16:19], v4 offset:10240
  ds_read_b128 v[20:23], v4 offset:10752
  s_waitcnt lgkmcnt(4)
  s_cmp_le_u32 s25, 1
  s_cbranch_scc1 af1_inv6
  v_mfma_f32_32x32x16_bf16 v[64:79], v[32:35], v[8:11], 0
af1_back6:
  s_nop 0
  v_exp_f32 v80, v80
  v_exp_f32 v81, v81
  v_exp_f32 v82, v82
  v_exp_f32 v83, v83
  v_exp_f32 v84, v84
  v_exp_f32 v85, v85
  v_exp_f32 v86, v86
  v_exp_f32 v87, v87
  v_exp_f32 v88, v88
  v_exp_f32 v89, v89
  v_mfma_f32_32x32x16_bf16 v[64:79], v[36:39], v[12:15], v[64:79]
  ds_read_b128 v[32:35], v4 offset:6144
  ds_read_b128 v[36:39], v4 offset:6656
  v_exp_f32 v90, v90
  v_exp_f32 v91, v91
  v_exp_f32 v92, v92
  v_exp_f32 v93, v93
  v_exp_f32 v94, v94
  v_exp_f32 v95, v95
  v_cvt_pk_bf16_f32 v112, v80, v81
  v_cvt_pk_bf16_f32 v113, v82, v83
  v_cvt_pk_bf16_f32 v114, v84, v85
  v_cvt_pk_bf16_f32 v115, v86, v87
  v_cvt_pk_bf16_f32 v116, v88, v89
  v_cvt_pk_bf16_f32 v117, v90, v91
  v_cvt_pk_bf16_f32 v118, v92, v93
  v_cvt_pk_bf16_f32 v119, v94, v95
  s_and_b32 s31, s3, 3
  s_lshl_b32 s31, s31, 11
  s_add_u32 s31, s31, 114688
  v_add_u32 v212, s31, v2
  v_mov_b32 v5, 122880
  s_mov_b32 s6, 1048576
lw19:
  ds_read_b32 v6, v5 offset:28
  s_waitcnt lgkmcnt(0)
  v_readfirstlane_b32 s7, v6
  s_nop 1
  s_cmp_ge_u32 s7, 4
  s_cbranch_scc1 lw19_ok
  s_sub_u32 s6, s6, 1
  s_cmp_eq_u32 s6, 0
  s_cbranch_scc1 lw19_ok
  s_sleep 1
  s_branch lw19
lw19_ok:
  ds_read_b128 v[184:187], v212 offset:0
  ds_read_b128 v[188:191], v212 offset:1024
  v_mov_b32 v5, 122880
  v_mov_b32 v6, 1
  s_mov_b64 exec, 1
  ds_add_u32 v5, v6 offset:4
  s_mov_b64 exec, -1
  s_and_b32 s31, s57, 7
  s_cmp_eq_u32 s31, 3
  s_cbranch_scc1 af1_nt1
  buffer_load_dword v253, v254, s[60:63], s35 offen
af1_nt1:
  s_cmp_le_u32 s25, 2
  s_cbranch_scc1 af1_inv5
  v_mfma_f32_32x32x16_bf16 v[80:95], v[16:19], v[8:11], 0
af1_back5:
  v_exp_f32 v64, v64
  v_exp_f32 v65, v65
  v_exp_f32 v66, v66
  v_exp_f32 v67, v67
  v_exp_f32 v68, v68
  v_exp_f32 v69, v69
  v_exp_f32 v70, v70
  v_mfma_f32_32x32x16_bf16 v[80:95], v[20:23], v[12:15], v[80:95]
  ds_read_b128 v[16:19], v4 offset:4096
  ds_read_b128 v[20:23], v4 offset:4608
  v_exp_f32 v71, v71
  v_exp_f32 v72, v72
  v_exp_f32 v73, v73
  v_exp_f32 v74, v74
  v_exp_f32 v75, v75
  v_exp_f32 v76, v76
  v_exp_f32 v77, v77
  v_mfma_f32_16x16x32_bf16 v[208:211], v[240:243], v[112:115], 0
  v_exp_f32 v78, v78
  v_exp_f32 v79, v79
  v_cvt_pk_bf16_f32 v120, v64, v65
  v_cvt_pk_bf16_f32 v121, v66, v67
  v_mfma_f32_16x16x32_bf16 v[208:211], v[240:243], v[116:119], v[208:211]
  v_cvt_pk_bf16_f32 v122, v68, v69
  v_cvt_pk_bf16_f32 v123, v70, v71
  v_cvt_pk_bf16_f32 v124, v72, v73
  v_cvt_pk_bf16_f32 v125, v74, v75
  v_cvt_pk_bf16_f32 v126, v76, v77
  v_cvt_pk_bf16_f32 v127, v78, v79
  v_mov_b32 v5, 122880
  s_mov_b32 s6, 1048576
lw20:
  ds_read_b32 v6, v5 offset:16
  s_waitcnt lgkmcnt(0)
  v_readfirstlane_b32 s7, v6
  s_nop 1
  s_cmp_ge_u32 s7, 4
  s_cbranch_scc1 lw20_ok
  s_sub_u32 s6, s6, 1
  s_cmp_eq_u32 s6, 0
  s_cbranch_scc1 lw20_ok
  s_sleep 1
  s_branch lw20
lw20_ok:
  s_and_b32 s31, s3, 3
  s_lshl_b32 s31, s31, 11
  s_lshl_b32 s30, s50, 14
  s_add_u32 s31, s31, s30
  s_add_u32 s31, s31, 8192
  buffer_store_dwordx4 v[184:187], v2, s[20:23], s31 offen offset:0 sc1
  buffer_store_dwordx4 v[188:191], v2, s[20:23], s31 offen offset:1024 sc1
  ds_read_b128 v[40:43], v3 offset:14336
  ds_read_b128 v[44:47], v3 offset:14848
  ds_read_b128 v[48:51], v3 offset:12288
  ds_read_b128 v[52:55], v3 offset:12800
  ds_read_b128 v[56:59], v3 offset:10240
  ds_read_b128 v[60:63], v3 offset:10752
  s_cmp_le_u32 s25, 3
  s_cbranch_scc1 af1_inv4
  v_mfma_f32_32x32x16_bf16 v[64:79], v[24:27], v[8:11], 0
af1_back4:
  v_exp_f32 v80, v80
  v_exp_f32 v81, v81
  v_exp_f32 v82, v82
  v_mfma_f32_32x32x16_bf16 v[64:79], v[28:31], v[12:15], v[64:79]
  ds_read_b128 v[24:27], v4 offset:2048
  ds_read_b128 v[28:31], v4 offset:2560
  v_exp_f32 v83, v83
  v_exp_f32 v84, v84
  v_exp_f32 v85, v85
  s_waitcnt lgkmcnt(6)
  v_mfma_f32_32x32x16_bf16 v[192:207], v[40:43], v[112:115], 0
  v_exp_f32 v86, v86
  v_exp_f32 v87, v87
  v_exp_f32 v88, v88
  v_mfma_f32_16x16x32_bf16 v[208:211], v[240:243], v[120:123], v[208:211]
  v_exp_f32 v89, v89
  v_mfma_f32_32x32x16_bf16 v[192:207], v[44:47], v[116:119], v[192:207]
  ds_read_b128 v[40:43], v3 offset:8192
  ds_read_b128 v[44:47], v3 offset:8704
  v_exp_f32 v90, v90
  v_exp_f32 v91, v91
  v_exp_f32 v92, v92
  v_mfma_f32_16x16x32_bf16 v[208:211], v[240:243], v[124:127], v[208:211]
  v_exp_f32 v93, v93
  v_exp_f32 v94, v94
  s_waitcnt lgkmcnt(6)
  v_mfma_f32_32x32x16_bf16 v[192:207], v[48:51], v[120:123], v[192:207]
  v_exp_f32 v95, v95
  v_cvt_pk_bf16_f32 v128, v80, v81
  v_cvt_pk_bf16_f32 v129, v82, v83
  v_cvt_pk_bf16_f32 v130, v84, v85
  v_mfma_f32_32x32x16_bf16 v[192:207], v[52:55], v[124:127], v[192:207]
  ds_read_b128 v[48:51], v3 offset:6144
  ds_read_b128 v[52:55], v3 offset:6656
  v_cvt_pk_bf16_f32 v131, v86, v87
  v_cvt_pk_bf16_f32 v132, v88, v89
  v_cvt_pk_bf16_f32 v133, v90, v91
  v_cvt_pk_bf16_f32 v134, v92, v93
  v_cvt_pk_bf16_f32 v135, v94, v95
  s_cmp_le_u32 s25, 4
  s_cbranch_scc1 af1_inv3
  v_mfma_f32_32x32x16_bf16 v[80:95], v[32:35], v[8:11], 0
af1_back3:
  v_exp_f32 v64, v64
  v_exp_f32 v65, v65
  v_exp_f32 v66, v66
  v_exp_f32 v67, v67
  v_mfma_f32_32x32x16_bf16 v[80:95], v[36:39], v[12:15], v[80:95]
  ds_read_b128 v[32:35], v4 offset:0
  ds_read_b128 v[36:39], v4 offset:512
  v_exp_f32 v68, v68
  v_exp_f32 v69, v69
  v_exp_f32 v70, v70
  v_exp_f32 v71, v71
  s_waitcnt lgkmcnt(8)
  v_mfma_f32_32x32x16_bf16 v[192:207], v[56:59], v[128:131], v[192:207]
  v_exp_f32 v72, v72
  v_exp_f32 v73, v73
  v_exp_f32 v74, v74
  v_exp_f32 v75, v75
  v_mfma_f32_16x16x32_bf16 v[208:211], v[240:243], v[128:131], v[208:211]
  v_exp_f32 v76, v76
  v_exp_f32 v77, v77
  v_mfma_f32_32x32x16_bf16 v[192:207], v[60:63], v[132:135], v[192:207]
  ds_read_b128 v[56:59], v3 offset:4096
  ds_read_b128 v[60:63], v3 offset:4608
  v_exp_f32 v78, v78
  v_exp_f32 v79, v79
  v_cvt_pk_bf16_f32 v136, v64, v65
  v_cvt_pk_bf16_f32 v137, v66, v67
  v_cvt_pk_bf16_f32 v138, v68, v69
  v_cvt_pk_bf16_f32 v139, v70, v71
  v_mfma_f32_16x16x32_bf16 v[208:211], v[240:243], v[132:135], v[208:211]
  v_cvt_pk_bf16_f32 v140, v72, v73
  v_cvt_pk_bf16_f32 v141, v74, v75
  v_cvt_pk_bf16_f32 v142, v76, v77
  v_cvt_pk_bf16_f32 v143, v78, v79
  s_cmp_le_u32 s25, 5
  s_cbranch_scc1 af1_inv2
  v_mfma_f32_32x32x16_bf16 v[64:79], v[16:19], v[8:11], 0
af1_back2:
  v_exp_f32 v80, v80
  v_exp_f32 v81, v81
  v_exp_f32 v82, v82
  v_exp_f32 v83, v83
  v_mfma_f32_32x32x16_bf16 v[64:79], v[20:23], v[12:15], v[64:79]
  v_exp_f32 v84, v84
  v_exp_f32 v85, v85
  v_exp_f32 v86, v86
  v_exp_f32 v87, v87
  s_waitcnt lgkmcnt(6)
  v_mfma_f32_32x32x16_bf16 v[192:207], v[40:43], v[136:139], v[192:207]
  v_exp_f32 v88, v88
  v_exp_f32 v89, v89
  v_exp_f32 v90, v90
  v_exp_f32 v91, v91
  v_mfma_f32_16x16x32_bf16 v[208:211], v[240:243], v[136:139], v[208:211]
  v_exp_f32 v92, v92
  v_exp_f32 v93, v93
  v_mfma_f32_32x32x16_bf16 v[192:207], v[44:47], v[140:143], v[192:207]
  ds_read_b128 v[40:43], v3 offset:2048
  ds_read_b128 v[44:47], v3 offset:2560
  v_exp_f32 v94, v94
  v_exp_f32 v95, v95
  v_cvt_pk_bf16_f32 v144, v80, v81
  v_cvt_pk_bf16_f32 v145, v82, v83
  v_cvt_pk_bf16_f32 v146, v84, v85
  v_cvt_pk_bf16_f32 v147, v86, v87
  v_mfma_f32_16x16x32_bf16 v[208:211], v[240:243], v[140:143], v[208:211]
  v_cvt_pk_bf16_f32 v148, v88, v89
  v_cvt_pk_bf16_f32 v149, v90, v91
  v_cvt_pk_bf16_f32 v150, v92, v93
  v_cvt_pk_bf16_f32 v151, v94, v95
  s_cmp_le_u32 s25, 6
  s_cbranch_scc1 af1_inv1
  v_mfma_f32_32x32x16_bf16 v[80:95], v[24:27], v[8:11], 0
af1_back1:
  v_exp_f32 v64, v64
  v_exp_f32 v65, v65
  v_exp_f32 v66, v66
  v_exp_f32 v67, v67
  v_mfma_f32_32x32x16_bf16 v[80:95], v[28:31], v[12:15], v[80:95]
  v_exp_f32 v68, v68
  v_exp_f32 v69, v69
  v_exp_f32 v70, v70
  v_exp_f32 v71, v71
  s_waitcnt lgkmcnt(6)
  v_mfma_f32_32x32x16_bf16 v[192:207], v[48:51], v[144:147], v[192:207]
  v_exp_f32 v72, v72
  v_exp_f32 v73, v73
  v_exp_f32 v74, v74
  v_exp_f32 v75, v75
  v_mfma_f32_16x16x32_bf16 v[208:211], v[240:243], v[144:147], v[208:211]
  v_exp_f32 v76, v76
  v_exp_f32 v77, v77
  v_mfma_f32_32x32x16_bf16 v[192:207], v[52:55], v[148:151], v[192:207]
  ds_read_b128 v[48:51], v3 offset:16384
  ds_read_b128 v[52:55], v3 offset:16896
  v_exp_f32 v78, v78
  v_exp_f32 v79, v79
  v_cvt_pk_bf16_f32 v152, v64, v65
  v_cvt_pk_bf16_f32 v153, v66, v67
  v_cvt_pk_bf16_f32 v154, v68, v69
  v_cvt_pk_bf16_f32 v155, v70, v71
  v_mfma_f32_16x16x32_bf16 v[208:211], v[240:243], v[148:151], v[208:211]
  v_cvt_pk_bf16_f32 v156, v72, v73
  v_cvt_pk_bf16_f32 v157, v74, v75
  v_cvt_pk_bf16_f32 v158, v76, v77
  v_cvt_pk_bf16_f32 v159, v78, v79
  s_waitcnt lgkmcnt(6)
  s_cmp_le_u32 s25, 7
  s_cbranch_scc1 af1_inv0
  v_mfma_f32_32x32x16_bf16 v[64:79], v[32:35], v[8:11], 0
af1_back0:
  v_exp_f32 v80, v80
  v_exp_f32 v81, v81
  v_exp_f32 v82, v82
  v_exp_f32 v83, v83
  v_mfma_f32_32x32x16_bf16 v[64:79], v[36:39], v[12:15], v[64:79]
  v_exp_f32 v84, v84
  v_exp_f32 v85, v85
  v_exp_f32 v86, v86
  v_exp_f32 v87, v87
  s_waitcnt lgkmcnt(4)
  v_mfma_f32_32x32x16_bf16 v[192:207], v[56:59], v[152:155], v[192:207]
  v_exp_f32 v88, v88
  v_exp_f32 v89, v89
  v_exp_f32 v90, v90
  v_exp_f32 v91, v91
  v_mfma_f32_16x16x32_bf16 v[208:211], v[240:243], v[152:155], v[208:211]
  v_exp_f32 v92, v92
  v_exp_f32 v93, v93
  v_mfma_f32_32x32x16_bf16 v[192:207], v[60:63], v[156:159], v[192:207]
  ds_read_b128 v[56:59], v3 offset:0
  ds_read_b128 v[60:63], v3 offset:512
  v_exp_f32 v94, v94
  v_exp_f32 v95, v95
  v_cvt_pk_bf16_f32 v160, v80, v81
  v_cvt_pk_bf16_f32 v161, v82, v83
  v_cvt_pk_bf16_f32 v162, v84, v85
  v_cvt_pk_bf16_f32 v163, v86, v87
  v_mfma_f32_16x16x32_bf16 v[208:211], v[240:243], v[156:159], v[208:211]
  v_cvt_pk_bf16_f32 v164, v88, v89
  v_cvt_pk_bf16_f32 v165, v90, v91
  v_cvt_pk_bf16_f32 v166, v92, v93
  v_cvt_pk_bf16_f32 v167, v94, v95
  s_waitcnt lgkmcnt(4)
  v_mfma_f32_32x32x16_bf16 v[192:207], v[40:43], v[160:163], v[192:207]
  s_mov_b32 s28, 0xffffffff
  s_mov_b32 s29, 0xfffffff0
  v_cndmask_b32 v64, v64, v96, s[28:29]
  s_mov_b32 s30, 0xfffffffe
  s_mov_b32 s31, 0xffffffe0
  v_cndmask_b32 v65, v65, v97, s[30:31]
  s_mov_b32 s32, 0xfffffffc
  s_mov_b32 s33, 0xffffffc0
  v_cndmask_b32 v66, v66, v98, s[32:33]
  s_mov_b32 s34, 0xfffffff8
  s_mov_b32 s35, 0xffffff80
  v_cndmask_b32 v67, v67, v99, s[34:35]
  s_mov_b32 s28, 0xffffff00
  s_mov_b32 s29, 0xfffff000
  v_cndmask_b32 v68, v68, v100, s[28:29]
  s_mov_b32 s30, 0xfffffe00
  s_mov_b32 s31, 0xffffe000
  v_cndmask_b32 v69, v69, v101, s[30:31]
  s_mov_b32 s32, 0xfffffc00
  s_mov_b32 s33, 0xffffc000
  v_cndmask_b32 v70, v70, v102, s[32:33]
  s_mov_b32 s34, 0xfffff800
  s_mov_b32 s35, 0xffff8000
  v_cndmask_b32 v71, v71, v103, s[34:35]
  s_mov_b32 s28, 0xffff0000
  s_mov_b32 s29, 0xfff00000
  v_cndmask_b32 v72, v72, v104, s[28:29]
  s_mov_b32 s30, 0xfffe0000
  s_mov_b32 s31, 0xffe00000
  v_cndmask_b32 v73, v73, v105, s[30:31]
  s_mov_b32 s32, 0xfffc0000
  s_mov_b32 s33, 0xffc00000
  v_cndmask_b32 v74, v74, v106, s[32:33]
  s_mov_b32 s34, 0xfff80000
  s_mov_b32 s35, 0xff800000
  v_cndmask_b32 v75, v75, v107, s[34:35]
  s_mov_b32 s28, 0xff000000
  s_mov_b32 s29, 0xf0000000
  v_cndmask_b32 v76, v76, v108, s[28:29]
  s_mov_b32 s30, 0xfe000000
  s_mov_b32 s31, 0xe0000000
  v_cndmask_b32 v77, v77, v109, s[30:31]
  s_mov_b32 s32, 0xfc000000
  s_mov_b32 s33, 0xc0000000
  v_cndmask_b32 v78, v78, v110, s[32:33]
  s_mov_b32 s34, 0xf8000000
  s_mov_b32 s35, 0x80000000
  v_cndmask_b32 v79, v79, v111, s[34:35]
  v_exp_f32 v64, v64
  v_exp_f32 v65, v65
  v_mfma_f32_16x16x32_bf16 v[208:211], v[240:243], v[160:163], v[208:211]
  v_exp_f32 v66, v66
  v_exp_f32 v67, v67
  v_exp_f32 v68, v68
  v_exp_f32 v69, v69
  v_mfma_f32_32x32x16_bf16 v[192:207], v[44:47], v[164:167], v[192:207]
  v_exp_f32 v70, v70
  v_exp_f32 v71, v71
  v_exp_f32 v72, v72
  v_exp_f32 v73, v73
  v_exp_f32 v74, v74
  v_exp_f32 v75, v75
  v_exp_f32 v76, v76
  v_exp_f32 v77, v77
  v_exp_f32 v78, v78
  v_exp_f32 v79, v79
  v_mfma_f32_16x16x32_bf16 v[208:211], v[240:243], v[164:167], v[208:211]
  v_cvt_pk_bf16_f32 v168, v64, v65
  v_cvt_pk_bf16_f32 v169, v66, v67
  v_cvt_pk_bf16_f32 v170, v68, v69
  v_cvt_pk_bf16_f32 v171, v70, v71
  v_cvt_pk_bf16_f32 v172, v72, v73
  v_cvt_pk_bf16_f32 v173, v74, v75
  v_cvt_pk_bf16_f32 v174, v76, v77
  v_cvt_pk_bf16_f32 v175, v78, v79
  v_mfma_f32_16x16x32_bf16 v[208:211], v[240:243], v[168:171], v[208:211]
  v_and_b32 v176, v232, v168
  v_and_b32 v177, v233, v169
  v_and_b32 v178, v234, v170
  v_and_b32 v179, v235, v171
  v_and_b32 v180, v236, v172
  v_and_b32 v181, v237, v173
  v_and_b32 v182, v238, v174
  v_and_b32 v183, v239, v175
  v_mfma_f32_16x16x32_bf16 v[208:211], v[240:243], v[172:175], v[208:211]
  v_bfi_b32 v64, v232, 0, v168
  v_bfi_b32 v65, v233, 0, v169
  v_bfi_b32 v66, v234, 0, v170
  v_bfi_b32 v67, v235, 0, v171
  v_bfi_b32 v68, v236, 0, v172
  v_bfi_b32 v69, v237, 0, v173
  v_bfi_b32 v70, v238, 0, v174
  v_bfi_b32 v71, v239, 0, v175
  s_waitcnt lgkmcnt(2)
  v_mfma_f32_32x32x16_bf16 v[192:207], v[48:51], v[176:179], v[192:207]
  v_mfma_f32_32x32x16_bf16 v[192:207], v[52:55], v[180:183], v[192:207]
  s_waitcnt lgkmcnt(0)
  v_mfma_f32_32x32x16_bf16 v[192:207], v[56:59], v[64:67], v[192:207]
  v_mfma_f32_32x32x16_bf16 v[192:207], v[60:63], v[68:71], v[192:207]
att_chk1:
  v_cmp_lt_f32 vcc, 0x21800000, v208
  s_mov_b32 s30, 0x5d800000
  v_cmp_gt_f32 s[28:29], s30, v208
  s_add_u32 s16, s98, 0xc00000
  s_addc_u32 s17, s99, 0
  s_mov_b32 s18, 0x400000
  s_mov_b32 s19, 0x00020000
  s_lshl_b32 s27, s25, 5
  s_add_u32 s27, s27, s24
  s_lshl_b32 s27, s27, 11
  s_and_b64 vcc, vcc, s[28:29]
  s_cmp_eq_u64 vcc, exec
  s_cbranch_scc0 att_slow
  v_rcp_f32 v212, v208
att_fin1:
  s_nop 0
  v_pk_mul_f32 v[192:193], v[192:193], v[212:213] op_sel_hi:[1,0]
  v_pk_mul_f32 v[194:195], v[194:195], v[212:213] op_sel_hi:[1,0]
  v_pk_mul_f32 v[196:197], v[196:197], v[212:213] op_sel_hi:[1,0]
  v_pk_mul_f32 v[198:199], v[198:199], v[212:213] op_sel_hi:[1,0]
  v_cvt_pk_bf16_f32 v192, v192, v193
  v_cvt_pk_bf16_f32 v193, v194, v195
  v_cvt_pk_bf16_f32 v194, v196, v197
  v_cvt_pk_bf16_f32 v195, v198, v199
  buffer_store_dwordx4 v[192:195], v2, s[16:19], s27 offen offset:0 sc1
  v_pk_mul_f32 v[200:201], v[200:201], v[212:213] op_sel_hi:[1,0]
  v_pk_mul_f32 v[202:203], v[202:203], v[212:213] op_sel_hi:[1,0]
  v_pk_mul_f32 v[204:205], v[204:205], v[212:213] op_sel_hi:[1,0]
  v_pk_mul_f32 v[206:207], v[206:207], v[212:213] op_sel_hi:[1,0]
  v_cvt_pk_bf16_f32 v200, v200, v201
  v_cvt_pk_bf16_f32 v201, v202, v203
  v_cvt_pk_bf16_f32 v202, v204, v205
  v_cvt_pk_bf16_f32 v203, v206, v207
  buffer_store_dwordx4 v[200:203], v2, s[16:19], s27 offen offset:1024 sc1
  s_and_b32 s31, s3, 3
  s_lshl_b32 s31, s31, 1
  s_add_u32 s31, s31, 0
  ds_read_b64_tr_b16 v[16:17], v228 offset:32
  ds_read_b64_tr_b16 v[18:19], v228 offset:0
  ds_read_b64_tr_b16 v[80:81], v229 offset:0
  ds_read_b64_tr_b16 v[82:83], v229 offset:32
  ds_read_b64_tr_b16 v[20:21], v228 offset:160
  ds_read_b64_tr_b16 v[22:23], v228 offset:128
  ds_read_b64_tr_b16 v[84:85], v229 offset:256
  ds_read_b64_tr_b16 v[86:87], v229 offset:288
  ds_read_b64_tr_b16 v[24:25], v228 offset:288
  ds_read_b64_tr_b16 v[26:27], v228 offset:256
  ds_read_b64_tr_b16 v[28:29], v228 offset:416
  ds_read_b64_tr_b16 v[30:31], v228 offset:384
  v_lshl_add_u32 v9, v0, 3, s31
  v_mov_b32 v14, 0
  s_mov_b32 s40, 0
  s_mov_b32 s41, 0x80000000
  s_waitcnt lgkmcnt(8)
  v_mfma_f32_16x16x32_bf16 v[112:115], v[16:19], v[80:83], 0
  ds_read_b64_tr_b16 v[88:89], v229 offset:512
  ds_read_b64_tr_b16 v[90:91], v229 offset:544
  ds_read_b64_tr_b16 v[32:33], v228 offset:544
  ds_read_b64_tr_b16 v[34:35], v228 offset:512
  ds_read_b64_tr_b16 v[36:37], v228 offset:672
  ds_read_b64_tr_b16 v[38:39], v228 offset:640
  s_waitcnt lgkmcnt(12)
  v_mfma_f32_16x16x32_bf16 v[116:119], v[20:23], v[80:83], 0
  ds_read_b64_tr_b16 v[92:93], v229 offset:768
  ds_read_b64_tr_b16 v[94:95], v229 offset:800
  s_waitcnt lgkmcnt(9)
  ds_read_b64_tr_b16 v[40:41], v228 offset:800
  ds_read_b64_tr_b16 v[42:43], v228 offset:768
  ds_read_b64_tr_b16 v[44:45], v228 offset:928
  ds_read_b64_tr_b16 v[46:47], v228 offset:896
  v_cndmask_b32 v5, v115, v14, s[40:41]
  v_cndmask_b32 v6, v119, v115, s[40:41]
  v_mfma_f32_16x16x32_bf16 v[120:123], v[16:19], v[84:87], 0
  ds_read_b64_tr_b16 v[96:97], v229 offset:1024
  ds_read_b64_tr_b16 v[98:99], v229 offset:1056
  s_waitcnt lgkmcnt(9)
  ds_read_b64_tr_b16 v[48:49], v228 offset:1056
  ds_read_b64_tr_b16 v[50:51], v228 offset:1024
  ds_read_b64_tr_b16 v[52:53], v228 offset:1184
  ds_read_b64_tr_b16 v[54:55], v228 offset:1152
  v_add_f32_dpp v114, v5, v114 wave_ror:1 row_mask:0xf bank_mask:0xf
  v_cndmask_b32 v5, v114, v14, s[40:41]
  v_mfma_f32_16x16x32_bf16 v[120:123], v[24:27], v[80:83], v[120:123]
  ds_read_b64_tr_b16 v[100:101], v229 offset:1280
  ds_read_b64_tr_b16 v[102:103], v229 offset:1312
  s_waitcnt lgkmcnt(9)
  ds_read_b64_tr_b16 v[56:57], v228 offset:1312
  ds_read_b64_tr_b16 v[58:59], v228 offset:1280
  ds_read_b64_tr_b16 v[60:61], v228 offset:1440
  ds_read_b64_tr_b16 v[62:63], v228 offset:1408
  v_add_f32_dpp v113, v5, v113 wave_ror:1 row_mask:0xf bank_mask:0xf
  v_cndmask_b32 v5, v113, v14, s[40:41]
  v_mfma_f32_16x16x32_bf16 v[124:127], v[20:23], v[84:87], 0
  ds_read_b64_tr_b16 v[104:105], v229 offset:1536
  ds_read_b64_tr_b16 v[106:107], v229 offset:1568
  s_waitcnt lgkmcnt(9)
  ds_read_b64_tr_b16 v[64:65], v228 offset:1568
  ds_read_b64_tr_b16 v[66:67], v228 offset:1536
  ds_read_b64_tr_b16 v[68:69], v228 offset:1696
  ds_read_b64_tr_b16 v[70:71], v228 offset:1664
  v_add_f32_dpp v112, v5, v112 wave_ror:1 row_mask:0xf bank_mask:0xf
  v_add_f32_dpp v118, v6, v118 wave_ror:1 row_mask:0xf bank_mask:0xf
  v_mfma_f32_16x16x32_bf16 v[124:127], v[28:31], v[80:83], v[124:127]
  ds_read_b64_tr_b16 v[108:109], v229 offset:1792
  ds_read_b64_tr_b16 v[110:111], v229 offset:1824
  s_waitcnt lgkmcnt(9)
  ds_read_b64_tr_b16 v[72:73], v228 offset:1824
  ds_read_b64_tr_b16 v[74:75], v228 offset:1792
  ds_read_b64_tr_b16 v[76:77], v228 offset:1952
  ds_read_b64_tr_b16 v[78:79], v228 offset:1920
  v_mov_b32 v4, 122880
  v_mov_b32 v12, 1
  s_mov_b64 exec, 1
  ds_add_u32 v4, v12 offset:40
  s_mov_b64 exec, -1
  v_cndmask_b32 v6, v118, v114, s[40:41]
  v_cndmask_b32 v8, v123, v119, s[40:41]
  v_mfma_f32_16x16x32_bf16 v[128:131], v[24:27], v[84:87], 0
  v_add_f32_dpp v117, v6, v117 wave_ror:1 row_mask:0xf bank_mask:0xf
  v_cndmask_b32 v6, v117, v113, s[40:41]
  v_mfma_f32_16x16x32_bf16 v[128:131], v[16:19], v[88:91], v[128:131]
  v_add_f32_dpp v122, v8, v122 wave_ror:1 row_mask:0xf bank_mask:0xf
  v_add_f32_dpp v116, v6, v116 wave_ror:1 row_mask:0xf bank_mask:0xf
  v_mfma_f32_16x16x32_bf16 v[128:131], v[32:35], v[80:83], v[128:131]
  v_cvt_pk_bf16_f32 v176, v112, v116
  v_cndmask_b32 v8, v122, v118, s[40:41]
  v_mfma_f32_16x16x32_bf16 v[132:135], v[28:31], v[84:87], 0
  v_cndmask_b32 v5, v127, v123, s[40:41]
  v_add_f32_dpp v121, v8, v121 wave_ror:1 row_mask:0xf bank_mask:0xf
  v_mfma_f32_16x16x32_bf16 v[132:135], v[20:23], v[88:91], v[132:135]
  v_cndmask_b32 v8, v121, v117, s[40:41]
  v_add_f32_dpp v126, v5, v126 wave_ror:1 row_mask:0xf bank_mask:0xf
  v_mfma_f32_16x16x32_bf16 v[132:135], v[36:39], v[80:83], v[132:135]
  v_add_f32_dpp v120, v8, v120 wave_ror:1 row_mask:0xf bank_mask:0xf
  v_cndmask_b32 v5, v126, v122, s[40:41]
  v_mfma_f32_16x16x32_bf16 v[136:139], v[32:35], v[84:87], 0
  v_cndmask_b32 v6, v131, v127, s[40:41]
  v_add_f32_dpp v125, v5, v125 wave_ror:1 row_mask:0xf bank_mask:0xf
  v_mfma_f32_16x16x32_bf16 v[136:139], v[24:27], v[88:91], v[136:139]
  v_cndmask_b32 v5, v125, v121, s[40:41]
  v_add_f32_dpp v130, v6, v130 wave_ror:1 row_mask:0xf bank_mask:0xf
  v_mfma_f32_16x16x32_bf16 v[136:139], v[16:19], v[92:95], v[136:139]
  v_add_f32_dpp v124, v5, v124 wave_ror:1 row_mask:0xf bank_mask:0xf
  v_cvt_pk_bf16_f32 v177, v120, v124
  v_mfma_f32_16x16x32_bf16 v[136:139], v[40:43], v[80:83], v[136:139]
  v_cndmask_b32 v6, v130, v126, s[40:41]
  v_cndmask_b32 v8, v135, v131, s[40:41]
  v_mfma_f32_16x16x32_bf16 v[140:143], v[36:39], v[84:87], 0
  v_add_f32_dpp v129, v6, v129 wave_ror:1 row_mask:0xf bank_mask:0xf
  v_cndmask_b32 v6, v129, v125, s[40:41]
  v_mfma_f32_16x16x32_bf16 v[140:143], v[28:31], v[88:91], v[140:143]
  v_add_f32_dpp v134, v8, v134 wave_ror:1 row_mask:0xf bank_mask:0xf
  v_add_f32_dpp v128, v6, v128 wave_ror:1 row_mask:0xf bank_mask:0xf
  v_mfma_f32_16x16x32_bf16 v[140:143], v[20:23], v[92:95], v[140:143]
  v_cndmask_b32 v8, v134, v130, s[40:41]
  v_cndmask_b32 v5, v139, v135, s[40:41]
  v_mfma_f32_16x16x32_bf16 v[140:143], v[44:47], v[80:83], v[140:143]
  v_add_f32_dpp v133, v8, v133 wave_ror:1 row_mask:0xf bank_mask:0xf
  v_cndmask_b32 v8, v133, v129, s[40:41]
  v_mfma_f32_16x16x32_bf16 v[144:147], v[40:43], v[84:87], 0
  v_add_f32_dpp v138, v5, v138 wave_ror:1 row_mask:0xf bank_mask:0xf
  v_add_f32_dpp v132, v8, v132 wave_ror:1 row_mask:0xf bank_mask:0xf
  v_mfma_f32_16x16x32_bf16 v[144:147], v[32:35], v[88:91], v[144:147]
  s_lshl_b32 s38, s25, 4
  s_add_u32 s38, s38, s55
  s_lshl_b32 s38, s38, 2
  s_add_u32 s38, s38, 7168
  v_mov_b32 v4, s38
  v_mov_b32 v12, 1
  s_mov_b64 exec, 1
  s_waitcnt vmcnt(0)
  buffer_store_dword v12, v4, s[68:71], 0 offen sc1
  s_mov_b64 exec, -1
  v_cvt_pk_bf16_f32 v178, v128, v132
  v_cndmask_b32 v5, v138, v134, s[40:41]
  v_mfma_f32_16x16x32_bf16 v[144:147], v[24:27], v[92:95], v[144:147]
  v_min_u32 v10, 2, v0
  v_add_u32 v10, s54, v10
  v_min_u32 v10, 15, v10
  s_and_b32 s31, s53, 1
  s_xor_b32 s31, s31, 1
  s_lshl_b32 s30, s52, 5
  s_add_u32 s31, s31, s30
  s_lshl_b32 s31, s31, 2
  v_lshl_add_u32 v10, v10, 3, s31
  buffer_load_dword v11, v10, s[68:71], 0 offen sc1
  v_add_f32_dpp v137, v5, v137 wave_ror:1 row_mask:0xf bank_mask:0xf
  v_cndmask_b32 v5, v137, v133, s[40:41]
  v_mfma_f32_16x16x32_bf16 v[144:147], v[16:19], v[96:99], v[144:147]
  v_cndmask_b32 v6, v143, v139, s[40:41]
  v_add_f32_dpp v136, v5, v136 wave_ror:1 row_mask:0xf bank_mask:0xf
  v_mfma_f32_16x16x32_bf16 v[144:147], v[48:51], v[80:83], v[144:147]
  v_add_f32_dpp v142, v6, v142 wave_ror:1 row_mask:0xf bank_mask:0xf
  v_cndmask_b32 v6, v142, v138, s[40:41]
  v_mfma_f32_16x16x32_bf16 v[148:151], v[44:47], v[84:87], 0
  v_mfma_f32_16x16x32_bf16 v[148:151], v[36:39], v[88:91], v[148:151]
  v_add_f32_dpp v141, v6, v141 wave_ror:1 row_mask:0xf bank_mask:0xf
  v_cndmask_b32 v6, v141, v137, s[40:41]
  v_mfma_f32_16x16x32_bf16 v[148:151], v[28:31], v[92:95], v[148:151]
  v_mfma_f32_16x16x32_bf16 v[148:151], v[20:23], v[96:99], v[148:151]
  v_add_f32_dpp v140, v6, v140 wave_ror:1 row_mask:0xf bank_mask:0xf
  v_cvt_pk_bf16_f32 v179, v136, v140
  v_mfma_f32_16x16x32_bf16 v[148:151], v[52:55], v[80:83], v[148:151]
  v_cndmask_b32 v8, v147, v143, s[40:41]
  v_mfma_f32_16x16x32_bf16 v[152:155], v[48:51], v[84:87], 0
  v_mov_b32 v4, 122880
  s_mov_b32 s6, 1048576
lw21:
  ds_read_b32 v12, v4 offset:40
  s_waitcnt lgkmcnt(0)
  v_readfirstlane_b32 s7, v12
  s_nop 1
  s_cmp_ge_u32 s7, 4
  s_cbranch_scc1 lw21_ok
  s_sub_u32 s6, s6, 1
  s_cmp_eq_u32 s6, 0
  s_cbranch_scc1 lw21_ok
  s_sleep 1
  s_branch lw21
lw21_ok:
  ds_write_b16 v9, v176 offset:0
  ds_write_b16_d16_hi v9, v176 offset:512
  v_mfma_f32_16x16x32_bf16 v[152:155], v[40:43], v[88:91], v[152:155]
  v_add_f32_dpp v146, v8, v146 wave_ror:1 row_mask:0xf bank_mask:0xf
  v_cndmask_b32 v8, v146, v142, s[40:41]
  ds_write_b16 v9, v177 offset:1024
  ds_write_b16_d16_hi v9, v177 offset:1536
  v_mfma_f32_16x16x32_bf16 v[152:155], v[32:35], v[92:95], v[152:155]
  v_add_f32_dpp v145, v8, v145 wave_ror:1 row_mask:0xf bank_mask:0xf
  v_cndmask_b32 v8, v145, v141, s[40:41]
  ds_write_b16 v9, v178 offset:2048
  ds_write_b16_d16_hi v9, v178 offset:2560
  v_mfma_f32_16x16x32_bf16 v[152:155], v[24:27], v[96:99], v[152:155]
  v_add_f32_dpp v144, v8, v144 wave_ror:1 row_mask:0xf bank_mask:0xf
  v_cndmask_b32 v5, v151, v147, s[40:41]
  ds_write_b16 v9, v179 offset:3072
  ds_write_b16_d16_hi v9, v179 offset:3584
  v_mfma_f32_16x16x32_bf16 v[152:155], v[16:19], v[100:103], v[152:155]
  v_add_f32_dpp v150, v5, v150 wave_ror:1 row_mask:0xf bank_mask:0xf
  v_mfma_f32_16x16x32_bf16 v[152:155], v[56:59], v[80:83], v[152:155]
  v_cndmask_b32 v5, v150, v146, s[40:41]
  v_mfma_f32_16x16x32_bf16 v[156:159], v[52:55], v[84:87], 0
  v_mfma_f32_16x16x32_bf16 v[156:159], v[44:47], v[88:91], v[156:159]
  v_add_f32_dpp v149, v5, v149 wave_ror:1 row_mask:0xf bank_mask:0xf
  v_cndmask_b32 v5, v149, v145, s[40:41]
  v_mfma_f32_16x16x32_bf16 v[156:159], v[36:39], v[92:95], v[156:159]
  v_mfma_f32_16x16x32_bf16 v[156:159], v[28:31], v[96:99], v[156:159]
  v_add_f32_dpp v148, v5, v148 wave_ror:1 row_mask:0xf bank_mask:0xf
  v_cvt_pk_bf16_f32 v180, v144, v148
  ds_write_b16 v9, v180 offset:4096
  ds_write_b16_d16_hi v9, v180 offset:4608
  v_mfma_f32_16x16x32_bf16 v[156:159], v[20:23], v[100:103], v[156:159]
  v_cndmask_b32 v6, v155, v151, s[40:41]
  v_mfma_f32_16x16x32_bf16 v[156:159], v[60:63], v[80:83], v[156:159]
  v_mfma_f32_16x16x32_bf16 v[160:163], v[56:59], v[84:87], 0
  v_add_f32_dpp v154, v6, v154 wave_ror:1 row_mask:0xf bank_mask:0xf
  v_cndmask_b32 v6, v154, v150, s[40:41]
  v_mfma_f32_16x16x32_bf16 v[160:163], v[48:51], v[88:91], v[160:163]
  v_mfma_f32_16x16x32_bf16 v[160:163], v[40:43], v[92:95], v[160:163]
  v_add_f32_dpp v153, v6, v153 wave_ror:1 row_mask:0xf bank_mask:0xf
  v_cndmask_b32 v6, v153, v149, s[40:41]
  v_mfma_f32_16x16x32_bf16 v[160:163], v[32:35], v[96:99], v[160:163]
  v_cndmask_b32 v8, v159, v155, s[40:41]
  v_add_f32_dpp v152, v6, v152 wave_ror:1 row_mask:0xf bank_mask:0xf
  v_mfma_f32_16x16x32_bf16 v[160:163], v[24:27], v[100:103], v[160:163]
  v_add_f32_dpp v158, v8, v158 wave_ror:1 row_mask:0xf bank_mask:0xf
  v_mfma_f32_16x16x32_bf16 v[160:163], v[16:19], v[104:107], v[160:163]
  v_cndmask_b32 v8, v158, v154, s[40:41]
  v_mfma_f32_16x16x32_bf16 v[160:163], v[64:67], v[80:83], v[160:163]
  v_mfma_f32_16x16x32_bf16 v[164:167], v[60:63], v[84:87], 0
  v_add_f32_dpp v157, v8, v157 wave_ror:1 row_mask:0xf bank_mask:0xf
  v_cndmask_b32 v8, v157, v153, s[40:41]
  v_mfma_f32_16x16x32_bf16 v[164:167], v[52:55], v[88:91], v[164:167]
  v_mfma_f32_16x16x32_bf16 v[164:167], v[44:47], v[92:95], v[164:167]
  v_add_f32_dpp v156, v8, v156 wave_ror:1 row_mask:0xf bank_mask:0xf
  v_cvt_pk_bf16_f32 v181, v152, v156
  ds_write_b16 v9, v181 offset:5120
  ds_write_b16_d16_hi v9, v181 offset:5632
  v_mfma_f32_16x16x32_bf16 v[164:167], v[36:39], v[96:99], v[164:167]
  v_cndmask_b32 v5, v163, v159, s[40:41]
  v_mfma_f32_16x16x32_bf16 v[164:167], v[28:31], v[100:103], v[164:167]
  v_mfma_f32_16x16x32_bf16 v[164:167], v[20:23], v[104:107], v[164:167]
  v_add_f32_dpp v162, v5, v162 wave_ror:1 row_mask:0xf bank_mask:0xf
  v_mfma_f32_16x16x32_bf16 v[164:167], v[68:71], v[80:83], v[164:167]
  v_cndmask_b32 v5, v162, v158, s[40:41]
  v_mfma_f32_16x16x32_bf16 v[168:171], v[64:67], v[84:87], 0
  v_mfma_f32_16x16x32_bf16 v[168:171], v[56:59], v[88:91], v[168:171]
  v_add_f32_dpp v161, v5, v161 wave_ror:1 row_mask:0xf bank_mask:0xf
  v_cndmask_b32 v5, v161, v157, s[40:41]
  v_mfma_f32_16x16x32_bf16 v[168:171], v[48:51], v[92:95], v[168:171]
  v_mfma_f32_16x16x32_bf16 v[168:171], v[40:43], v[96:99], v[168:171]
  v_add_f32_dpp v160, v5, v160 wave_ror:1 row_mask:0xf bank_mask:0xf
  v_cndmask_b32 v6, v167, v163, s[40:41]
  v_mfma_f32_16x16x32_bf16 v[168:171], v[32:35], v[100:103], v[168:171]
  v_mfma_f32_16x16x32_bf16 v[168:171], v[24:27], v[104:107], v[168:171]
  v_add_f32_dpp v166, v6, v166 wave_ror:1 row_mask:0xf bank_mask:0xf
  v_mfma_f32_16x16x32_bf16 v[168:171], v[16:19], v[108:111], v[168:171]
  v_cndmask_b32 v6, v166, v162, s[40:41]
  v_mfma_f32_16x16x32_bf16 v[168:171], v[72:75], v[80:83], v[168:171]
  v_mfma_f32_16x16x32_bf16 v[172:175], v[68:71], v[84:87], 0
  v_add_f32_dpp v165, v6, v165 wave_ror:1 row_mask:0xf bank_mask:0xf
  v_cndmask_b32 v6, v165, v161, s[40:41]
  v_mfma_f32_16x16x32_bf16 v[172:175], v[60:63], v[88:91], v[172:175]
  v_mfma_f32_16x16x32_bf16 v[172:175], v[52:55], v[92:95], v[172:175]
  v_add_f32_dpp v164, v6, v164 wave_ror:1 row_mask:0xf bank_mask:0xf
  v_cvt_pk_bf16_f32 v182, v160, v164
  ds_write_b16 v9, v182 offset:6144
  ds_write_b16_d16_hi v9, v182 offset:6656
  v_mfma_f32_16x16x32_bf16 v[172:175], v[44:47], v[96:99], v[172:175]
  v_cndmask_b32 v8, v171, v167, s[40:41]
  v_mfma_f32_16x16x32_bf16 v[172:175], v[36:39], v[100:103], v[172:175]
  v_mfma_f32_16x16x32_bf16 v[172:175], v[28:31], v[104:107], v[172:175]
  v_add_f32_dpp v170, v8, v170 wave_ror:1 row_mask:0xf bank_mask:0xf
  v_mfma_f32_16x16x32_bf16 v[172:175], v[20:23], v[108:111], v[172:175]
  v_cndmask_b32 v8, v170, v166, s[40:41]
  v_mfma_f32_16x16x32_bf16 v[172:175], v[76:79], v[80:83], v[172:175]
  s_nop 0
  v_add_f32_dpp v169, v8, v169 wave_ror:1 row_mask:0xf bank_mask:0xf
  v_cndmask_b32 v8, v169, v165, s[40:41]
  s_nop 1
  v_add_f32_dpp v168, v8, v168 wave_ror:1 row_mask:0xf bank_mask:0xf
  s_nop 1
  v_cndmask_b32 v5, v175, v171, s[40:41]
  s_nop 1
  v_add_f32_dpp v174, v5, v174 wave_ror:1 row_mask:0xf bank_mask:0xf
  v_cndmask_b32 v5, v174, v170, s[40:41]
  s_nop 1
  v_add_f32_dpp v173, v5, v173 wave_ror:1 row_mask:0xf bank_mask:0xf
  v_cndmask_b32 v5, v173, v169, s[40:41]
  s_nop 1
  v_add_f32_dpp v172, v5, v172 wave_ror:1 row_mask:0xf bank_mask:0xf
  v_cvt_pk_bf16_f32 v183, v168, v172
  ds_write_b16 v9, v183 offset:7168
  s_waitcnt lgkmcnt(10)
  ds_write_b16_d16_hi v9, v183 offset:7680
  v_mov_b32 v5, 122880
  v_mov_b32 v6, 1
  s_mov_b64 exec, 1
  ds_add_u32 v5, v6 offset:32
  s_mov_b64 exec, -1
  s_and_b32 s31, s3, 3
  s_lshl_b32 s31, s31, 11
  s_add_u32 s31, s31, 0
  v_add_u32 v6, s31, v2
  s_add_u32 s20, s98, 0x1000000
  s_addc_u32 s21, s99, 0
  s_mov_b32 s22, 0x400000
  s_mov_b32 s23, 0x00020000
  v_lshrrev_b32 v4, 4, v0
  v_and_b32 v246, 15, v0
  v_lshlrev_b32 v246, 4, v246
  v_lshl_add_u32 v246, v4, 12, v246
  s_andn2_b32 s42, s43, 0xc0
  s_lshl_b32 s31, s26, 15
  s_add_u32 s42, s42, s31
  v_mov_b32 v4, 122880
  s_mov_b32 s6, 1048576
lw22:
  ds_read_b32 v5, v4 offset:32
  s_waitcnt lgkmcnt(0)
  v_readfirstlane_b32 s7, v5
  s_nop 1
  s_cmp_ge_u32 s7, 4
  s_cbranch_scc1 lw22_ok
  s_sub_u32 s6, s6, 1
  s_cmp_eq_u32 s6, 0
  s_cbranch_scc1 lw22_ok
  s_sleep 1
  s_branch lw22
lw22_ok:
  ds_read_b128 v[16:19], v6 offset:0
  ds_read_b128 v[20:23], v6 offset:1024
  s_waitcnt vmcnt(0)
  s_mov_b32 s6, 131072
  s_branch poll23_chk
poll23:
  buffer_load_dword v11, v10, s[68:71], 0 offen sc1
  s_waitcnt vmcnt(0)
poll23_chk:
  v_cmp_gt_u32 vcc, 2, v11
  s_nop 1
  s_cmp_eq_u64 vcc, 0
  s_cbranch_scc1 poll23_ok
  s_sub_u32 s6, s6, 1
  s_cmp_eq_u32 s6, 0
  s_cbranch_scc1 poll23_ok
  s_sleep 1
  s_branch poll23
poll23_ok:
  s_waitcnt lgkmcnt(0)
  s_add_u32 s30, s42, 0
  s_add_u32 s31, s42, 16384
  s_cmp_eq_u32 s49, 1
  s_cbranch_scc0 du24g
  buffer_store_dwordx4 v[16:19], v246, s[20:23], s30 offen
  buffer_store_dwordx4 v[20:23], v246, s[20:23], s31 offen
  s_branch du24d
du24g:
  buffer_store_dwordx4 v[16:19], v246, s[20:23], s30 offen sc1
  buffer_store_dwordx4 v[20:23], v246, s[20:23], s31 offen sc1
du24d:
  s_lshl2_add_u32 s39, s56, s3
  s_lshl_b32 s39, s39, 6
  s_add_u32 s39, s39, 6912
  s_load_dwordx16 s[76:91], s[68:69], s39 glc
  s_and_b32 s37, s3, 3
  s_lshl_b32 s33, s37, 10
  s_add_u32 s32, s37, 4
  v_and_b32 v17, 15, v0
  v_lshrrev_b32 v12, 4, v0
  s_and_b32 s28, s3, 3
  v_lshlrev_b32 v16, 9, v12
  v_lshl_add_u32 v216, v17, 4, v16
  v_lshrrev_b32 v13, 1, v12
  v_and_b32 v12, 1, v12
  v_bfe_u32 v14, v0, 2, 2
  v_lshlrev_b32 v15, 4, v13
  v_lshl_add_u32 v15, v12, 2, v15
  v_add_u32 v15, v15, v14
  v_lshlrev_b32 v15, 7, v15
  v_bfe_u32 v16, v0, 1, 1
  v_lshrrev_b32 v14, 1, v14
  v_lshl_add_u32 v16, v14, 2, v16
  v_lshl_add_u32 v16, v12, 1, v16
  v_lshl_add_u32 v15, v16, 4, v15
  v_and_b32 v16, 1, v0
  v_lshl_add_u32 v15, v16, 3, v15
  v_add_u32 v218, 114688, v15
  v_xor_b32 v219, 32, v218
  v_xor_b32 v220, 64, v218
  v_xor_b32 v221, 96, v218
  s_lshl_b32 s31, s28, 13
  s_add_u32 s31, s31, 49152
  v_lshl_add_u32 v222, v0, 4, s31
  s_lshl_b32 s31, s56, 7
  s_lshl_b32 s30, s28, 5
  s_add_u32 s31, s31, s30
  v_add_u32 v17, s31, v17
  v_lshlrev_b32 v17, 12, v17
  v_lshl_add_u32 v17, v12, 5, v17
  v_lshl_add_u32 v224, v13, 4, v17
  s_lshl_b32 s35, s56, 2
  s_add_u32 s35, s35, s37
  s_lshl_b32 s35, s35, 16
  s_add_u32 s8, s98, 0xc00000
  s_addc_u32 s9, s99, 0
  s_mov_b32 s10, 0x400000
  s_mov_b32 s11, 0x00020000
  s_mov_b32 s20, s94
  s_mov_b32 s21, s95
  s_mov_b32 s22, 0x800000
  s_mov_b32 s23, 0x00020000
  s_lshl_b32 s36, s57, 7
  s_add_u32 s36, s36, 2048
  s_add_u32 s34, s36, 65536
  s_waitcnt vmcnt(0)
  s_add_u32 s38, s51, 0
  s_mov_b32 s31, 3
  s_cmp_eq_u32 s49, 1
  s_cbranch_scc0 du25g
  v_mov_b32 v4, 122880
  v_mov_b32 v5, 1
  s_mov_b64 exec, 1
  ds_add_rtn_u32 v4, v4, v5 offset:52
  s_waitcnt lgkmcnt(0)
  v_readfirstlane_b32 s7, v4
  s_nop 1
  s_cmp_lg_u32 s7, 3
  s_cbranch_scc1 sig26
  v_mov_b32 v4, s38
  v_mov_b32 v5, s31
  buffer_store_dword v5, v4, s[68:71], 0 offen
sig26:
  s_mov_b64 exec, -1
  s_branch du25d
du25g:
  v_mov_b32 v4, 122880
  v_mov_b32 v5, 1
  s_mov_b64 exec, 1
  ds_add_rtn_u32 v4, v4, v5 offset:52
  s_waitcnt lgkmcnt(0)
  v_readfirstlane_b32 s7, v4
  s_nop 1
  s_cmp_lg_u32 s7, 3
  s_cbranch_scc1 sig27
  v_mov_b32 v4, s38
  v_mov_b32 v5, s31
  buffer_store_dword v5, v4, s[68:71], 0 offen sc1
sig27:
  s_mov_b64 exec, -1
du25d:
  s_mov_b32 s6, 131072
  s_branch sp28_chk
sp28:
  s_load_dwordx16 s[76:91], s[68:69], s39 glc
sp28_chk:
  s_waitcnt lgkmcnt(0)
  s_and_b64 s[76:77], s[76:77], s[84:85]
  s_and_b64 s[78:79], s[78:79], s[86:87]
  s_and_b64 s[80:81], s[80:81], s[88:89]
  s_and_b64 s[82:83], s[82:83], s[90:91]
  s_and_b64 s[76:77], s[76:77], s[80:81]
  s_and_b64 s[78:79], s[78:79], s[82:83]
  s_and_b64 s[76:77], s[76:77], s[78:79]
  s_and_b32 s76, s76, s77
  s_cbranch_scc1 sp28_ok
  s_sub_u32 s6, s6, 1
  s_cmp_eq_u32 s6, 0
  s_cbranch_scc1 sp28_ok
  s_sleep 2
  s_branch sp28
sp28_ok:
  s_add_u32 s38, s59, 0
  s_and_b32 s38, s38, 15
  s_lshl_b32 s38, s38, 12
  s_add_u32 s38, s38, s35
  buffer_load_dwordx4 v[80:83], v216, s[8:11], s38 offen offset:2048
  buffer_load_dwordx4 v[84:87], v216, s[8:11], s38 offen offset:2304
  s_add_u32 s38, s59, 1
  s_and_b32 s38, s38, 15
  s_lshl_b32 s38, s38, 12
  s_add_u32 s38, s38, s35
  buffer_load_dwordx4 v[88:91], v216, s[8:11], s38 offen offset:2048
  buffer_load_dwordx4 v[92:95], v216, s[8:11], s38 offen offset:2304
  s_add_u32 s38, s59, 2
  s_and_b32 s38, s38, 15
  s_lshl_b32 s38, s38, 12
  s_add_u32 s38, s38, s35
  buffer_load_dwordx4 v[96:99], v216, s[8:11], s38 offen offset:2048
  buffer_load_dwordx4 v[100:103], v216, s[8:11], s38 offen offset:2304
  s_add_u32 s38, s59, 3
  s_and_b32 s38, s38, 15
  s_lshl_b32 s38, s38, 12
  s_add_u32 s38, s38, s35
  buffer_load_dwordx4 v[104:107], v216, s[8:11], s38 offen offset:2048
  buffer_load_dwordx4 v[108:111], v216, s[8:11], s38 offen offset:2304
  s_setprio 0
  v_mov_b32 v4, 122880
  s_mov_b32 s6, 1048576
lw29:
  ds_read_b32 v5, v4 offset:44
  s_waitcnt lgkmcnt(0)
  v_readfirstlane_b32 s7, v5
  s_nop 1
  s_cmp_ge_u32 s7, 4
  s_cbranch_scc1 lw29_ok
  s_sub_u32 s6, s6, 1
  s_cmp_eq_u32 s6, 0
  s_cbranch_scc1 lw29_ok
  s_sleep 1
  s_branch lw29
lw29_ok:
  ds_read_b64_tr_b16 v[16:17], v218 offset:0
  ds_read_b64_tr_b16 v[18:19], v218 offset:1024
  ds_read_b64_tr_b16 v[20:21], v219 offset:0
  ds_read_b64_tr_b16 v[22:23], v219 offset:1024
  ds_read_b64_tr_b16 v[24:25], v220 offset:0
  ds_read_b64_tr_b16 v[26:27], v220 offset:1024
  ds_read_b64_tr_b16 v[28:29], v221 offset:0
  ds_read_b64_tr_b16 v[30:31], v221 offset:1024
  s_waitcnt vmcnt(6)
  s_waitcnt lgkmcnt(6)
  v_mfma_f32_16x16x32_bf16 v[48:51], v[16:19], v[80:83], 0
  ds_read_b64_tr_b16 v[32:33], v218 offset:4096
  v_mfma_f32_16x16x32_bf16 v[64:67], v[16:19], v[84:87], 0
  ds_read_b64_tr_b16 v[34:35], v218 offset:5120
  s_waitcnt lgkmcnt(6)
  v_mfma_f32_16x16x32_bf16 v[52:55], v[20:23], v[80:83], 0
  ds_read_b64_tr_b16 v[36:37], v219 offset:4096
  v_mfma_f32_16x16x32_bf16 v[68:71], v[20:23], v[84:87], 0
  ds_read_b64_tr_b16 v[38:39], v219 offset:5120
  s_waitcnt lgkmcnt(6)
  v_mfma_f32_16x16x32_bf16 v[56:59], v[24:27], v[80:83], 0
  ds_read_b64_tr_b16 v[40:41], v220 offset:4096
  v_mfma_f32_16x16x32_bf16 v[72:75], v[24:27], v[84:87], 0
  ds_read_b64_tr_b16 v[42:43], v220 offset:5120
  s_waitcnt lgkmcnt(6)
  v_mfma_f32_16x16x32_bf16 v[60:63], v[28:31], v[80:83], 0
  ds_read_b64_tr_b16 v[44:45], v221 offset:4096
  v_mfma_f32_16x16x32_bf16 v[76:79], v[28:31], v[84:87], 0
  ds_read_b64_tr_b16 v[46:47], v221 offset:5120
  s_add_u32 s38, s59, 4
  s_and_b32 s38, s38, 15
  s_lshl_b32 s38, s38, 12
  s_add_u32 s38, s38, s35
  buffer_load_dwordx4 v[112:115], v216, s[8:11], s38 offen offset:2048
  buffer_load_dwordx4 v[116:119], v216, s[8:11], s38 offen offset:2304
  s_waitcnt vmcnt(6)
  s_waitcnt lgkmcnt(6)
  v_mfma_f32_16x16x32_bf16 v[48:51], v[32:35], v[88:91], v[48:51]
  ds_read_b64_tr_b16 v[16:17], v218 offset:12288
  v_mfma_f32_16x16x32_bf16 v[64:67], v[32:35], v[92:95], v[64:67]
  ds_read_b64_tr_b16 v[18:19], v218 offset:13312
  s_waitcnt lgkmcnt(6)
  v_mfma_f32_16x16x32_bf16 v[52:55], v[36:39], v[88:91], v[52:55]
  ds_read_b64_tr_b16 v[20:21], v219 offset:12288
  v_mfma_f32_16x16x32_bf16 v[68:71], v[36:39], v[92:95], v[68:71]
  ds_read_b64_tr_b16 v[22:23], v219 offset:13312
  s_waitcnt lgkmcnt(6)
  v_mfma_f32_16x16x32_bf16 v[56:59], v[40:43], v[88:91], v[56:59]
  ds_read_b64_tr_b16 v[24:25], v220 offset:12288
  v_mfma_f32_16x16x32_bf16 v[72:75], v[40:43], v[92:95], v[72:75]
  ds_read_b64_tr_b16 v[26:27], v220 offset:13312
  s_waitcnt lgkmcnt(6)
  v_mfma_f32_16x16x32_bf16 v[60:63], v[44:47], v[88:91], v[60:63]
  ds_read_b64_tr_b16 v[28:29], v221 offset:12288
  v_mfma_f32_16x16x32_bf16 v[76:79], v[44:47], v[92:95], v[76:79]
  ds_read_b64_tr_b16 v[30:31], v221 offset:13312
  s_add_u32 s38, s59, 5
  s_and_b32 s38, s38, 15
  s_lshl_b32 s38, s38, 12
  s_add_u32 s38, s38, s35
  buffer_load_dwordx4 v[120:123], v216, s[8:11], s38 offen offset:2048
  buffer_load_dwordx4 v[124:127], v216, s[8:11], s38 offen offset:2304
  s_waitcnt vmcnt(6)
  s_waitcnt lgkmcnt(6)
  v_mfma_f32_16x16x32_bf16 v[48:51], v[16:19], v[96:99], v[48:51]
  ds_read_b64_tr_b16 v[32:33], v218 offset:16384
  v_mfma_f32_16x16x32_bf16 v[64:67], v[16:19], v[100:103], v[64:67]
  ds_read_b64_tr_b16 v[34:35], v218 offset:17408
  s_waitcnt lgkmcnt(6)
  v_mfma_f32_16x16x32_bf16 v[52:55], v[20:23], v[96:99], v[52:55]
  ds_read_b64_tr_b16 v[36:37], v219 offset:16384
  v_mfma_f32_16x16x32_bf16 v[68:71], v[20:23], v[100:103], v[68:71]
  ds_read_b64_tr_b16 v[38:39], v219 offset:17408
  s_waitcnt lgkmcnt(6)
  v_mfma_f32_16x16x32_bf16 v[56:59], v[24:27], v[96:99], v[56:59]
  ds_read_b64_tr_b16 v[40:41], v220 offset:16384
  v_mfma_f32_16x16x32_bf16 v[72:75], v[24:27], v[100:103], v[72:75]
  ds_read_b64_tr_b16 v[42:43], v220 offset:17408
  s_waitcnt lgkmcnt(6)
  v_mfma_f32_16x16x32_bf16 v[60:63], v[28:31], v[96:99], v[60:63]
  ds_read_b64_tr_b16 v[44:45], v221 offset:16384
  v_mfma_f32_16x16x32_bf16 v[76:79], v[28:31], v[100:103], v[76:79]
  ds_read_b64_tr_b16 v[46:47], v221 offset:17408
  s_add_u32 s38, s59, 6
  s_and_b32 s38, s38, 15
  s_lshl_b32 s38, s38, 12
  s_add_u32 s38, s38, s35
  buffer_load_dwordx4 v[128:131], v216, s[8:11], s38 offen offset:2048
  buffer_load_dwordx4 v[132:135], v216, s[8:11], s38 offen offset:2304
  s_waitcnt vmcnt(6)
  s_waitcnt lgkmcnt(6)
  v_mfma_f32_16x16x32_bf16 v[48:51], v[32:35], v[104:107], v[48:51]
  ds_read_b64_tr_b16 v[16:17], v218 offset:20480
  v_mfma_f32_16x16x32_bf16 v[64:67], v[32:35], v[108:111], v[64:67]
  ds_read_b64_tr_b16 v[18:19], v218 offset:21504
  s_waitcnt lgkmcnt(6)
  v_mfma_f32_16x16x32_bf16 v[52:55], v[36:39], v[104:107], v[52:55]
  ds_read_b64_tr_b16 v[20:21], v219 offset:20480
  v_mfma_f32_16x16x32_bf16 v[68:71], v[36:39], v[108:111], v[68:71]
  ds_read_b64_tr_b16 v[22:23], v219 offset:21504
  s_waitcnt lgkmcnt(6)
  v_mfma_f32_16x16x32_bf16 v[56:59], v[40:43], v[104:107], v[56:59]
  ds_read_b64_tr_b16 v[24:25], v220 offset:20480
  v_mfma_f32_16x16x32_bf16 v[72:75], v[40:43], v[108:111], v[72:75]
  ds_read_b64_tr_b16 v[26:27], v220 offset:21504
  s_waitcnt lgkmcnt(6)
  v_mfma_f32_16x16x32_bf16 v[60:63], v[44:47], v[104:107], v[60:63]
  ds_read_b64_tr_b16 v[28:29], v221 offset:20480
  v_mfma_f32_16x16x32_bf16 v[76:79], v[44:47], v[108:111], v[76:79]
  ds_read_b64_tr_b16 v[30:31], v221 offset:21504
  s_add_u32 s38, s59, 7
  s_and_b32 s38, s38, 15
  s_lshl_b32 s38, s38, 12
  s_add_u32 s38, s38, s35
  buffer_load_dwordx4 v[136:139], v216, s[8:11], s38 offen offset:2048
  buffer_load_dwordx4 v[140:143], v216, s[8:11], s38 offen offset:2304
  s_waitcnt vmcnt(6)
  s_waitcnt lgkmcnt(6)
  v_mfma_f32_16x16x32_bf16 v[48:51], v[16:19], v[112:115], v[48:51]
  ds_read_b64_tr_b16 v[32:33], v218 offset:24576
  v_mfma_f32_16x16x32_bf16 v[64:67], v[16:19], v[116:119], v[64:67]
  ds_read_b64_tr_b16 v[34:35], v218 offset:25600
  s_waitcnt lgkmcnt(6)
  v_mfma_f32_16x16x32_bf16 v[52:55], v[20:23], v[112:115], v[52:55]
  ds_read_b64_tr_b16 v[36:37], v219 offset:24576
  v_mfma_f32_16x16x32_bf16 v[68:71], v[20:23], v[116:119], v[68:71]
  ds_read_b64_tr_b16 v[38:39], v219 offset:25600
  s_waitcnt lgkmcnt(6)
  v_mfma_f32_16x16x32_bf16 v[56:59], v[24:27], v[112:115], v[56:59]
  ds_read_b64_tr_b16 v[40:41], v220 offset:24576
  v_mfma_f32_16x16x32_bf16 v[72:75], v[24:27], v[116:119], v[72:75]
  ds_read_b64_tr_b16 v[42:43], v220 offset:25600
  s_waitcnt lgkmcnt(6)
  v_mfma_f32_16x16x32_bf16 v[60:63], v[28:31], v[112:115], v[60:63]
  ds_read_b64_tr_b16 v[44:45], v221 offset:24576
  v_mfma_f32_16x16x32_bf16 v[76:79], v[28:31], v[116:119], v[76:79]
  ds_read_b64_tr_b16 v[46:47], v221 offset:25600
  s_add_u32 s38, s59, 8
  s_and_b32 s38, s38, 15
  s_lshl_b32 s38, s38, 12
  s_add_u32 s38, s38, s35
  buffer_load_dwordx4 v[80:83], v216, s[8:11], s38 offen offset:2048
  buffer_load_dwordx4 v[84:87], v216, s[8:11], s38 offen offset:2304
  s_waitcnt vmcnt(6)
  s_waitcnt lgkmcnt(6)
  v_mfma_f32_16x16x32_bf16 v[48:51], v[32:35], v[120:123], v[48:51]
  ds_read_b64_tr_b16 v[16:17], v218 offset:28672
  v_mfma_f32_16x16x32_bf16 v[64:67], v[32:35], v[124:127], v[64:67]
  ds_read_b64_tr_b16 v[18:19], v218 offset:29696
  s_waitcnt lgkmcnt(6)
  v_mfma_f32_16x16x32_bf16 v[52:55], v[36:39], v[120:123], v[52:55]
  ds_read_b64_tr_b16 v[20:21], v219 offset:28672
  v_mfma_f32_16x16x32_bf16 v[68:71], v[36:39], v[124:127], v[68:71]
  ds_read_b64_tr_b16 v[22:23], v219 offset:29696
  s_waitcnt lgkmcnt(6)
  v_mfma_f32_16x16x32_bf16 v[56:59], v[40:43], v[120:123], v[56:59]
  ds_read_b64_tr_b16 v[24:25], v220 offset:28672
  v_mfma_f32_16x16x32_bf16 v[72:75], v[40:43], v[124:127], v[72:75]
  ds_read_b64_tr_b16 v[26:27], v220 offset:29696
  s_waitcnt lgkmcnt(6)
  v_mfma_f32_16x16x32_bf16 v[60:63], v[44:47], v[120:123], v[60:63]
  ds_read_b64_tr_b16 v[28:29], v221 offset:28672
  v_mfma_f32_16x16x32_bf16 v[76:79], v[44:47], v[124:127], v[76:79]
  ds_read_b64_tr_b16 v[30:31], v221 offset:29696
  s_add_u32 s38, s59, 9
  s_and_b32 s38, s38, 15
  s_lshl_b32 s38, s38, 12
  s_add_u32 s38, s38, s35
  buffer_load_dwordx4 v[88:91], v216, s[8:11], s38 offen offset:2048
  buffer_load_dwordx4 v[92:95], v216, s[8:11], s38 offen offset:2304
  s_waitcnt vmcnt(6)
  s_waitcnt lgkmcnt(6)
  v_mfma_f32_16x16x32_bf16 v[48:51], v[16:19], v[128:131], v[48:51]
  ds_read_b64_tr_b16 v[32:33], v218 offset:32768
  v_mfma_f32_16x16x32_bf16 v[64:67], v[16:19], v[132:135], v[64:67]
  ds_read_b64_tr_b16 v[34:35], v218 offset:33792
  s_waitcnt lgkmcnt(6)
  v_mfma_f32_16x16x32_bf16 v[52:55], v[20:23], v[128:131], v[52:55]
  ds_read_b64_tr_b16 v[36:37], v219 offset:32768
  v_mfma_f32_16x16x32_bf16 v[68:71], v[20:23], v[132:135], v[68:71]
  ds_read_b64_tr_b16 v[38:39], v219 offset:33792
  s_waitcnt lgkmcnt(6)
  v_mfma_f32_16x16x32_bf16 v[56:59], v[24:27], v[128:131], v[56:59]
  ds_read_b64_tr_b16 v[40:41], v220 offset:32768
  v_mfma_f32_16x16x32_bf16 v[72:75], v[24:27], v[132:135], v[72:75]
  ds_read_b64_tr_b16 v[42:43], v220 offset:33792
  s_waitcnt lgkmcnt(6)
  v_mfma_f32_16x16x32_bf16 v[60:63], v[28:31], v[128:131], v[60:63]
  ds_read_b64_tr_b16 v[44:45], v221 offset:32768
  v_mfma_f32_16x16x32_bf16 v[76:79], v[28:31], v[132:135], v[76:79]
  ds_read_b64_tr_b16 v[46:47], v221 offset:33792
  s_add_u32 s38, s59, 10
  s_and_b32 s38, s38, 15
  s_lshl_b32 s38, s38, 12
  s_add_u32 s38, s38, s35
  buffer_load_dwordx4 v[96:99], v216, s[8:11], s38 offen offset:2048
  buffer_load_dwordx4 v[100:103], v216, s[8:11], s38 offen offset:2304
  s_waitcnt vmcnt(6)
  s_waitcnt lgkmcnt(6)
  v_mfma_f32_16x16x32_bf16 v[48:51], v[32:35], v[136:139], v[48:51]
  ds_read_b64_tr_b16 v[16:17], v218 offset:36864
  v_mfma_f32_16x16x32_bf16 v[64:67], v[32:35], v[140:143], v[64:67]
  ds_read_b64_tr_b16 v[18:19], v218 offset:37888
  s_waitcnt lgkmcnt(6)
  v_mfma_f32_16x16x32_bf16 v[52:55], v[36:39], v[136:139], v[52:55]
  ds_read_b64_tr_b16 v[20:21], v219 offset:36864
  v_mfma_f32_16x16x32_bf16 v[68:71], v[36:39], v[140:143], v[68:71]
  ds_read_b64_tr_b16 v[22:23], v219 offset:37888
  s_waitcnt lgkmcnt(6)
  v_mfma_f32_16x16x32_bf16 v[56:59], v[40:43], v[136:139], v[56:59]
  ds_read_b64_tr_b16 v[24:25], v220 offset:36864
  v_mfma_f32_16x16x32_bf16 v[72:75], v[40:43], v[140:143], v[72:75]
  ds_read_b64_tr_b16 v[26:27], v220 offset:37888
  s_waitcnt lgkmcnt(6)
  v_mfma_f32_16x16x32_bf16 v[60:63], v[44:47], v[136:139], v[60:63]
  ds_read_b64_tr_b16 v[28:29], v221 offset:36864
  v_mfma_f32_16x16x32_bf16 v[76:79], v[44:47], v[140:143], v[76:79]
  ds_read_b64_tr_b16 v[30:31], v221 offset:37888
  s_add_u32 s38, s59, 11
  s_and_b32 s38, s38, 15
  s_lshl_b32 s38, s38, 12
  s_add_u32 s38, s38, s35
  buffer_load_dwordx4 v[104:107], v216, s[8:11], s38 offen offset:2048
  buffer_load_dwordx4 v[108:111], v216, s[8:11], s38 offen offset:2304
  s_waitcnt vmcnt(6)
  s_waitcnt lgkmcnt(6)
  v_mfma_f32_16x16x32_bf16 v[48:51], v[16:19], v[80:83], v[48:51]
  ds_read_b64_tr_b16 v[32:33], v218 offset:40960
  v_mfma_f32_16x16x32_bf16 v[64:67], v[16:19], v[84:87], v[64:67]
  ds_read_b64_tr_b16 v[34:35], v218 offset:41984
  s_waitcnt lgkmcnt(6)
  v_mfma_f32_16x16x32_bf16 v[52:55], v[20:23], v[80:83], v[52:55]
  ds_read_b64_tr_b16 v[36:37], v219 offset:40960
  v_mfma_f32_16x16x32_bf16 v[68:71], v[20:23], v[84:87], v[68:71]
  ds_read_b64_tr_b16 v[38:39], v219 offset:41984
  s_waitcnt lgkmcnt(6)
  v_mfma_f32_16x16x32_bf16 v[56:59], v[24:27], v[80:83], v[56:59]
  ds_read_b64_tr_b16 v[40:41], v220 offset:40960
  v_mfma_f32_16x16x32_bf16 v[72:75], v[24:27], v[84:87], v[72:75]
  ds_read_b64_tr_b16 v[42:43], v220 offset:41984
  s_waitcnt lgkmcnt(6)
  v_mfma_f32_16x16x32_bf16 v[60:63], v[28:31], v[80:83], v[60:63]
  ds_read_b64_tr_b16 v[44:45], v221 offset:40960
  v_mfma_f32_16x16x32_bf16 v[76:79], v[28:31], v[84:87], v[76:79]
  ds_read_b64_tr_b16 v[46:47], v221 offset:41984
  s_add_u32 s38, s59, 12
  s_and_b32 s38, s38, 15
  s_lshl_b32 s38, s38, 12
  s_add_u32 s38, s38, s35
  buffer_load_dwordx4 v[112:115], v216, s[8:11], s38 offen offset:2048
  buffer_load_dwordx4 v[116:119], v216, s[8:11], s38 offen offset:2304
  s_waitcnt vmcnt(6)
  s_waitcnt lgkmcnt(6)
  v_mfma_f32_16x16x32_bf16 v[48:51], v[32:35], v[88:91], v[48:51]
  ds_read_b64_tr_b16 v[16:17], v218 offset:45056
  v_mfma_f32_16x16x32_bf16 v[64:67], v[32:35], v[92:95], v[64:67]
  ds_read_b64_tr_b16 v[18:19], v218 offset:46080
  s_waitcnt lgkmcnt(6)
  v_mfma_f32_16x16x32_bf16 v[52:55], v[36:39], v[88:91], v[52:55]
  ds_read_b64_tr_b16 v[20:21], v219 offset:45056
  v_mfma_f32_16x16x32_bf16 v[68:71], v[36:39], v[92:95], v[68:71]
  ds_read_b64_tr_b16 v[22:23], v219 offset:46080
  s_waitcnt lgkmcnt(6)
  v_mfma_f32_16x16x32_bf16 v[56:59], v[40:43], v[88:91], v[56:59]
  ds_read_b64_tr_b16 v[24:25], v220 offset:45056
  v_mfma_f32_16x16x32_bf16 v[72:75], v[40:43], v[92:95], v[72:75]
  ds_read_b64_tr_b16 v[26:27], v220 offset:46080
  s_waitcnt lgkmcnt(6)
  v_mfma_f32_16x16x32_bf16 v[60:63], v[44:47], v[88:91], v[60:63]
  ds_read_b64_tr_b16 v[28:29], v221 offset:45056
  v_mfma_f32_16x16x32_bf16 v[76:79], v[44:47], v[92:95], v[76:79]
  ds_read_b64_tr_b16 v[30:31], v221 offset:46080
  s_add_u32 s38, s59, 13
  s_and_b32 s38, s38, 15
  s_lshl_b32 s38, s38, 12
  s_add_u32 s38, s38, s35
  buffer_load_dwordx4 v[120:123], v216, s[8:11], s38 offen offset:2048
  buffer_load_dwordx4 v[124:127], v216, s[8:11], s38 offen offset:2304
  v_subrev_u32 v218, 86016, v218
  v_subrev_u32 v219, 86016, v219
  v_subrev_u32 v220, 86016, v220
  v_subrev_u32 v221, 86016, v221
  s_waitcnt vmcnt(6)
  s_waitcnt lgkmcnt(6)
  v_mfma_f32_16x16x32_bf16 v[48:51], v[16:19], v[96:99], v[48:51]
  ds_read_b64_tr_b16 v[32:33], v218 offset:0
  v_mfma_f32_16x16x32_bf16 v[64:67], v[16:19], v[100:103], v[64:67]
  ds_read_b64_tr_b16 v[34:35], v218 offset:1024
  s_waitcnt lgkmcnt(6)
  v_mfma_f32_16x16x32_bf16 v[52:55], v[20:23], v[96:99], v[52:55]
  ds_read_b64_tr_b16 v[36:37], v219 offset:0
  v_mfma_f32_16x16x32_bf16 v[68:71], v[20:23], v[100:103], v[68:71]
  ds_read_b64_tr_b16 v[38:39], v219 offset:1024
  s_waitcnt lgkmcnt(6)
  v_mfma_f32_16x16x32_bf16 v[56:59], v[24:27], v[96:99], v[56:59]
  ds_read_b64_tr_b16 v[40:41], v220 offset:0
  v_mfma_f32_16x16x32_bf16 v[72:75], v[24:27], v[100:103], v[72:75]
  ds_read_b64_tr_b16 v[42:43], v220 offset:1024
  s_waitcnt lgkmcnt(6)
  v_mfma_f32_16x16x32_bf16 v[60:63], v[28:31], v[96:99], v[60:63]
  ds_read_b64_tr_b16 v[44:45], v221 offset:0
  v_mfma_f32_16x16x32_bf16 v[76:79], v[28:31], v[100:103], v[76:79]
  ds_read_b64_tr_b16 v[46:47], v221 offset:1024
  s_add_u32 s38, s59, 14
  s_and_b32 s38, s38, 15
  s_lshl_b32 s38, s38, 12
  s_add_u32 s38, s38, s35
  buffer_load_dwordx4 v[128:131], v216, s[8:11], s38 offen offset:2048
  buffer_load_dwordx4 v[132:135], v216, s[8:11], s38 offen offset:2304
  s_waitcnt vmcnt(6)
  s_waitcnt lgkmcnt(6)
  v_mfma_f32_16x16x32_bf16 v[48:51], v[32:35], v[104:107], v[48:51]
  ds_read_b64_tr_b16 v[16:17], v218 offset:4096
  v_mfma_f32_16x16x32_bf16 v[64:67], v[32:35], v[108:111], v[64:67]
  ds_read_b64_tr_b16 v[18:19], v218 offset:5120
  s_waitcnt lgkmcnt(6)
  v_mfma_f32_16x16x32_bf16 v[52:55], v[36:39], v[104:107], v[52:55]
  ds_read_b64_tr_b16 v[20:21], v219 offset:4096
  v_mfma_f32_16x16x32_bf16 v[68:71], v[36:39], v[108:111], v[68:71]
  ds_read_b64_tr_b16 v[22:23], v219 offset:5120
  s_waitcnt lgkmcnt(6)
  v_mfma_f32_16x16x32_bf16 v[56:59], v[40:43], v[104:107], v[56:59]
  ds_read_b64_tr_b16 v[24:25], v220 offset:4096
  v_mfma_f32_16x16x32_bf16 v[72:75], v[40:43], v[108:111], v[72:75]
  ds_read_b64_tr_b16 v[26:27], v220 offset:5120
  s_waitcnt lgkmcnt(6)
  v_mfma_f32_16x16x32_bf16 v[60:63], v[44:47], v[104:107], v[60:63]
  ds_read_b64_tr_b16 v[28:29], v221 offset:4096
  v_mfma_f32_16x16x32_bf16 v[76:79], v[44:47], v[108:111], v[76:79]
  ds_read_b64_tr_b16 v[30:31], v221 offset:5120
  s_add_u32 s38, s59, 15
  s_and_b32 s38, s38, 15
  s_lshl_b32 s38, s38, 12
  s_add_u32 s38, s38, s35
  buffer_load_dwordx4 v[136:139], v216, s[8:11], s38 offen offset:2048
  buffer_load_dwordx4 v[140:143], v216, s[8:11], s38 offen offset:2304
  s_waitcnt vmcnt(6)
  s_waitcnt lgkmcnt(6)
  v_mfma_f32_16x16x32_bf16 v[48:51], v[16:19], v[112:115], v[48:51]
  ds_read_b64_tr_b16 v[32:33], v218 offset:8192
  v_mfma_f32_16x16x32_bf16 v[64:67], v[16:19], v[116:119], v[64:67]
  ds_read_b64_tr_b16 v[34:35], v218 offset:9216
  s_waitcnt lgkmcnt(6)
  v_mfma_f32_16x16x32_bf16 v[52:55], v[20:23], v[112:115], v[52:55]
  ds_read_b64_tr_b16 v[36:37], v219 offset:8192
  v_mfma_f32_16x16x32_bf16 v[68:71], v[20:23], v[116:119], v[68:71]
  ds_read_b64_tr_b16 v[38:39], v219 offset:9216
  s_waitcnt lgkmcnt(6)
  v_mfma_f32_16x16x32_bf16 v[56:59], v[24:27], v[112:115], v[56:59]
  ds_read_b64_tr_b16 v[40:41], v220 offset:8192
  v_mfma_f32_16x16x32_bf16 v[72:75], v[24:27], v[116:119], v[72:75]
  ds_read_b64_tr_b16 v[42:43], v220 offset:9216
  s_waitcnt lgkmcnt(6)
  v_mfma_f32_16x16x32_bf16 v[60:63], v[28:31], v[112:115], v[60:63]
  ds_read_b64_tr_b16 v[44:45], v221 offset:8192
  v_mfma_f32_16x16x32_bf16 v[76:79], v[28:31], v[116:119], v[76:79]
  ds_read_b64_tr_b16 v[46:47], v221 offset:9216
  v_mov_b32 v4, 122880
  s_mov_b32 s6, 1048576
lw30:
  ds_read_b32 v5, v4 offset:60
  s_waitcnt lgkmcnt(0)
  v_readfirstlane_b32 s7, v5
  s_nop 1
  s_cmp_ge_u32 s7, 4
  s_cbranch_scc1 lw30_ok
  s_sub_u32 s6, s6, 1
  s_cmp_eq_u32 s6, 0
  s_cbranch_scc1 lw30_ok
  s_sleep 1
  s_branch lw30
lw30_ok:
  ds_read_b128 v[144:147], v222 offset:0
  ds_read_b128 v[148:151], v222 offset:1024
  ds_read_b128 v[152:155], v222 offset:2048
  ds_read_b128 v[156:159], v222 offset:3072
  ds_read_b128 v[160:163], v222 offset:4096
  ds_read_b128 v[164:167], v222 offset:5120
  ds_read_b128 v[168:171], v222 offset:6144
  ds_read_b128 v[172:175], v222 offset:7168
  s_waitcnt vmcnt(4)
  v_mfma_f32_16x16x32_bf16 v[48:51], v[32:35], v[120:123], v[48:51]
  ds_read_b64_tr_b16 v[16:17], v218 offset:12288
  v_mfma_f32_16x16x32_bf16 v[64:67], v[32:35], v[124:127], v[64:67]
  ds_read_b64_tr_b16 v[18:19], v218 offset:13312
  v_mfma_f32_16x16x32_bf16 v[52:55], v[36:39], v[120:123], v[52:55]
  ds_read_b64_tr_b16 v[20:21], v219 offset:12288
  v_mfma_f32_16x16x32_bf16 v[68:71], v[36:39], v[124:127], v[68:71]
  ds_read_b64_tr_b16 v[22:23], v219 offset:13312
  v_mfma_f32_16x16x32_bf16 v[56:59], v[40:43], v[120:123], v[56:59]
  ds_read_b64_tr_b16 v[24:25], v220 offset:12288
  v_mfma_f32_16x16x32_bf16 v[72:75], v[40:43], v[124:127], v[72:75]
  ds_read_b64_tr_b16 v[26:27], v220 offset:13312
  v_mfma_f32_16x16x32_bf16 v[60:63], v[44:47], v[120:123], v[60:63]
  ds_read_b64_tr_b16 v[28:29], v221 offset:12288
  v_mfma_f32_16x16x32_bf16 v[76:79], v[44:47], v[124:127], v[76:79]
  s_waitcnt lgkmcnt(10)
  ds_read_b64_tr_b16 v[30:31], v221 offset:13312
  s_waitcnt vmcnt(2)
  s_waitcnt lgkmcnt(6)
  v_mfma_f32_16x16x32_bf16 v[48:51], v[16:19], v[128:131], v[48:51]
  ds_read_b64_tr_b16 v[32:33], v218 offset:16384
  v_mfma_f32_16x16x32_bf16 v[64:67], v[16:19], v[132:135], v[64:67]
  ds_read_b64_tr_b16 v[34:35], v218 offset:17408
  s_waitcnt lgkmcnt(6)
  v_mfma_f32_16x16x32_bf16 v[52:55], v[20:23], v[128:131], v[52:55]
  ds_read_b64_tr_b16 v[36:37], v219 offset:16384
  v_mfma_f32_16x16x32_bf16 v[68:71], v[20:23], v[132:135], v[68:71]
  ds_read_b64_tr_b16 v[38:39], v219 offset:17408
  s_waitcnt lgkmcnt(6)
  v_mfma_f32_16x16x32_bf16 v[56:59], v[24:27], v[128:131], v[56:59]
  ds_read_b64_tr_b16 v[40:41], v220 offset:16384
  v_mfma_f32_16x16x32_bf16 v[72:75], v[24:27], v[132:135], v[72:75]
  ds_read_b64_tr_b16 v[42:43], v220 offset:17408
  s_waitcnt lgkmcnt(6)
  v_mfma_f32_16x16x32_bf16 v[60:63], v[28:31], v[128:131], v[60:63]
  ds_read_b64_tr_b16 v[44:45], v221 offset:16384
  v_mfma_f32_16x16x32_bf16 v[76:79], v[28:31], v[132:135], v[76:79]
  ds_read_b64_tr_b16 v[46:47], v221 offset:17408
  s_waitcnt vmcnt(0)
  s_waitcnt lgkmcnt(6)
  v_mfma_f32_16x16x32_bf16 v[48:51], v[32:35], v[136:139], v[48:51]
  v_mfma_f32_16x16x32_bf16 v[64:67], v[32:35], v[140:143], v[64:67]
  s_waitcnt lgkmcnt(4)
  v_mfma_f32_16x16x32_bf16 v[52:55], v[36:39], v[136:139], v[52:55]
  v_mfma_f32_16x16x32_bf16 v[68:71], v[36:39], v[140:143], v[68:71]
  s_waitcnt lgkmcnt(2)
  v_mfma_f32_16x16x32_bf16 v[56:59], v[40:43], v[136:139], v[56:59]
  v_mfma_f32_16x16x32_bf16 v[72:75], v[40:43], v[140:143], v[72:75]
  s_waitcnt lgkmcnt(0)
  v_mfma_f32_16x16x32_bf16 v[60:63], v[44:47], v[136:139], v[60:63]
  v_mfma_f32_16x16x32_bf16 v[76:79], v[44:47], v[140:143], v[76:79]
  v_add_f32 v48, v48, v144
  v_add_f32 v49, v49, v145
  v_add_f32 v50, v50, v146
  v_add_f32 v51, v51, v147
  v_cvt_pk_bf16_f32 v16, v48, v49
  v_cvt_pk_bf16_f32 v17, v50, v51
  v_add_f32 v52, v52, v148
  v_add_f32 v53, v53, v149
  v_add_f32 v54, v54, v150
  v_add_f32 v55, v55, v151
  v_cvt_pk_bf16_f32 v18, v52, v53
  v_cvt_pk_bf16_f32 v19, v54, v55
  s_nop 0
  v_permlane16_swap_b32 v16, v18
  v_permlane16_swap_b32 v17, v19
  buffer_store_dwordx4 v[16:19], v224, s[20:23], s36 offen offset:0 nt
  v_add_f32 v56, v56, v152
  v_add_f32 v57, v57, v153
  v_add_f32 v58, v58, v154
  v_add_f32 v59, v59, v155
  v_cvt_pk_bf16_f32 v20, v56, v57
  v_cvt_pk_bf16_f32 v21, v58, v59
  v_add_f32 v60, v60, v156
  v_add_f32 v61, v61, v157
  v_add_f32 v62, v62, v158
  v_add_f32 v63, v63, v159
  v_cvt_pk_bf16_f32 v22, v60, v61
  v_cvt_pk_bf16_f32 v23, v62, v63
  s_nop 0
  v_permlane16_swap_b32 v20, v22
  v_permlane16_swap_b32 v21, v23
  buffer_store_dwordx4 v[20:23], v224, s[20:23], s36 offen offset:64 nt
  v_add_f32 v64, v64, v160
  v_add_f32 v65, v65, v161
  v_add_f32 v66, v66, v162
  v_add_f32 v67, v67, v163
  v_cvt_pk_bf16_f32 v24, v64, v65
  v_cvt_pk_bf16_f32 v25, v66, v67
  v_add_f32 v68, v68, v164
  v_add_f32 v69, v69, v165
  v_add_f32 v70, v70, v166
  v_add_f32 v71, v71, v167
  v_cvt_pk_bf16_f32 v26, v68, v69
  v_cvt_pk_bf16_f32 v27, v70, v71
  s_nop 0
  v_permlane16_swap_b32 v24, v26
  v_permlane16_swap_b32 v25, v27
  buffer_store_dwordx4 v[24:27], v224, s[20:23], s34 offen offset:0 nt
  v_add_f32 v72, v72, v168
  v_add_f32 v73, v73, v169
  v_add_f32 v74, v74, v170
  v_add_f32 v75, v75, v171
  v_cvt_pk_bf16_f32 v28, v72, v73
  v_cvt_pk_bf16_f32 v29, v74, v75
  v_add_f32 v76, v76, v172
  v_add_f32 v77, v77, v173
  v_add_f32 v78, v78, v174
  v_add_f32 v79, v79, v175
  v_cvt_pk_bf16_f32 v30, v76, v77
  v_cvt_pk_bf16_f32 v31, v78, v79
  s_nop 0
  v_permlane16_swap_b32 v28, v30
  v_permlane16_swap_b32 v29, v31
  buffer_store_dwordx4 v[28:31], v224, s[20:23], s34 offen offset:64 nt
mk_fin:
mk_end:
  s_endpgm
g1_us0:
  buffer_store_dwordx4 v[216:219], v215, s[20:23], 0 offen offset:0 sc1
  buffer_store_dwordx4 v[220:223], v215, s[20:23], 0 offen offset:256 sc1
  buffer_store_dwordx4 v[224:227], v215, s[20:23], 0 offen offset:128 sc1
  buffer_store_dwordx4 v[228:231], v215, s[20:23], 0 offen offset:384 sc1
  s_branch g1_ub0
g1_us2:
  buffer_store_dwordx4 v[216:219], v215, s[20:23], 0 offen offset:0 sc1
  buffer_store_dwordx4 v[220:223], v215, s[20:23], 0 offen offset:256 sc1
  buffer_store_dwordx4 v[224:227], v215, s[20:23], 0 offen offset:128 sc1
  buffer_store_dwordx4 v[228:231], v215, s[20:23], 0 offen offset:384 sc1
  s_branch g1_ub2
g1_us4:
  buffer_store_dwordx4 v[216:219], v215, s[20:23], 0 offen offset:0 sc1
  buffer_store_dwordx4 v[220:223], v215, s[20:23], 0 offen offset:256 sc1
  buffer_store_dwordx4 v[224:227], v215, s[20:23], 0 offen offset:128 sc1
  buffer_store_dwordx4 v[228:231], v215, s[20:23], 0 offen offset:384 sc1
  s_branch g1_ub4
g1_us6:
  buffer_store_dwordx4 v[216:219], v215, s[20:23], 0 offen offset:0 sc1
  buffer_store_dwordx4 v[220:223], v215, s[20:23], 0 offen offset:256 sc1
  buffer_store_dwordx4 v[224:227], v215, s[20:23], 0 offen offset:128 sc1
  buffer_store_dwordx4 v[228:231], v215, s[20:23], 0 offen offset:384 sc1
  s_branch g1_ub6
g1_us7:
  buffer_store_dwordx4 v[216:219], v215, s[20:23], 0 offen offset:0 sc1
  buffer_store_dwordx4 v[220:223], v215, s[20:23], 0 offen offset:256 sc1
  buffer_store_dwordx4 v[224:227], v215, s[20:23], 0 offen offset:128 sc1
  buffer_store_dwordx4 v[228:231], v215, s[20:23], 0 offen offset:384 sc1
  s_branch g1_ub7
g1_us8:
  buffer_store_dwordx4 v[216:219], v215, s[20:23], 0 offen offset:0 sc1
  buffer_store_dwordx4 v[220:223], v215, s[20:23], 0 offen offset:256 sc1
  buffer_store_dwordx4 v[224:227], v215, s[20:23], 0 offen offset:128 sc1
  buffer_store_dwordx4 v[228:231], v215, s[20:23], 0 offen offset:384 sc1
  s_branch g1_ub8
g1_us9:
  buffer_store_dwordx4 v[216:219], v215, s[20:23], 0 offen offset:0 sc1
  buffer_store_dwordx4 v[220:223], v215, s[20:23], 0 offen offset:256 sc1
  buffer_store_dwordx4 v[224:227], v215, s[20:23], 0 offen offset:128 sc1
  buffer_store_dwordx4 v[228:231], v215, s[20:23], 0 offen offset:384 sc1
  s_branch g1_ub9
g1_us10:
  buffer_store_dwordx4 v[216:219], v215, s[20:23], 0 offen offset:0 sc1
  buffer_store_dwordx4 v[220:223], v215, s[20:23], 0 offen offset:256 sc1
  buffer_store_dwordx4 v[224:227], v215, s[20:23], 0 offen offset:128 sc1
  buffer_store_dwordx4 v[228:231], v215, s[20:23], 0 offen offset:384 sc1
  s_branch g1_ub10
g1_hook:
  s_cmp_lg_u32 s3, 0
  s_cbranch_scc1 g1_h2
  s_mov_b32 s6, 131072
go31:
  v_readfirstlane_b32 s7, v22
  s_nop 1
  s_cmp_lg_u32 s7, 0
  s_cbranch_scc1 go31_ok
  s_sub_u32 s6, s6, 1
  s_cmp_eq_u32 s6, 0
  s_cbranch_scc1 go31_ok
  v_mov_b32 v5, 0
  buffer_load_dword v22, v5, s[72:75], 0 offen sc1
  s_waitcnt vmcnt(0)
  s_branch go31
go31_ok:
  buffer_store_dword v253, v254, s[68:71], 0 offen sc1
  s_branch g1_hb5
g1_h2:
  s_mov_b32 m0, 123136
  s_nop 0
  buffer_load_dword v23, s[68:71], 0 offen sc1 lds
  s_branch g1_hb3
g1_uw:
  v_mov_b32 v5, 122880
  s_mov_b32 s6, 1048576
lw32:
  ds_read_b32 v21, v5 offset:72
  s_waitcnt lgkmcnt(0)
  v_readfirstlane_b32 s7, v21
  s_nop 1
  s_cmp_ge_u32 s7, 4
  s_cbranch_scc1 lw32_ok
  s_sub_u32 s6, s6, 1
  s_cmp_eq_u32 s6, 0
  s_cbranch_scc1 lw32_ok
  s_sleep 1
  s_branch lw32
lw32_ok:
  s_branch g1_ub
att_short0:
  ds_read_b128 v[8:11], v1
  ds_read_b128 v[12:15], v1 offset:512
  ds_read_b128 v[24:27], v4 offset:14336
  ds_read_b128 v[28:31], v4 offset:14848
  ds_read_b128 v[16:19], v4 offset:16384
  ds_read_b128 v[20:23], v4 offset:16896
  ds_read_b128 v[32:35], v4 offset:12288
  ds_read_b128 v[36:39], v4 offset:12800
  s_waitcnt lgkmcnt(4)
  s_cmp_le_u32 s25, 0
  s_cbranch_scc1 af0s_inv7
  v_mfma_f32_32x32x16_bf16 v[80:95], v[24:27], v[8:11], 0
af0s_back7:
  v_mfma_f32_32x32x16_bf16 v[80:95], v[28:31], v[12:15], v[80:95]
  ds_read_b128 v[24:27], v4 offset:8192
  ds_read_b128 v[28:31], v4 offset:8704
  s_waitcnt lgkmcnt(4)
  v_mfma_f32_32x32x16_bf16 v[96:111], v[16:19], v[8:11], 0
  v_mfma_f32_32x32x16_bf16 v[96:111], v[20:23], v[12:15], v[96:111]
  ds_read_b128 v[16:19], v4 offset:10240
  ds_read_b128 v[20:23], v4 offset:10752
  s_waitcnt lgkmcnt(4)
  s_cmp_le_u32 s25, 1
  s_cbranch_scc1 af0s_inv6
  v_mfma_f32_32x32x16_bf16 v[64:79], v[32:35], v[8:11], 0
af0s_back6:
  s_nop 0
  v_exp_f32 v80, v80
  v_exp_f32 v81, v81
  v_exp_f32 v82, v82
  v_exp_f32 v83, v83
  v_exp_f32 v84, v84
  v_exp_f32 v85, v85
  v_exp_f32 v86, v86
  v_exp_f32 v87, v87
  v_exp_f32 v88, v88
  v_exp_f32 v89, v89
  v_mfma_f32_32x32x16_bf16 v[64:79], v[36:39], v[12:15], v[64:79]
  v_exp_f32 v90, v90
  v_exp_f32 v91, v91
  v_exp_f32 v92, v92
  v_exp_f32 v93, v93
  v_exp_f32 v94, v94
  v_exp_f32 v95, v95
  v_cvt_pk_bf16_f32 v112, v80, v81
  v_cvt_pk_bf16_f32 v113, v82, v83
  v_cvt_pk_bf16_f32 v114, v84, v85
  v_cvt_pk_bf16_f32 v115, v86, v87
  v_cvt_pk_bf16_f32 v116, v88, v89
  v_cvt_pk_bf16_f32 v117, v90, v91
  v_cvt_pk_bf16_f32 v118, v92, v93
  v_cvt_pk_bf16_f32 v119, v94, v95
  s_waitcnt lgkmcnt(0)
  s_cmp_le_u32 s25, 2
  s_cbranch_scc1 af0s_inv5
  v_mfma_f32_32x32x16_bf16 v[80:95], v[16:19], v[8:11], 0
af0s_back5:
  v_exp_f32 v64, v64
  v_exp_f32 v65, v65
  v_exp_f32 v66, v66
  v_exp_f32 v67, v67
  v_exp_f32 v68, v68
  v_exp_f32 v69, v69
  v_exp_f32 v70, v70
  v_mfma_f32_32x32x16_bf16 v[80:95], v[20:23], v[12:15], v[80:95]
  v_exp_f32 v71, v71
  v_exp_f32 v72, v72
  v_exp_f32 v73, v73
  v_exp_f32 v74, v74
  v_exp_f32 v75, v75
  v_exp_f32 v76, v76
  v_exp_f32 v77, v77
  v_mfma_f32_16x16x32_bf16 v[208:211], v[240:243], v[112:115], 0
  v_exp_f32 v78, v78
  v_exp_f32 v79, v79
  v_cvt_pk_bf16_f32 v120, v64, v65
  v_cvt_pk_bf16_f32 v121, v66, v67
  v_mfma_f32_16x16x32_bf16 v[208:211], v[240:243], v[116:119], v[208:211]
  v_cvt_pk_bf16_f32 v122, v68, v69
  v_cvt_pk_bf16_f32 v123, v70, v71
  v_cvt_pk_bf16_f32 v124, v72, v73
  v_cvt_pk_bf16_f32 v125, v74, v75
  v_cvt_pk_bf16_f32 v126, v76, v77
  v_cvt_pk_bf16_f32 v127, v78, v79
  s_cmp_le_u32 s25, 3
  s_cbranch_scc1 af0s_inv4
  v_mfma_f32_32x32x16_bf16 v[64:79], v[24:27], v[8:11], 0
af0s_back4:
  v_exp_f32 v80, v80
  v_exp_f32 v81, v81
  v_exp_f32 v82, v82
  v_exp_f32 v83, v83
  v_exp_f32 v84, v84
  v_exp_f32 v85, v85
  v_exp_f32 v86, v86
  v_mfma_f32_32x32x16_bf16 v[64:79], v[28:31], v[12:15], v[64:79]
  v_exp_f32 v87, v87
  v_exp_f32 v88, v88
  v_exp_f32 v89, v89
  v_exp_f32 v90, v90
  v_exp_f32 v91, v91
  v_exp_f32 v92, v92
  v_exp_f32 v93, v93
  v_mfma_f32_16x16x32_bf16 v[208:211], v[240:243], v[120:123], v[208:211]
  v_exp_f32 v94, v94
  v_exp_f32 v95, v95
  v_cvt_pk_bf16_f32 v128, v80, v81
  v_cvt_pk_bf16_f32 v129, v82, v83
  v_mfma_f32_16x16x32_bf16 v[208:211], v[240:243], v[124:127], v[208:211]
  v_cvt_pk_bf16_f32 v130, v84, v85
  v_cvt_pk_bf16_f32 v131, v86, v87
  v_cvt_pk_bf16_f32 v132, v88, v89
  v_cvt_pk_bf16_f32 v133, v90, v91
  v_cvt_pk_bf16_f32 v134, v92, v93
  v_cvt_pk_bf16_f32 v135, v94, v95
  s_waitcnt vmcnt(0)
  v_mov_b32 v5, 122880
  v_mov_b32 v6, 1
  s_mov_b64 exec, 1
  ds_add_u32 v5, v6 offset:16
  s_mov_b64 exec, -1
  v_mfma_f32_16x16x32_bf16 v[208:211], v[240:243], v[128:131], v[208:211]
  s_mov_b32 s28, 0xffffffff
  s_mov_b32 s29, 0xfffffff0
  v_cndmask_b32 v64, v64, v96, s[28:29]
  s_mov_b32 s30, 0xfffffffe
  s_mov_b32 s31, 0xffffffe0
  v_cndmask_b32 v65, v65, v97, s[30:31]
  s_mov_b32 s32, 0xfffffffc
  s_mov_b32 s33, 0xffffffc0
  v_cndmask_b32 v66, v66, v98, s[32:33]
  s_mov_b32 s34, 0xfffffff8
  s_mov_b32 s35, 0xffffff80
  v_cndmask_b32 v67, v67, v99, s[34:35]
  s_mov_b32 s28, 0xffffff00
  s_mov_b32 s29, 0xfffff000
  v_cndmask_b32 v68, v68, v100, s[28:29]
  s_mov_b32 s30, 0xfffffe00
  s_mov_b32 s31, 0xffffe000
  v_cndmask_b32 v69, v69, v101, s[30:31]
  s_mov_b32 s32, 0xfffffc00
  s_mov_b32 s33, 0xffffc000
  v_cndmask_b32 v70, v70, v102, s[32:33]
  s_mov_b32 s34, 0xfffff800
  s_mov_b32 s35, 0xffff8000
  v_cndmask_b32 v71, v71, v103, s[34:35]
  s_mov_b32 s28, 0xffff0000
  s_mov_b32 s29, 0xfff00000
  v_cndmask_b32 v72, v72, v104, s[28:29]
  s_mov_b32 s30, 0xfffe0000
  s_mov_b32 s31, 0xffe00000
  v_cndmask_b32 v73, v73, v105, s[30:31]
  s_mov_b32 s32, 0xfffc0000
  s_mov_b32 s33, 0xffc00000
  v_cndmask_b32 v74, v74, v106, s[32:33]
  s_mov_b32 s34, 0xfff80000
  s_mov_b32 s35, 0xff800000
  v_cndmask_b32 v75, v75, v107, s[34:35]
  s_mov_b32 s28, 0xff000000
  s_mov_b32 s29, 0xf0000000
  v_cndmask_b32 v76, v76, v108, s[28:29]
  s_mov_b32 s30, 0xfe000000
  s_mov_b32 s31, 0xe0000000
  v_cndmask_b32 v77, v77, v109, s[30:31]
  s_mov_b32 s32, 0xfc000000
  s_mov_b32 s33, 0xc0000000
  v_cndmask_b32 v78, v78, v110, s[32:33]
  s_mov_b32 s34, 0xf8000000
  s_mov_b32 s35, 0x80000000
  v_cndmask_b32 v79, v79, v111, s[34:35]
  v_exp_f32 v64, v64
  v_exp_f32 v65, v65
  v_exp_f32 v66, v66
  v_exp_f32 v67, v67
  v_exp_f32 v68, v68
  v_exp_f32 v69, v69
  v_mfma_f32_16x16x32_bf16 v[208:211], v[240:243], v[132:135], v[208:211]
  v_exp_f32 v70, v70
  v_exp_f32 v71, v71
  v_exp_f32 v72, v72
  v_exp_f32 v73, v73
  v_exp_f32 v74, v74
  v_exp_f32 v75, v75
  v_exp_f32 v76, v76
  v_exp_f32 v77, v77
  v_exp_f32 v78, v78
  v_exp_f32 v79, v79
  v_cvt_pk_bf16_f32 v136, v64, v65
  v_cvt_pk_bf16_f32 v137, v66, v67
  v_cvt_pk_bf16_f32 v138, v68, v69
  v_cvt_pk_bf16_f32 v139, v70, v71
  v_cvt_pk_bf16_f32 v140, v72, v73
  v_cvt_pk_bf16_f32 v141, v74, v75
  v_cvt_pk_bf16_f32 v142, v76, v77
  v_cvt_pk_bf16_f32 v143, v78, v79
  v_mov_b32 v5, 122880
  s_mov_b32 s6, 1048576
lw33:
  ds_read_b32 v6, v5 offset:16
  s_waitcnt lgkmcnt(0)
  v_readfirstlane_b32 s7, v6
  s_nop 1
  s_cmp_ge_u32 s7, 4
  s_cbranch_scc1 lw33_ok
  s_sub_u32 s6, s6, 1
  s_cmp_eq_u32 s6, 0
  s_cbranch_scc1 lw33_ok
  s_sleep 1
  s_branch lw33
lw33_ok:
  ds_read_b128 v[40:43], v3 offset:14336
  ds_read_b128 v[44:47], v3 offset:14848
  ds_read_b128 v[48:51], v3 offset:12288
  ds_read_b128 v[52:55], v3 offset:12800
  ds_read_b128 v[56:59], v3 offset:10240
  ds_read_b128 v[60:63], v3 offset:10752
  s_waitcnt lgkmcnt(4)
  v_mfma_f32_32x32x16_bf16 v[192:207], v[40:43], v[112:115], 0
  v_and_b32 v176, v232, v136
  v_and_b32 v177, v233, v137
  v_and_b32 v178, v234, v138
  v_mfma_f32_32x32x16_bf16 v[192:207], v[44:47], v[116:119], v[192:207]
  ds_read_b128 v[40:43], v3 offset:16384
  ds_read_b128 v[44:47], v3 offset:16896
  v_and_b32 v179, v235, v139
  v_and_b32 v180, v236, v140
  s_waitcnt lgkmcnt(4)
  v_mfma_f32_32x32x16_bf16 v[192:207], v[48:51], v[120:123], v[192:207]
  v_and_b32 v181, v237, v141
  v_and_b32 v182, v238, v142
  v_mfma_f32_32x32x16_bf16 v[192:207], v[52:55], v[124:127], v[192:207]
  ds_read_b128 v[48:51], v3 offset:8192
  ds_read_b128 v[52:55], v3 offset:8704
  v_and_b32 v183, v239, v143
  v_bfi_b32 v64, v232, 0, v136
  v_bfi_b32 v65, v233, 0, v137
  s_waitcnt lgkmcnt(4)
  v_mfma_f32_32x32x16_bf16 v[192:207], v[56:59], v[128:131], v[192:207]
  v_bfi_b32 v66, v234, 0, v138
  v_bfi_b32 v67, v235, 0, v139
  v_mfma_f32_32x32x16_bf16 v[192:207], v[60:63], v[132:135], v[192:207]
  v_bfi_b32 v68, v236, 0, v140
  v_bfi_b32 v69, v237, 0, v141
  v_mfma_f32_16x16x32_bf16 v[208:211], v[240:243], v[136:139], v[208:211]
  v_bfi_b32 v70, v238, 0, v142
  v_mfma_f32_16x16x32_bf16 v[208:211], v[240:243], v[140:143], v[208:211]
  v_bfi_b32 v71, v239, 0, v143
  s_waitcnt lgkmcnt(2)
  v_mfma_f32_32x32x16_bf16 v[192:207], v[40:43], v[176:179], v[192:207]
  v_mfma_f32_32x32x16_bf16 v[192:207], v[44:47], v[180:183], v[192:207]
  s_waitcnt lgkmcnt(0)
  v_mfma_f32_32x32x16_bf16 v[192:207], v[48:51], v[64:67], v[192:207]
  v_mfma_f32_32x32x16_bf16 v[192:207], v[52:55], v[68:71], v[192:207]
  s_nop 7
  s_nop 7
  s_branch att_chk0
af0s_inv7:
  v_mov_b32 v80, 0xf149f2ca
  v_mov_b32 v81, 0xf149f2ca
  v_mov_b32 v82, 0xf149f2ca
  v_mov_b32 v83, 0xf149f2ca
  v_mov_b32 v84, 0xf149f2ca
  v_mov_b32 v85, 0xf149f2ca
  v_mov_b32 v86, 0xf149f2ca
  v_mov_b32 v87, 0xf149f2ca
  v_mov_b32 v88, 0xf149f2ca
  v_mov_b32 v89, 0xf149f2ca
  v_mov_b32 v90, 0xf149f2ca
  v_mov_b32 v91, 0xf149f2ca
  v_mov_b32 v92, 0xf149f2ca
  v_mov_b32 v93, 0xf149f2ca
  v_mov_b32 v94, 0xf149f2ca
  v_mov_b32 v95, 0xf149f2ca
  s_nop 1
  s_branch af0s_back7
af0s_inv6:
  v_mov_b32 v64, 0xf149f2ca
  v_mov_b32 v65, 0xf149f2ca
  v_mov_b32 v66, 0xf149f2ca
  v_mov_b32 v67, 0xf149f2ca
  v_mov_b32 v68, 0xf149f2ca
  v_mov_b32 v69, 0xf149f2ca
  v_mov_b32 v70, 0xf149f2ca
  v_mov_b32 v71, 0xf149f2ca
  v_mov_b32 v72, 0xf149f2ca
  v_mov_b32 v73, 0xf149f2ca
  v_mov_b32 v74, 0xf149f2ca
  v_mov_b32 v75, 0xf149f2ca
  v_mov_b32 v76, 0xf149f2ca
  v_mov_b32 v77, 0xf149f2ca
  v_mov_b32 v78, 0xf149f2ca
  v_mov_b32 v79, 0xf149f2ca
  s_nop 1
  s_branch af0s_back6
af0s_inv5:
  v_mov_b32 v80, 0xf149f2ca
  v_mov_b32 v81, 0xf149f2ca
  v_mov_b32 v82, 0xf149f2ca
  v_mov_b32 v83, 0xf149f2ca
  v_mov_b32 v84, 0xf149f2ca
  v_mov_b32 v85, 0xf149f2ca
  v_mov_b32 v86, 0xf149f2ca
  v_mov_b32 v87, 0xf149f2ca
  v_mov_b32 v88, 0xf149f2ca
  v_mov_b32 v89, 0xf149f2ca
  v_mov_b32 v90, 0xf149f2ca
  v_mov_b32 v91, 0xf149f2ca
  v_mov_b32 v92, 0xf149f2ca
  v_mov_b32 v93, 0xf149f2ca
  v_mov_b32 v94, 0xf149f2ca
  v_mov_b32 v95, 0xf149f2ca
  s_nop 1
  s_branch af0s_back5
af0s_inv4:
  v_mov_b32 v64, 0xf149f2ca
  v_mov_b32 v65, 0xf149f2ca
  v_mov_b32 v66, 0xf149f2ca
  v_mov_b32 v67, 0xf149f2ca
  v_mov_b32 v68, 0xf149f2ca
  v_mov_b32 v69, 0xf149f2ca
  v_mov_b32 v70, 0xf149f2ca
  v_mov_b32 v71, 0xf149f2ca
  v_mov_b32 v72, 0xf149f2ca
  v_mov_b32 v73, 0xf149f2ca
  v_mov_b32 v74, 0xf149f2ca
  v_mov_b32 v75, 0xf149f2ca
  v_mov_b32 v76, 0xf149f2ca
  v_mov_b32 v77, 0xf149f2ca
  v_mov_b32 v78, 0xf149f2ca
  v_mov_b32 v79, 0xf149f2ca
  s_nop 1
  s_branch af0s_back4
af0_inv7:
  v_mov_b32 v80, 0xf149f2ca
  v_mov_b32 v81, 0xf149f2ca
  v_mov_b32 v82, 0xf149f2ca
  v_mov_b32 v83, 0xf149f2ca
  v_mov_b32 v84, 0xf149f2ca
  v_mov_b32 v85, 0xf149f2ca
  v_mov_b32 v86, 0xf149f2ca
  v_mov_b32 v87, 0xf149f2ca
  v_mov_b32 v88, 0xf149f2ca
  v_mov_b32 v89, 0xf149f2ca
  v_mov_b32 v90, 0xf149f2ca
  v_mov_b32 v91, 0xf149f2ca
  v_mov_b32 v92, 0xf149f2ca
  v_mov_b32 v93, 0xf149f2ca
  v_mov_b32 v94, 0xf149f2ca
  v_mov_b32 v95, 0xf149f2ca
  s_nop 1
  s_branch af0_back7
af0_inv6:
  v_mov_b32 v64, 0xf149f2ca
  v_mov_b32 v65, 0xf149f2ca
  v_mov_b32 v66, 0xf149f2ca
  v_mov_b32 v67, 0xf149f2ca
  v_mov_b32 v68, 0xf149f2ca
  v_mov_b32 v69, 0xf149f2ca
  v_mov_b32 v70, 0xf149f2ca
  v_mov_b32 v71, 0xf149f2ca
  v_mov_b32 v72, 0xf149f2ca
  v_mov_b32 v73, 0xf149f2ca
  v_mov_b32 v74, 0xf149f2ca
  v_mov_b32 v75, 0xf149f2ca
  v_mov_b32 v76, 0xf149f2ca
  v_mov_b32 v77, 0xf149f2ca
  v_mov_b32 v78, 0xf149f2ca
  v_mov_b32 v79, 0xf149f2ca
  s_nop 1
  s_branch af0_back6
af0_inv5:
  v_mov_b32 v80, 0xf149f2ca
  v_mov_b32 v81, 0xf149f2ca
  v_mov_b32 v82, 0xf149f2ca
  v_mov_b32 v83, 0xf149f2ca
  v_mov_b32 v84, 0xf149f2ca
  v_mov_b32 v85, 0xf149f2ca
  v_mov_b32 v86, 0xf149f2ca
  v_mov_b32 v87, 0xf149f2ca
  v_mov_b32 v88, 0xf149f2ca
  v_mov_b32 v89, 0xf149f2ca
  v_mov_b32 v90, 0xf149f2ca
  v_mov_b32 v91, 0xf149f2ca
  v_mov_b32 v92, 0xf149f2ca
  v_mov_b32 v93, 0xf149f2ca
  v_mov_b32 v94, 0xf149f2ca
  v_mov_b32 v95, 0xf149f2ca
  s_nop 1
  s_branch af0_back5
af0_inv4:
  v_mov_b32 v64, 0xf149f2ca
  v_mov_b32 v65, 0xf149f2ca
  v_mov_b32 v66, 0xf149f2ca
  v_mov_b32 v67, 0xf149f2ca
  v_mov_b32 v68, 0xf149f2ca
  v_mov_b32 v69, 0xf149f2ca
  v_mov_b32 v70, 0xf149f2ca
  v_mov_b32 v71, 0xf149f2ca
  v_mov_b32 v72, 0xf149f2ca
  v_mov_b32 v73, 0xf149f2ca
  v_mov_b32 v74, 0xf149f2ca
  v_mov_b32 v75, 0xf149f2ca
  v_mov_b32 v76, 0xf149f2ca
  v_mov_b32 v77, 0xf149f2ca
  v_mov_b32 v78, 0xf149f2ca
  v_mov_b32 v79, 0xf149f2ca
  s_nop 1
  s_branch af0_back4
af0_inv3:
  v_mov_b32 v80, 0xf149f2ca
  v_mov_b32 v81, 0xf149f2ca
  v_mov_b32 v82, 0xf149f2ca
  v_mov_b32 v83, 0xf149f2ca
  v_mov_b32 v84, 0xf149f2ca
  v_mov_b32 v85, 0xf149f2ca
  v_mov_b32 v86, 0xf149f2ca
  v_mov_b32 v87, 0xf149f2ca
  v_mov_b32 v88, 0xf149f2ca
  v_mov_b32 v89, 0xf149f2ca
  v_mov_b32 v90, 0xf149f2ca
  v_mov_b32 v91, 0xf149f2ca
  v_mov_b32 v92, 0xf149f2ca
  v_mov_b32 v93, 0xf149f2ca
  v_mov_b32 v94, 0xf149f2ca
  v_mov_b32 v95, 0xf149f2ca
  s_nop 1
  s_branch af0_back3
af0_inv2:
  v_mov_b32 v64, 0xf149f2ca
  v_mov_b32 v65, 0xf149f2ca
  v_mov_b32 v66, 0xf149f2ca
  v_mov_b32 v67, 0xf149f2ca
  v_mov_b32 v68, 0xf149f2ca
  v_mov_b32 v69, 0xf149f2ca
  v_mov_b32 v70, 0xf149f2ca
  v_mov_b32 v71, 0xf149f2ca
  v_mov_b32 v72, 0xf149f2ca
  v_mov_b32 v73, 0xf149f2ca
  v_mov_b32 v74, 0xf149f2ca
  v_mov_b32 v75, 0xf149f2ca
  v_mov_b32 v76, 0xf149f2ca
  v_mov_b32 v77, 0xf149f2ca
  v_mov_b32 v78, 0xf149f2ca
  v_mov_b32 v79, 0xf149f2ca
  s_nop 1
  s_branch af0_back2
af0_inv1:
  v_mov_b32 v80, 0xf149f2ca
  v_mov_b32 v81, 0xf149f2ca
  v_mov_b32 v82, 0xf149f2ca
  v_mov_b32 v83, 0xf149f2ca
  v_mov_b32 v84, 0xf149f2ca
  v_mov_b32 v85, 0xf149f2ca
  v_mov_b32 v86, 0xf149f2ca
  v_mov_b32 v87, 0xf149f2ca
  v_mov_b32 v88, 0xf149f2ca
  v_mov_b32 v89, 0xf149f2ca
  v_mov_b32 v90, 0xf149f2ca
  v_mov_b32 v91, 0xf149f2ca
  v_mov_b32 v92, 0xf149f2ca
  v_mov_b32 v93, 0xf149f2ca
  v_mov_b32 v94, 0xf149f2ca
  v_mov_b32 v95, 0xf149f2ca
  s_nop 1
  s_branch af0_back1
af0_inv0:
  v_mov_b32 v64, 0xf149f2ca
  v_mov_b32 v65, 0xf149f2ca
  v_mov_b32 v66, 0xf149f2ca
  v_mov_b32 v67, 0xf149f2ca
  v_mov_b32 v68, 0xf149f2ca
  v_mov_b32 v69, 0xf149f2ca
  v_mov_b32 v70, 0xf149f2ca
  v_mov_b32 v71, 0xf149f2ca
  v_mov_b32 v72, 0xf149f2ca
  v_mov_b32 v73, 0xf149f2ca
  v_mov_b32 v74, 0xf149f2ca
  v_mov_b32 v75, 0xf149f2ca
  v_mov_b32 v76, 0xf149f2ca
  v_mov_b32 v77, 0xf149f2ca
  v_mov_b32 v78, 0xf149f2ca
  v_mov_b32 v79, 0xf149f2ca
  s_nop 1
  s_branch af0_back0
mk_clr:
  s_waitcnt lgkmcnt(0)
  s_add_u32 s68, s98, 0x1800000
  s_addc_u32 s69, s99, 0
  s_mov_b32 s70, 0x2c00
  s_mov_b32 s71, 0x00020000
  s_mov_b32 s72, s96
  s_mov_b32 s73, s97
  s_mov_b32 s74, 0x100
  s_mov_b32 s75, 0x00020000
  v_mov_b32 v104, 0
  v_mov_b32 v105, 0
  v_mov_b32 v106, 0
  v_mov_b32 v107, 0
  v_lshlrev_b32 v4, 4, v0
  s_mov_b32 s28, 0
  buffer_store_dwordx4 v[104:107], v4, s[68:71], s28 offen offset:0 sc1
  buffer_store_dwordx4 v[104:107], v4, s[68:71], s28 offen offset:1024 sc1
  buffer_store_dwordx4 v[104:107], v4, s[68:71], s28 offen offset:2048 sc1
  buffer_store_dwordx4 v[104:107], v4, s[68:71], s28 offen offset:3072 sc1
  s_mov_b32 s28, 4096
  buffer_store_dwordx4 v[104:107], v4, s[68:71], s28 offen offset:0 sc1
  buffer_store_dwordx4 v[104:107], v4, s[68:71], s28 offen offset:1024 sc1
  buffer_store_dwordx4 v[104:107], v4, s[68:71], s28 offen offset:2048 sc1
  buffer_store_dwordx4 v[104:107], v4, s[68:71], s28 offen offset:3072 sc1
  s_mov_b32 s28, 8192
  buffer_store_dwordx4 v[104:107], v4, s[68:71], s28 offen offset:0 sc1
  buffer_store_dwordx4 v[104:107], v4, s[68:71], s28 offen offset:1024 sc1
  buffer_store_dwordx4 v[104:107], v4, s[68:71], s28 offen offset:2048 sc1
  s_branch mk_clb
att_short1:
  ds_read_b128 v[8:11], v1
  ds_read_b128 v[12:15], v1 offset:512
  ds_read_b128 v[24:27], v4 offset:14336
  ds_read_b128 v[28:31], v4 offset:14848
  ds_read_b128 v[16:19], v4 offset:16384
  ds_read_b128 v[20:23], v4 offset:16896
  ds_read_b128 v[32:35], v4 offset:12288
  ds_read_b128 v[36:39], v4 offset:12800
  s_lshl2_add_u32 s31, s53, s26
  s_lshl_b32 s31, s31, 14
  s_and_b32 s30, s57, 8
  s_lshl_b32 s30, s30, 7
  s_add_u32 s31, s31, s30
  v_and_b32 v231, 14336, v254
  buffer_load_dword v231, v231, s[60:63], s31 offen offset:384
  s_waitcnt lgkmcnt(4)
  s_cmp_le_u32 s25, 0
  s_cbranch_scc1 af1s_inv7
  v_mfma_f32_32x32x16_bf16 v[80:95], v[24:27], v[8:11], 0
af1s_back7:
  v_mfma_f32_32x32x16_bf16 v[80:95], v[28:31], v[12:15], v[80:95]
  ds_read_b128 v[24:27], v4 offset:8192
  ds_read_b128 v[28:31], v4 offset:8704
  s_waitcnt lgkmcnt(4)
  v_mfma_f32_32x32x16_bf16 v[96:111], v[16:19], v[8:11], 0
  v_mfma_f32_32x32x16_bf16 v[96:111], v[20:23], v[12:15], v[96:111]
  ds_read_b128 v[16:19], v4 offset:10240
  ds_read_b128 v[20:23], v4 offset:10752
  s_waitcnt lgkmcnt(4)
  s_cmp_le_u32 s25, 1
  s_cbranch_scc1 af1s_inv6
  v_mfma_f32_32x32x16_bf16 v[64:79], v[32:35], v[8:11], 0
af1s_back6:
  s_nop 0
  v_exp_f32 v80, v80
  v_exp_f32 v81, v81
  v_exp_f32 v82, v82
  v_exp_f32 v83, v83
  v_exp_f32 v84, v84
  v_exp_f32 v85, v85
  v_exp_f32 v86, v86
  v_exp_f32 v87, v87
  v_exp_f32 v88, v88
  v_exp_f32 v89, v89
  v_mfma_f32_32x32x16_bf16 v[64:79], v[36:39], v[12:15], v[64:79]
  v_exp_f32 v90, v90
  v_exp_f32 v91, v91
  v_exp_f32 v92, v92
  v_exp_f32 v93, v93
  v_exp_f32 v94, v94
  v_exp_f32 v95, v95
  v_cvt_pk_bf16_f32 v112, v80, v81
  v_cvt_pk_bf16_f32 v113, v82, v83
  v_cvt_pk_bf16_f32 v114, v84, v85
  v_cvt_pk_bf16_f32 v115, v86, v87
  v_cvt_pk_bf16_f32 v116, v88, v89
  v_cvt_pk_bf16_f32 v117, v90, v91
  v_cvt_pk_bf16_f32 v118, v92, v93
  v_cvt_pk_bf16_f32 v119, v94, v95
  s_and_b32 s31, s3, 3
  s_lshl_b32 s31, s31, 11
  s_add_u32 s31, s31, 114688
  v_add_u32 v212, s31, v2
  v_mov_b32 v5, 122880
  s_mov_b32 s6, 1048576
lw34:
  ds_read_b32 v6, v5 offset:28
  s_waitcnt lgkmcnt(0)
  v_readfirstlane_b32 s7, v6
  s_nop 1
  s_cmp_ge_u32 s7, 4
  s_cbranch_scc1 lw34_ok
  s_sub_u32 s6, s6, 1
  s_cmp_eq_u32 s6, 0
  s_cbranch_scc1 lw34_ok
  s_sleep 1
  s_branch lw34
lw34_ok:
  ds_read_b128 v[184:187], v212 offset:0
  ds_read_b128 v[188:191], v212 offset:1024
  v_mov_b32 v5, 122880
  v_mov_b32 v6, 1
  s_mov_b64 exec, 1
  ds_add_u32 v5, v6 offset:4
  s_mov_b64 exec, -1
  s_and_b32 s31, s57, 7
  s_cmp_eq_u32 s31, 3
  s_cbranch_scc1 af1s_nt1
  buffer_load_dword v253, v254, s[60:63], s35 offen
af1s_nt1:
  s_cmp_le_u32 s25, 2
  s_cbranch_scc1 af1s_inv5
  v_mfma_f32_32x32x16_bf16 v[80:95], v[16:19], v[8:11], 0
af1s_back5:
  v_exp_f32 v64, v64
  v_exp_f32 v65, v65
  v_exp_f32 v66, v66
  v_exp_f32 v67, v67
  v_exp_f32 v68, v68
  v_exp_f32 v69, v69
  v_exp_f32 v70, v70
  v_mfma_f32_32x32x16_bf16 v[80:95], v[20:23], v[12:15], v[80:95]
  v_exp_f32 v71, v71
  v_exp_f32 v72, v72
  v_exp_f32 v73, v73
  v_exp_f32 v74, v74
  v_exp_f32 v75, v75
  v_exp_f32 v76, v76
  v_exp_f32 v77, v77
  v_mfma_f32_16x16x32_bf16 v[208:211], v[240:243], v[112:115], 0
  v_exp_f32 v78, v78
  v_exp_f32 v79, v79
  v_cvt_pk_bf16_f32 v120, v64, v65
  v_cvt_pk_bf16_f32 v121, v66, v67
  v_mfma_f32_16x16x32_bf16 v[208:211], v[240:243], v[116:119], v[208:211]
  v_cvt_pk_bf16_f32 v122, v68, v69
  v_cvt_pk_bf16_f32 v123, v70, v71
  v_cvt_pk_bf16_f32 v124, v72, v73
  v_cvt_pk_bf16_f32 v125, v74, v75
  v_cvt_pk_bf16_f32 v126, v76, v77
  v_cvt_pk_bf16_f32 v127, v78, v79
  v_mov_b32 v5, 122880
  s_mov_b32 s6, 1048576
lw35:
  ds_read_b32 v6, v5 offset:16
  s_waitcnt lgkmcnt(0)
  v_readfirstlane_b32 s7, v6
  s_nop 1
  s_cmp_ge_u32 s7, 4
  s_cbranch_scc1 lw35_ok
  s_sub_u32 s6, s6, 1
  s_cmp_eq_u32 s6, 0
  s_cbranch_scc1 lw35_ok
  s_sleep 1
  s_branch lw35
lw35_ok:
  s_and_b32 s31, s3, 3
  s_lshl_b32 s31, s31, 11
  s_lshl_b32 s30, s50, 14
  s_add_u32 s31, s31, s30
  s_add_u32 s31, s31, 8192
  buffer_store_dwordx4 v[184:187], v2, s[20:23], s31 offen offset:0 sc1
  buffer_store_dwordx4 v[188:191], v2, s[20:23], s31 offen offset:1024 sc1
  ds_read_b128 v[40:43], v3 offset:14336
  ds_read_b128 v[44:47], v3 offset:14848
  ds_read_b128 v[48:51], v3 offset:12288
  ds_read_b128 v[52:55], v3 offset:12800
  ds_read_b128 v[56:59], v3 offset:10240
  ds_read_b128 v[60:63], v3 offset:10752
  s_cmp_le_u32 s25, 3
  s_cbranch_scc1 af1s_inv4
  v_mfma_f32_32x32x16_bf16 v[64:79], v[24:27], v[8:11], 0
af1s_back4:
  v_exp_f32 v80, v80
  v_exp_f32 v81, v81
  v_exp_f32 v82, v82
  v_mfma_f32_32x32x16_bf16 v[64:79], v[28:31], v[12:15], v[64:79]
  v_exp_f32 v83, v83
  v_exp_f32 v84, v84
  v_exp_f32 v85, v85
  s_waitcnt lgkmcnt(4)
  v_mfma_f32_32x32x16_bf16 v[192:207], v[40:43], v[112:115], 0
  v_exp_f32 v86, v86
  v_exp_f32 v87, v87
  v_exp_f32 v88, v88
  v_mfma_f32_16x16x32_bf16 v[208:211], v[240:243], v[120:123], v[208:211]
  v_exp_f32 v89, v89
  v_mfma_f32_32x32x16_bf16 v[192:207], v[44:47], v[116:119], v[192:207]
  ds_read_b128 v[40:43], v3 offset:16384
  ds_read_b128 v[44:47], v3 offset:16896
  v_exp_f32 v90, v90
  v_exp_f32 v91, v91
  v_exp_f32 v92, v92
  v_mfma_f32_16x16x32_bf16 v[208:211], v[240:243], v[124:127], v[208:211]
  v_exp_f32 v93, v93
  v_exp_f32 v94, v94
  s_waitcnt lgkmcnt(4)
  v_mfma_f32_32x32x16_bf16 v[192:207], v[48:51], v[120:123], v[192:207]
  v_exp_f32 v95, v95
  v_cvt_pk_bf16_f32 v128, v80, v81
  v_cvt_pk_bf16_f32 v129, v82, v83
  v_cvt_pk_bf16_f32 v130, v84, v85
  v_mfma_f32_32x32x16_bf16 v[192:207], v[52:55], v[124:127], v[192:207]
  ds_read_b128 v[48:51], v3 offset:8192
  ds_read_b128 v[52:55], v3 offset:8704
  v_cvt_pk_bf16_f32 v131, v86, v87
  v_cvt_pk_bf16_f32 v132, v88, v89
  v_cvt_pk_bf16_f32 v133, v90, v91
  v_cvt_pk_bf16_f32 v134, v92, v93
  v_cvt_pk_bf16_f32 v135, v94, v95
  s_waitcnt lgkmcnt(4)
  v_mfma_f32_32x32x16_bf16 v[192:207], v[56:59], v[128:131], v[192:207]
  s_mov_b32 s28, 0xffffffff
  s_mov_b32 s29, 0xfffffff0
  v_cndmask_b32 v64, v64, v96, s[28:29]
  s_mov_b32 s30, 0xfffffffe
  s_mov_b32 s31, 0xffffffe0
  v_cndmask_b32 v65, v65, v97, s[30:31]
  s_mov_b32 s32, 0xfffffffc
  s_mov_b32 s33, 0xffffffc0
  v_cndmask_b32 v66, v66, v98, s[32:33]
  s_mov_b32 s34, 0xfffffff8
  s_mov_b32 s35, 0xffffff80
  v_cndmask_b32 v67, v67, v99, s[34:35]
  s_mov_b32 s28, 0xffffff00
  s_mov_b32 s29, 0xfffff000
  v_cndmask_b32 v68, v68, v100, s[28:29]
  s_mov_b32 s30, 0xfffffe00
  s_mov_b32 s31, 0xffffe000
  v_cndmask_b32 v69, v69, v101, s[30:31]
  s_mov_b32 s32, 0xfffffc00
  s_mov_b32 s33, 0xffffc000
  v_cndmask_b32 v70, v70, v102, s[32:33]
  s_mov_b32 s34, 0xfffff800
  s_mov_b32 s35, 0xffff8000
  v_cndmask_b32 v71, v71, v103, s[34:35]
  s_mov_b32 s28, 0xffff0000
  s_mov_b32 s29, 0xfff00000
  v_cndmask_b32 v72, v72, v104, s[28:29]
  s_mov_b32 s30, 0xfffe0000
  s_mov_b32 s31, 0xffe00000
  v_cndmask_b32 v73, v73, v105, s[30:31]
  s_mov_b32 s32, 0xfffc0000
  s_mov_b32 s33, 0xffc00000
  v_cndmask_b32 v74, v74, v106, s[32:33]
  s_mov_b32 s34, 0xfff80000
  s_mov_b32 s35, 0xff800000
  v_cndmask_b32 v75, v75, v107, s[34:35]
  s_mov_b32 s28, 0xff000000
  s_mov_b32 s29, 0xf0000000
  v_cndmask_b32 v76, v76, v108, s[28:29]
  s_mov_b32 s30, 0xfe000000
  s_mov_b32 s31, 0xe0000000
  v_cndmask_b32 v77, v77, v109, s[30:31]
  s_mov_b32 s32, 0xfc000000
  s_mov_b32 s33, 0xc0000000
  v_cndmask_b32 v78, v78, v110, s[32:33]
  s_mov_b32 s34, 0xf8000000
  s_mov_b32 s35, 0x80000000
  v_cndmask_b32 v79, v79, v111, s[34:35]
  v_exp_f32 v64, v64
  v_exp_f32 v65, v65
  v_mfma_f32_16x16x32_bf16 v[208:211], v[240:243], v[128:131], v[208:211]
  v_exp_f32 v66, v66
  v_exp_f32 v67, v67
  v_exp_f32 v68, v68
  v_exp_f32 v69, v69
  v_mfma_f32_32x32x16_bf16 v[192:207], v[60:63], v[132:135], v[192:207]
  v_exp_f32 v70, v70
  v_exp_f32 v71, v71
  v_exp_f32 v72, v72
  v_exp_f32 v73, v73
  v_exp_f32 v74, v74
  v_exp_f32 v75, v75
  v_exp_f32 v76, v76
  v_exp_f32 v77, v77
  v_exp_f32 v78, v78
  v_exp_f32 v79, v79
  v_mfma_f32_16x16x32_bf16 v[208:211], v[240:243], v[132:135], v[208:211]
  v_cvt_pk_bf16_f32 v136, v64, v65
  v_cvt_pk_bf16_f32 v137, v66, v67
  v_cvt_pk_bf16_f32 v138, v68, v69
  v_cvt_pk_bf16_f32 v139, v70, v71
  v_cvt_pk_bf16_f32 v140, v72, v73
  v_cvt_pk_bf16_f32 v141, v74, v75
  v_cvt_pk_bf16_f32 v142, v76, v77
  v_cvt_pk_bf16_f32 v143, v78, v79
  v_mfma_f32_16x16x32_bf16 v[208:211], v[240:243], v[136:139], v[208:211]
  v_and_b32 v176, v232, v136
  v_and_b32 v177, v233, v137
  v_and_b32 v178, v234, v138
  v_and_b32 v179, v235, v139
  v_and_b32 v180, v236, v140
  v_and_b32 v181, v237, v141
  v_and_b32 v182, v238, v142
  v_and_b32 v183, v239, v143
  v_mfma_f32_16x16x32_bf16 v[208:211], v[240:243], v[140:143], v[208:211]
  v_bfi_b32 v64, v232, 0, v136
  v_bfi_b32 v65, v233, 0, v137
  v_bfi_b32 v66, v234, 0, v138
  v_bfi_b32 v67, v235, 0, v139
  v_bfi_b32 v68, v236, 0, v140
  v_bfi_b32 v69, v237, 0, v141
  v_bfi_b32 v70, v238, 0, v142
  v_bfi_b32 v71, v239, 0, v143
  s_waitcnt lgkmcnt(2)
  v_mfma_f32_32x32x16_bf16 v[192:207], v[40:43], v[176:179], v[192:207]
  v_mfma_f32_32x32x16_bf16 v[192:207], v[44:47], v[180:183], v[192:207]
  s_waitcnt lgkmcnt(0)
  v_mfma_f32_32x32x16_bf16 v[192:207], v[48:51], v[64:67], v[192:207]
  v_mfma_f32_32x32x16_bf16 v[192:207], v[52:55], v[68:71], v[192:207]
  s_nop 7
  s_nop 7
  s_branch att_chk1
af1s_inv7:
  v_mov_b32 v80, 0xf149f2ca
  v_mov_b32 v81, 0xf149f2ca
  v_mov_b32 v82, 0xf149f2ca
  v_mov_b32 v83, 0xf149f2ca
  v_mov_b32 v84, 0xf149f2ca
  v_mov_b32 v85, 0xf149f2ca
  v_mov_b32 v86, 0xf149f2ca
  v_mov_b32 v87, 0xf149f2ca
  v_mov_b32 v88, 0xf149f2ca
  v_mov_b32 v89, 0xf149f2ca
  v_mov_b32 v90, 0xf149f2ca
  v_mov_b32 v91, 0xf149f2ca
  v_mov_b32 v92, 0xf149f2ca
  v_mov_b32 v93, 0xf149f2ca
  v_mov_b32 v94, 0xf149f2ca
  v_mov_b32 v95, 0xf149f2ca
  s_nop 1
  s_branch af1s_back7
af1s_inv6:
  v_mov_b32 v64, 0xf149f2ca
  v_mov_b32 v65, 0xf149f2ca
  v_mov_b32 v66, 0xf149f2ca
  v_mov_b32 v67, 0xf149f2ca
  v_mov_b32 v68, 0xf149f2ca
  v_mov_b32 v69, 0xf149f2ca
  v_mov_b32 v70, 0xf149f2ca
  v_mov_b32 v71, 0xf149f2ca
  v_mov_b32 v72, 0xf149f2ca
  v_mov_b32 v73, 0xf149f2ca
  v_mov_b32 v74, 0xf149f2ca
  v_mov_b32 v75, 0xf149f2ca
  v_mov_b32 v76, 0xf149f2ca
  v_mov_b32 v77, 0xf149f2ca
  v_mov_b32 v78, 0xf149f2ca
  v_mov_b32 v79, 0xf149f2ca
  s_nop 1
  s_branch af1s_back6
af1s_inv5:
  v_mov_b32 v80, 0xf149f2ca
  v_mov_b32 v81, 0xf149f2ca
  v_mov_b32 v82, 0xf149f2ca
  v_mov_b32 v83, 0xf149f2ca
  v_mov_b32 v84, 0xf149f2ca
  v_mov_b32 v85, 0xf149f2ca
  v_mov_b32 v86, 0xf149f2ca
  v_mov_b32 v87, 0xf149f2ca
  v_mov_b32 v88, 0xf149f2ca
  v_mov_b32 v89, 0xf149f2ca
  v_mov_b32 v90, 0xf149f2ca
  v_mov_b32 v91, 0xf149f2ca
  v_mov_b32 v92, 0xf149f2ca
  v_mov_b32 v93, 0xf149f2ca
  v_mov_b32 v94, 0xf149f2ca
  v_mov_b32 v95, 0xf149f2ca
  s_nop 1
  s_branch af1s_back5
af1s_inv4:
  v_mov_b32 v64, 0xf149f2ca
  v_mov_b32 v65, 0xf149f2ca
  v_mov_b32 v66, 0xf149f2ca
  v_mov_b32 v67, 0xf149f2ca
  v_mov_b32 v68, 0xf149f2ca
  v_mov_b32 v69, 0xf149f2ca
  v_mov_b32 v70, 0xf149f2ca
  v_mov_b32 v71, 0xf149f2ca
  v_mov_b32 v72, 0xf149f2ca
  v_mov_b32 v73, 0xf149f2ca
  v_mov_b32 v74, 0xf149f2ca
  v_mov_b32 v75, 0xf149f2ca
  v_mov_b32 v76, 0xf149f2ca
  v_mov_b32 v77, 0xf149f2ca
  v_mov_b32 v78, 0xf149f2ca
  v_mov_b32 v79, 0xf149f2ca
  s_nop 1
  s_branch af1s_back4
af1_inv7:
  v_mov_b32 v80, 0xf149f2ca
  v_mov_b32 v81, 0xf149f2ca
  v_mov_b32 v82, 0xf149f2ca
  v_mov_b32 v83, 0xf149f2ca
  v_mov_b32 v84, 0xf149f2ca
  v_mov_b32 v85, 0xf149f2ca
  v_mov_b32 v86, 0xf149f2ca
  v_mov_b32 v87, 0xf149f2ca
  v_mov_b32 v88, 0xf149f2ca
  v_mov_b32 v89, 0xf149f2ca
  v_mov_b32 v90, 0xf149f2ca
  v_mov_b32 v91, 0xf149f2ca
  v_mov_b32 v92, 0xf149f2ca
  v_mov_b32 v93, 0xf149f2ca
  v_mov_b32 v94, 0xf149f2ca
  v_mov_b32 v95, 0xf149f2ca
  s_nop 1
  s_branch af1_back7
af1_inv6:
  v_mov_b32 v64, 0xf149f2ca
  v_mov_b32 v65, 0xf149f2ca
  v_mov_b32 v66, 0xf149f2ca
  v_mov_b32 v67, 0xf149f2ca
  v_mov_b32 v68, 0xf149f2ca
  v_mov_b32 v69, 0xf149f2ca
  v_mov_b32 v70, 0xf149f2ca
  v_mov_b32 v71, 0xf149f2ca
  v_mov_b32 v72, 0xf149f2ca
  v_mov_b32 v73, 0xf149f2ca
  v_mov_b32 v74, 0xf149f2ca
  v_mov_b32 v75, 0xf149f2ca
  v_mov_b32 v76, 0xf149f2ca
  v_mov_b32 v77, 0xf149f2ca
  v_mov_b32 v78, 0xf149f2ca
  v_mov_b32 v79, 0xf149f2ca
  s_nop 1
  s_branch af1_back6
af1_inv5:
  v_mov_b32 v80, 0xf149f2ca
  v_mov_b32 v81, 0xf149f2ca
  v_mov_b32 v82, 0xf149f2ca
  v_mov_b32 v83, 0xf149f2ca
  v_mov_b32 v84, 0xf149f2ca
  v_mov_b32 v85, 0xf149f2ca
  v_mov_b32 v86, 0xf149f2ca
  v_mov_b32 v87, 0xf149f2ca
  v_mov_b32 v88, 0xf149f2ca
  v_mov_b32 v89, 0xf149f2ca
  v_mov_b32 v90, 0xf149f2ca
  v_mov_b32 v91, 0xf149f2ca
  v_mov_b32 v92, 0xf149f2ca
  v_mov_b32 v93, 0xf149f2ca
  v_mov_b32 v94, 0xf149f2ca
  v_mov_b32 v95, 0xf149f2ca
  s_nop 1
  s_branch af1_back5
af1_inv4:
  v_mov_b32 v64, 0xf149f2ca
  v_mov_b32 v65, 0xf149f2ca
  v_mov_b32 v66, 0xf149f2ca
  v_mov_b32 v67, 0xf149f2ca
  v_mov_b32 v68, 0xf149f2ca
  v_mov_b32 v69, 0xf149f2ca
  v_mov_b32 v70, 0xf149f2ca
  v_mov_b32 v71, 0xf149f2ca
  v_mov_b32 v72, 0xf149f2ca
  v_mov_b32 v73, 0xf149f2ca
  v_mov_b32 v74, 0xf149f2ca
  v_mov_b32 v75, 0xf149f2ca
  v_mov_b32 v76, 0xf149f2ca
  v_mov_b32 v77, 0xf149f2ca
  v_mov_b32 v78, 0xf149f2ca
  v_mov_b32 v79, 0xf149f2ca
  s_nop 1
  s_branch af1_back4
af1_inv3:
  v_mov_b32 v80, 0xf149f2ca
  v_mov_b32 v81, 0xf149f2ca
  v_mov_b32 v82, 0xf149f2ca
  v_mov_b32 v83, 0xf149f2ca
  v_mov_b32 v84, 0xf149f2ca
  v_mov_b32 v85, 0xf149f2ca
  v_mov_b32 v86, 0xf149f2ca
  v_mov_b32 v87, 0xf149f2ca
  v_mov_b32 v88, 0xf149f2ca
  v_mov_b32 v89, 0xf149f2ca
  v_mov_b32 v90, 0xf149f2ca
  v_mov_b32 v91, 0xf149f2ca
  v_mov_b32 v92, 0xf149f2ca
  v_mov_b32 v93, 0xf149f2ca
  v_mov_b32 v94, 0xf149f2ca
  v_mov_b32 v95, 0xf149f2ca
  s_nop 1
  s_branch af1_back3
af1_inv2:
  v_mov_b32 v64, 0xf149f2ca
  v_mov_b32 v65, 0xf149f2ca
  v_mov_b32 v66, 0xf149f2ca
  v_mov_b32 v67, 0xf149f2ca
  v_mov_b32 v68, 0xf149f2ca
  v_mov_b32 v69, 0xf149f2ca
  v_mov_b32 v70, 0xf149f2ca
  v_mov_b32 v71, 0xf149f2ca
  v_mov_b32 v72, 0xf149f2ca
  v_mov_b32 v73, 0xf149f2ca
  v_mov_b32 v74, 0xf149f2ca
  v_mov_b32 v75, 0xf149f2ca
  v_mov_b32 v76, 0xf149f2ca
  v_mov_b32 v77, 0xf149f2ca
  v_mov_b32 v78, 0xf149f2ca
  v_mov_b32 v79, 0xf149f2ca
  s_nop 1
  s_branch af1_back2
af1_inv1:
  v_mov_b32 v80, 0xf149f2ca
  v_mov_b32 v81, 0xf149f2ca
  v_mov_b32 v82, 0xf149f2ca
  v_mov_b32 v83, 0xf149f2ca
  v_mov_b32 v84, 0xf149f2ca
  v_mov_b32 v85, 0xf149f2ca
  v_mov_b32 v86, 0xf149f2ca
  v_mov_b32 v87, 0xf149f2ca
  v_mov_b32 v88, 0xf149f2ca
  v_mov_b32 v89, 0xf149f2ca
  v_mov_b32 v90, 0xf149f2ca
  v_mov_b32 v91, 0xf149f2ca
  v_mov_b32 v92, 0xf149f2ca
  v_mov_b32 v93, 0xf149f2ca
  v_mov_b32 v94, 0xf149f2ca
  v_mov_b32 v95, 0xf149f2ca
  s_nop 1
  s_branch af1_back1
af1_inv0:
  v_mov_b32 v64, 0xf149f2ca
  v_mov_b32 v65, 0xf149f2ca
  v_mov_b32 v66, 0xf149f2ca
  v_mov_b32 v67, 0xf149f2ca
  v_mov_b32 v68, 0xf149f2ca
  v_mov_b32 v69, 0xf149f2ca
  v_mov_b32 v70, 0xf149f2ca
  v_mov_b32 v71, 0xf149f2ca
  v_mov_b32 v72, 0xf149f2ca
  v_mov_b32 v73, 0xf149f2ca
  v_mov_b32 v74, 0xf149f2ca
  v_mov_b32 v75, 0xf149f2ca
  v_mov_b32 v76, 0xf149f2ca
  v_mov_b32 v77, 0xf149f2ca
  v_mov_b32 v78, 0xf149f2ca
  v_mov_b32 v79, 0xf149f2ca
  s_nop 1
  s_branch af1_back0
att_slow:
  s_nop 15
  v_mov_b32 v212, 0xf149f2ca
  ds_read_b128 v[16:19], v4 offset:0
  ds_read_b128 v[20:23], v4 offset:512
  s_waitcnt lgkmcnt(0)
  v_mfma_f32_32x32x16_bf16 v[64:79], v[16:19], v[8:11], 0
  v_mfma_f32_32x32x16_bf16 v[64:79], v[20:23], v[12:15], v[64:79]
  s_nop 15
  v_mov_b32 v215, 0xf149f2ca
  v_cmp_le_i32 vcc, 0, v7
  s_nop 1
  v_cndmask_b32 v64, v64, v215, vcc
  v_cmp_le_i32 vcc, 1, v7
  s_nop 1
  v_cndmask_b32 v65, v65, v215, vcc
  v_cmp_le_i32 vcc, 2, v7
  s_nop 1
  v_cndmask_b32 v66, v66, v215, vcc
  v_cmp_le_i32 vcc, 3, v7
  s_nop 1
  v_cndmask_b32 v67, v67, v215, vcc
  v_cmp_le_i32 vcc, 8, v7
  s_nop 1
  v_cndmask_b32 v68, v68, v215, vcc
  v_cmp_le_i32 vcc, 9, v7
  s_nop 1
  v_cndmask_b32 v69, v69, v215, vcc
  v_cmp_le_i32 vcc, 10, v7
  s_nop 1
  v_cndmask_b32 v70, v70, v215, vcc
  v_cmp_le_i32 vcc, 11, v7
  s_nop 1
  v_cndmask_b32 v71, v71, v215, vcc
  v_cmp_le_i32 vcc, 16, v7
  s_nop 1
  v_cndmask_b32 v72, v72, v215, vcc
  v_cmp_le_i32 vcc, 17, v7
  s_nop 1
  v_cndmask_b32 v73, v73, v215, vcc
  v_cmp_le_i32 vcc, 18, v7
  s_nop 1
  v_cndmask_b32 v74, v74, v215, vcc
  v_cmp_le_i32 vcc, 19, v7
  s_nop 1
  v_cndmask_b32 v75, v75, v215, vcc
  v_cmp_le_i32 vcc, 24, v7
  s_nop 1
  v_cndmask_b32 v76, v76, v215, vcc
  v_cmp_le_i32 vcc, 25, v7
  s_nop 1
  v_cndmask_b32 v77, v77, v215, vcc
  v_cmp_le_i32 vcc, 26, v7
  s_nop 1
  v_cndmask_b32 v78, v78, v215, vcc
  v_cmp_le_i32 vcc, 27, v7
  s_nop 1
  v_cndmask_b32 v79, v79, v215, vcc
  s_cmp_ge_u32 s25, 8
  s_cbranch_scc1 as1_0
  v_mov_b32 v64, 0xf149f2ca
  v_mov_b32 v65, 0xf149f2ca
  v_mov_b32 v66, 0xf149f2ca
  v_mov_b32 v67, 0xf149f2ca
  v_mov_b32 v68, 0xf149f2ca
  v_mov_b32 v69, 0xf149f2ca
  v_mov_b32 v70, 0xf149f2ca
  v_mov_b32 v71, 0xf149f2ca
  v_mov_b32 v72, 0xf149f2ca
  v_mov_b32 v73, 0xf149f2ca
  v_mov_b32 v74, 0xf149f2ca
  v_mov_b32 v75, 0xf149f2ca
  v_mov_b32 v76, 0xf149f2ca
  v_mov_b32 v77, 0xf149f2ca
  v_mov_b32 v78, 0xf149f2ca
  v_mov_b32 v79, 0xf149f2ca
as1_0:
  v_max3_f32 v212, v212, v64, v65
  v_max3_f32 v212, v212, v66, v67
  v_max3_f32 v212, v212, v68, v69
  v_max3_f32 v212, v212, v70, v71
  v_max3_f32 v212, v212, v72, v73
  v_max3_f32 v212, v212, v74, v75
  v_max3_f32 v212, v212, v76, v77
  v_max3_f32 v212, v212, v78, v79
  ds_read_b128 v[16:19], v4 offset:2048
  ds_read_b128 v[20:23], v4 offset:2560
  s_waitcnt lgkmcnt(0)
  v_mfma_f32_32x32x16_bf16 v[64:79], v[16:19], v[8:11], 0
  v_mfma_f32_32x32x16_bf16 v[64:79], v[20:23], v[12:15], v[64:79]
  s_nop 15
  s_cmp_ge_u32 s25, 7
  s_cbranch_scc1 as1_1
  v_mov_b32 v64, 0xf149f2ca
  v_mov_b32 v65, 0xf149f2ca
  v_mov_b32 v66, 0xf149f2ca
  v_mov_b32 v67, 0xf149f2ca
  v_mov_b32 v68, 0xf149f2ca
  v_mov_b32 v69, 0xf149f2ca
  v_mov_b32 v70, 0xf149f2ca
  v_mov_b32 v71, 0xf149f2ca
  v_mov_b32 v72, 0xf149f2ca
  v_mov_b32 v73, 0xf149f2ca
  v_mov_b32 v74, 0xf149f2ca
  v_mov_b32 v75, 0xf149f2ca
  v_mov_b32 v76, 0xf149f2ca
  v_mov_b32 v77, 0xf149f2ca
  v_mov_b32 v78, 0xf149f2ca
  v_mov_b32 v79, 0xf149f2ca
as1_1:
  v_max3_f32 v212, v212, v64, v65
  v_max3_f32 v212, v212, v66, v67
  v_max3_f32 v212, v212, v68, v69
  v_max3_f32 v212, v212, v70, v71
  v_max3_f32 v212, v212, v72, v73
  v_max3_f32 v212, v212, v74, v75
  v_max3_f32 v212, v212, v76, v77
  v_max3_f32 v212, v212, v78, v79
  ds_read_b128 v[16:19], v4 offset:4096
  ds_read_b128 v[20:23], v4 offset:4608
  s_waitcnt lgkmcnt(0)
  v_mfma_f32_32x32x16_bf16 v[64:79], v[16:19], v[8:11], 0
  v_mfma_f32_32x32x16_bf16 v[64:79], v[20:23], v[12:15], v[64:79]
  s_nop 15
  s_cmp_ge_u32 s25, 6
  s_cbranch_scc1 as1_2
  v_mov_b32 v64, 0xf149f2ca
  v_mov_b32 v65, 0xf149f2ca
  v_mov_b32 v66, 0xf149f2ca
  v_mov_b32 v67, 0xf149f2ca
  v_mov_b32 v68, 0xf149f2ca
  v_mov_b32 v69, 0xf149f2ca
  v_mov_b32 v70, 0xf149f2ca
  v_mov_b32 v71, 0xf149f2ca
  v_mov_b32 v72, 0xf149f2ca
  v_mov_b32 v73, 0xf149f2ca
  v_mov_b32 v74, 0xf149f2ca
  v_mov_b32 v75, 0xf149f2ca
  v_mov_b32 v76, 0xf149f2ca
  v_mov_b32 v77, 0xf149f2ca
  v_mov_b32 v78, 0xf149f2ca
  v_mov_b32 v79, 0xf149f2ca
as1_2:
  v_max3_f32 v212, v212, v64, v65
  v_max3_f32 v212, v212, v66, v67
  v_max3_f32 v212, v212, v68, v69
  v_max3_f32 v212, v212, v70, v71
  v_max3_f32 v212, v212, v72, v73
  v_max3_f32 v212, v212, v74, v75
  v_max3_f32 v212, v212, v76, v77
  v_max3_f32 v212, v212, v78, v79
  ds_read_b128 v[16:19], v4 offset:6144
  ds_read_b128 v[20:23], v4 offset:6656
  s_waitcnt lgkmcnt(0)
  v_mfma_f32_32x32x16_bf16 v[64:79], v[16:19], v[8:11], 0
  v_mfma_f32_32x32x16_bf16 v[64:79], v[20:23], v[12:15], v[64:79]
  s_nop 15
  s_cmp_ge_u32 s25, 5
  s_cbranch_scc1 as1_3
  v_mov_b32 v64, 0xf149f2ca
  v_mov_b32 v65, 0xf149f2ca
  v_mov_b32 v66, 0xf149f2ca
  v_mov_b32 v67, 0xf149f2ca
  v_mov_b32 v68, 0xf149f2ca
  v_mov_b32 v69, 0xf149f2ca
  v_mov_b32 v70, 0xf149f2ca
  v_mov_b32 v71, 0xf149f2ca
  v_mov_b32 v72, 0xf149f2ca
  v_mov_b32 v73, 0xf149f2ca
  v_mov_b32 v74, 0xf149f2ca
  v_mov_b32 v75, 0xf149f2ca
  v_mov_b32 v76, 0xf149f2ca
  v_mov_b32 v77, 0xf149f2ca
  v_mov_b32 v78, 0xf149f2ca
  v_mov_b32 v79, 0xf149f2ca
as1_3:
  v_max3_f32 v212, v212, v64, v65
  v_max3_f32 v212, v212, v66, v67
  v_max3_f32 v212, v212, v68, v69
  v_max3_f32 v212, v212, v70, v71
  v_max3_f32 v212, v212, v72, v73
  v_max3_f32 v212, v212, v74, v75
  v_max3_f32 v212, v212, v76, v77
  v_max3_f32 v212, v212, v78, v79
  ds_read_b128 v[16:19], v4 offset:8192
  ds_read_b128 v[20:23], v4 offset:8704
  s_waitcnt lgkmcnt(0)
  v_mfma_f32_32x32x16_bf16 v[64:79], v[16:19], v[8:11], 0
  v_mfma_f32_32x32x16_bf16 v[64:79], v[20:23], v[12:15], v[64:79]
  s_nop 15
  s_cmp_ge_u32 s25, 4
  s_cbranch_scc1 as1_4
  v_mov_b32 v64, 0xf149f2ca
  v_mov_b32 v65, 0xf149f2ca
  v_mov_b32 v66, 0xf149f2ca
  v_mov_b32 v67, 0xf149f2ca
  v_mov_b32 v68, 0xf149f2ca
  v_mov_b32 v69, 0xf149f2ca
  v_mov_b32 v70, 0xf149f2ca
  v_mov_b32 v71, 0xf149f2ca
  v_mov_b32 v72, 0xf149f2ca
  v_mov_b32 v73, 0xf149f2ca
  v_mov_b32 v74, 0xf149f2ca
  v_mov_b32 v75, 0xf149f2ca
  v_mov_b32 v76, 0xf149f2ca
  v_mov_b32 v77, 0xf149f2ca
  v_mov_b32 v78, 0xf149f2ca
  v_mov_b32 v79, 0xf149f2ca
as1_4:
  v_max3_f32 v212, v212, v64, v65
  v_max3_f32 v212, v212, v66, v67
  v_max3_f32 v212, v212, v68, v69
  v_max3_f32 v212, v212, v70, v71
  v_max3_f32 v212, v212, v72, v73
  v_max3_f32 v212, v212, v74, v75
  v_max3_f32 v212, v212, v76, v77
  v_max3_f32 v212, v212, v78, v79
  ds_read_b128 v[16:19], v4 offset:10240
  ds_read_b128 v[20:23], v4 offset:10752
  s_waitcnt lgkmcnt(0)
  v_mfma_f32_32x32x16_bf16 v[64:79], v[16:19], v[8:11], 0
  v_mfma_f32_32x32x16_bf16 v[64:79], v[20:23], v[12:15], v[64:79]
  s_nop 15
  s_cmp_ge_u32 s25, 3
  s_cbranch_scc1 as1_5
  v_mov_b32 v64, 0xf149f2ca
  v_mov_b32 v65, 0xf149f2ca
  v_mov_b32 v66, 0xf149f2ca
  v_mov_b32 v67, 0xf149f2ca
  v_mov_b32 v68, 0xf149f2ca
  v_mov_b32 v69, 0xf149f2ca
  v_mov_b32 v70, 0xf149f2ca
  v_mov_b32 v71, 0xf149f2ca
  v_mov_b32 v72, 0xf149f2ca
  v_mov_b32 v73, 0xf149f2ca
  v_mov_b32 v74, 0xf149f2ca
  v_mov_b32 v75, 0xf149f2ca
  v_mov_b32 v76, 0xf149f2ca
  v_mov_b32 v77, 0xf149f2ca
  v_mov_b32 v78, 0xf149f2ca
  v_mov_b32 v79, 0xf149f2ca
as1_5:
  v_max3_f32 v212, v212, v64, v65
  v_max3_f32 v212, v212, v66, v67
  v_max3_f32 v212, v212, v68, v69
  v_max3_f32 v212, v212, v70, v71
  v_max3_f32 v212, v212, v72, v73
  v_max3_f32 v212, v212, v74, v75
  v_max3_f32 v212, v212, v76, v77
  v_max3_f32 v212, v212, v78, v79
  ds_read_b128 v[16:19], v4 offset:12288
  ds_read_b128 v[20:23], v4 offset:12800
  s_waitcnt lgkmcnt(0)
  v_mfma_f32_32x32x16_bf16 v[64:79], v[16:19], v[8:11], 0
  v_mfma_f32_32x32x16_bf16 v[64:79], v[20:23], v[12:15], v[64:79]
  s_nop 15
  s_cmp_ge_u32 s25, 2
  s_cbranch_scc1 as1_6
  v_mov_b32 v64, 0xf149f2ca
  v_mov_b32 v65, 0xf149f2ca
  v_mov_b32 v66, 0xf149f2ca
  v_mov_b32 v67, 0xf149f2ca
  v_mov_b32 v68, 0xf149f2ca
  v_mov_b32 v69, 0xf149f2ca
  v_mov_b32 v70, 0xf149f2ca
  v_mov_b32 v71, 0xf149f2ca
  v_mov_b32 v72, 0xf149f2ca
  v_mov_b32 v73, 0xf149f2ca
  v_mov_b32 v74, 0xf149f2ca
  v_mov_b32 v75, 0xf149f2ca
  v_mov_b32 v76, 0xf149f2ca
  v_mov_b32 v77, 0xf149f2ca
  v_mov_b32 v78, 0xf149f2ca
  v_mov_b32 v79, 0xf149f2ca
as1_6:
  v_max3_f32 v212, v212, v64, v65
  v_max3_f32 v212, v212, v66, v67
  v_max3_f32 v212, v212, v68, v69
  v_max3_f32 v212, v212, v70, v71
  v_max3_f32 v212, v212, v72, v73
  v_max3_f32 v212, v212, v74, v75
  v_max3_f32 v212, v212, v76, v77
  v_max3_f32 v212, v212, v78, v79
  ds_read_b128 v[16:19], v4 offset:14336
  ds_read_b128 v[20:23], v4 offset:14848
  s_waitcnt lgkmcnt(0)
  v_mfma_f32_32x32x16_bf16 v[64:79], v[16:19], v[8:11], 0
  v_mfma_f32_32x32x16_bf16 v[64:79], v[20:23], v[12:15], v[64:79]
  s_nop 15
  s_cmp_ge_u32 s25, 1
  s_cbranch_scc1 as1_7
  v_mov_b32 v64, 0xf149f2ca
  v_mov_b32 v65, 0xf149f2ca
  v_mov_b32 v66, 0xf149f2ca
  v_mov_b32 v67, 0xf149f2ca
  v_mov_b32 v68, 0xf149f2ca
  v_mov_b32 v69, 0xf149f2ca
  v_mov_b32 v70, 0xf149f2ca
  v_mov_b32 v71, 0xf149f2ca
  v_mov_b32 v72, 0xf149f2ca
  v_mov_b32 v73, 0xf149f2ca
  v_mov_b32 v74, 0xf149f2ca
  v_mov_b32 v75, 0xf149f2ca
  v_mov_b32 v76, 0xf149f2ca
  v_mov_b32 v77, 0xf149f2ca
  v_mov_b32 v78, 0xf149f2ca
  v_mov_b32 v79, 0xf149f2ca
as1_7:
  v_max3_f32 v212, v212, v64, v65
  v_max3_f32 v212, v212, v66, v67
  v_max3_f32 v212, v212, v68, v69
  v_max3_f32 v212, v212, v70, v71
  v_max3_f32 v212, v212, v72, v73
  v_max3_f32 v212, v212, v74, v75
  v_max3_f32 v212, v212, v76, v77
  v_max3_f32 v212, v212, v78, v79
  ds_read_b128 v[16:19], v4 offset:16384
  ds_read_b128 v[20:23], v4 offset:16896
  s_waitcnt lgkmcnt(0)
  v_mfma_f32_32x32x16_bf16 v[64:79], v[16:19], v[8:11], 0
  v_mfma_f32_32x32x16_bf16 v[64:79], v[20:23], v[12:15], v[64:79]
  s_nop 15
  v_mov_b32 v215, 0xf149f2ca
  v_cmp_le_i32 vcc, 0, v7
  s_nop 1
  v_cndmask_b32 v64, v215, v64, vcc
  v_cmp_le_i32 vcc, 1, v7
  s_nop 1
  v_cndmask_b32 v65, v215, v65, vcc
  v_cmp_le_i32 vcc, 2, v7
  s_nop 1
  v_cndmask_b32 v66, v215, v66, vcc
  v_cmp_le_i32 vcc, 3, v7
  s_nop 1
  v_cndmask_b32 v67, v215, v67, vcc
  v_cmp_le_i32 vcc, 8, v7
  s_nop 1
  v_cndmask_b32 v68, v215, v68, vcc
  v_cmp_le_i32 vcc, 9, v7
  s_nop 1
  v_cndmask_b32 v69, v215, v69, vcc
  v_cmp_le_i32 vcc, 10, v7
  s_nop 1
  v_cndmask_b32 v70, v215, v70, vcc
  v_cmp_le_i32 vcc, 11, v7
  s_nop 1
  v_cndmask_b32 v71, v215, v71, vcc
  v_cmp_le_i32 vcc, 16, v7
  s_nop 1
  v_cndmask_b32 v72, v215, v72, vcc
  v_cmp_le_i32 vcc, 17, v7
  s_nop 1
  v_cndmask_b32 v73, v215, v73, vcc
  v_cmp_le_i32 vcc, 18, v7
  s_nop 1
  v_cndmask_b32 v74, v215, v74, vcc
  v_cmp_le_i32 vcc, 19, v7
  s_nop 1
  v_cndmask_b32 v75, v215, v75, vcc
  v_cmp_le_i32 vcc, 24, v7
  s_nop 1
  v_cndmask_b32 v76, v215, v76, vcc
  v_cmp_le_i32 vcc, 25, v7
  s_nop 1
  v_cndmask_b32 v77, v215, v77, vcc
  v_cmp_le_i32 vcc, 26, v7
  s_nop 1
  v_cndmask_b32 v78, v215, v78, vcc
  v_cmp_le_i32 vcc, 27, v7
  s_nop 1
  v_cndmask_b32 v79, v215, v79, vcc
  v_max3_f32 v212, v212, v64, v65
  v_max3_f32 v212, v212, v66, v67
  v_max3_f32 v212, v212, v68, v69
  v_max3_f32 v212, v212, v70, v71
  v_max3_f32 v212, v212, v72, v73
  v_max3_f32 v212, v212, v74, v75
  v_max3_f32 v212, v212, v76, v77
  v_max3_f32 v212, v212, v78, v79
  v_mov_b32 v213, v212
  s_nop 1
  v_permlane32_swap_b32 v212, v213
  v_max_f32 v212, v212, v213
  ds_read_b128 v[16:19], v4 offset:0
  ds_read_b128 v[20:23], v4 offset:512
  s_waitcnt lgkmcnt(0)
  v_mfma_f32_32x32x16_bf16 v[64:79], v[16:19], v[8:11], 0
  v_mfma_f32_32x32x16_bf16 v[64:79], v[20:23], v[12:15], v[64:79]
  s_nop 15
  v_mov_b32 v215, 0xf149f2ca
  v_cmp_le_i32 vcc, 0, v7
  s_nop 1
  v_cndmask_b32 v64, v64, v215, vcc
  v_cmp_le_i32 vcc, 1, v7
  s_nop 1
  v_cndmask_b32 v65, v65, v215, vcc
  v_cmp_le_i32 vcc, 2, v7
  s_nop 1
  v_cndmask_b32 v66, v66, v215, vcc
  v_cmp_le_i32 vcc, 3, v7
  s_nop 1
  v_cndmask_b32 v67, v67, v215, vcc
  v_cmp_le_i32 vcc, 8, v7
  s_nop 1
  v_cndmask_b32 v68, v68, v215, vcc
  v_cmp_le_i32 vcc, 9, v7
  s_nop 1
  v_cndmask_b32 v69, v69, v215, vcc
  v_cmp_le_i32 vcc, 10, v7
  s_nop 1
  v_cndmask_b32 v70, v70, v215, vcc
  v_cmp_le_i32 vcc, 11, v7
  s_nop 1
  v_cndmask_b32 v71, v71, v215, vcc
  v_cmp_le_i32 vcc, 16, v7
  s_nop 1
  v_cndmask_b32 v72, v72, v215, vcc
  v_cmp_le_i32 vcc, 17, v7
  s_nop 1
  v_cndmask_b32 v73, v73, v215, vcc
  v_cmp_le_i32 vcc, 18, v7
  s_nop 1
  v_cndmask_b32 v74, v74, v215, vcc
  v_cmp_le_i32 vcc, 19, v7
  s_nop 1
  v_cndmask_b32 v75, v75, v215, vcc
  v_cmp_le_i32 vcc, 24, v7
  s_nop 1
  v_cndmask_b32 v76, v76, v215, vcc
  v_cmp_le_i32 vcc, 25, v7
  s_nop 1
  v_cndmask_b32 v77, v77, v215, vcc
  v_cmp_le_i32 vcc, 26, v7
  s_nop 1
  v_cndmask_b32 v78, v78, v215, vcc
  v_cmp_le_i32 vcc, 27, v7
  s_nop 1
  v_cndmask_b32 v79, v79, v215, vcc
  s_cmp_ge_u32 s25, 8
  s_cbranch_scc1 as2_0
  v_mov_b32 v64, 0xf149f2ca
  v_mov_b32 v65, 0xf149f2ca
  v_mov_b32 v66, 0xf149f2ca
  v_mov_b32 v67, 0xf149f2ca
  v_mov_b32 v68, 0xf149f2ca
  v_mov_b32 v69, 0xf149f2ca
  v_mov_b32 v70, 0xf149f2ca
  v_mov_b32 v71, 0xf149f2ca
  v_mov_b32 v72, 0xf149f2ca
  v_mov_b32 v73, 0xf149f2ca
  v_mov_b32 v74, 0xf149f2ca
  v_mov_b32 v75, 0xf149f2ca
  v_mov_b32 v76, 0xf149f2ca
  v_mov_b32 v77, 0xf149f2ca
  v_mov_b32 v78, 0xf149f2ca
  v_mov_b32 v79, 0xf149f2ca
as2_0:
  ds_read_b128 v[24:27], v3 offset:0
  ds_read_b128 v[28:31], v3 offset:512
  v_sub_f32 v64, v64, v212
  v_sub_f32 v65, v65, v212
  v_sub_f32 v66, v66, v212
  v_sub_f32 v67, v67, v212
  v_sub_f32 v68, v68, v212
  v_sub_f32 v69, v69, v212
  v_sub_f32 v70, v70, v212
  v_sub_f32 v71, v71, v212
  v_sub_f32 v72, v72, v212
  v_sub_f32 v73, v73, v212
  v_sub_f32 v74, v74, v212
  v_sub_f32 v75, v75, v212
  v_sub_f32 v76, v76, v212
  v_sub_f32 v77, v77, v212
  v_sub_f32 v78, v78, v212
  v_sub_f32 v79, v79, v212
  v_exp_f32 v64, v64
  v_exp_f32 v65, v65
  v_exp_f32 v66, v66
  v_exp_f32 v67, v67
  v_exp_f32 v68, v68
  v_exp_f32 v69, v69
  v_exp_f32 v70, v70
  v_exp_f32 v71, v71
  v_exp_f32 v72, v72
  v_exp_f32 v73, v73
  v_exp_f32 v74, v74
  v_exp_f32 v75, v75
  v_exp_f32 v76, v76
  v_exp_f32 v77, v77
  v_exp_f32 v78, v78
  v_exp_f32 v79, v79
  v_cvt_pk_bf16_f32 v112, v64, v65
  v_cvt_pk_bf16_f32 v113, v66, v67
  v_cvt_pk_bf16_f32 v114, v68, v69
  v_cvt_pk_bf16_f32 v115, v70, v71
  v_cvt_pk_bf16_f32 v116, v72, v73
  v_cvt_pk_bf16_f32 v117, v74, v75
  v_cvt_pk_bf16_f32 v118, v76, v77
  v_cvt_pk_bf16_f32 v119, v78, v79
  s_waitcnt lgkmcnt(0)
  v_mfma_f32_32x32x16_bf16 v[192:207], v[24:27], v[112:115], 0
  v_mfma_f32_32x32x16_bf16 v[192:207], v[28:31], v[116:119], v[192:207]
  v_mfma_f32_16x16x32_bf16 v[208:211], v[240:243], v[112:115], 0
  v_mfma_f32_16x16x32_bf16 v[208:211], v[240:243], v[116:119], v[208:211]
  s_nop 15
  ds_read_b128 v[16:19], v4 offset:2048
  ds_read_b128 v[20:23], v4 offset:2560
  s_waitcnt lgkmcnt(0)
  v_mfma_f32_32x32x16_bf16 v[64:79], v[16:19], v[8:11], 0
  v_mfma_f32_32x32x16_bf16 v[64:79], v[20:23], v[12:15], v[64:79]
  s_nop 15
  s_cmp_ge_u32 s25, 7
  s_cbranch_scc1 as2_1
  v_mov_b32 v64, 0xf149f2ca
  v_mov_b32 v65, 0xf149f2ca
  v_mov_b32 v66, 0xf149f2ca
  v_mov_b32 v67, 0xf149f2ca
  v_mov_b32 v68, 0xf149f2ca
  v_mov_b32 v69, 0xf149f2ca
  v_mov_b32 v70, 0xf149f2ca
  v_mov_b32 v71, 0xf149f2ca
  v_mov_b32 v72, 0xf149f2ca
  v_mov_b32 v73, 0xf149f2ca
  v_mov_b32 v74, 0xf149f2ca
  v_mov_b32 v75, 0xf149f2ca
  v_mov_b32 v76, 0xf149f2ca
  v_mov_b32 v77, 0xf149f2ca
  v_mov_b32 v78, 0xf149f2ca
  v_mov_b32 v79, 0xf149f2ca
as2_1:
  ds_read_b128 v[24:27], v3 offset:2048
  ds_read_b128 v[28:31], v3 offset:2560
  v_sub_f32 v64, v64, v212
  v_sub_f32 v65, v65, v212
  v_sub_f32 v66, v66, v212
  v_sub_f32 v67, v67, v212
  v_sub_f32 v68, v68, v212
  v_sub_f32 v69, v69, v212
  v_sub_f32 v70, v70, v212
  v_sub_f32 v71, v71, v212
  v_sub_f32 v72, v72, v212
  v_sub_f32 v73, v73, v212
  v_sub_f32 v74, v74, v212
  v_sub_f32 v75, v75, v212
  v_sub_f32 v76, v76, v212
  v_sub_f32 v77, v77, v212
  v_sub_f32 v78, v78, v212
  v_sub_f32 v79, v79, v212
  v_exp_f32 v64, v64
  v_exp_f32 v65, v65
  v_exp_f32 v66, v66
  v_exp_f32 v67, v67
  v_exp_f32 v68, v68
  v_exp_f32 v69, v69
  v_exp_f32 v70, v70
  v_exp_f32 v71, v71
  v_exp_f32 v72, v72
  v_exp_f32 v73, v73
  v_exp_f32 v74, v74
  v_exp_f32 v75, v75
  v_exp_f32 v76, v76
  v_exp_f32 v77, v77
  v_exp_f32 v78, v78
  v_exp_f32 v79, v79
  v_cvt_pk_bf16_f32 v112, v64, v65
  v_cvt_pk_bf16_f32 v113, v66, v67
  v_cvt_pk_bf16_f32 v114, v68, v69
  v_cvt_pk_bf16_f32 v115, v70, v71
  v_cvt_pk_bf16_f32 v116, v72, v73
  v_cvt_pk_bf16_f32 v117, v74, v75
  v_cvt_pk_bf16_f32 v118, v76, v77
  v_cvt_pk_bf16_f32 v119, v78, v79
  s_waitcnt lgkmcnt(0)
  v_mfma_f32_32x32x16_bf16 v[192:207], v[24:27], v[112:115], v[192:207]
  v_mfma_f32_32x32x16_bf16 v[192:207], v[28:31], v[116:119], v[192:207]
  v_mfma_f32_16x16x32_bf16 v[208:211], v[240:243], v[112:115], v[208:211]
  v_mfma_f32_16x16x32_bf16 v[208:211], v[240:243], v[116:119], v[208:211]
  s_nop 15
  ds_read_b128 v[16:19], v4 offset:4096
  ds_read_b128 v[20:23], v4 offset:4608
  s_waitcnt lgkmcnt(0)
  v_mfma_f32_32x32x16_bf16 v[64:79], v[16:19], v[8:11], 0
  v_mfma_f32_32x32x16_bf16 v[64:79], v[20:23], v[12:15], v[64:79]
  s_nop 15
  s_cmp_ge_u32 s25, 6
  s_cbranch_scc1 as2_2
  v_mov_b32 v64, 0xf149f2ca
  v_mov_b32 v65, 0xf149f2ca
  v_mov_b32 v66, 0xf149f2ca
  v_mov_b32 v67, 0xf149f2ca
  v_mov_b32 v68, 0xf149f2ca
  v_mov_b32 v69, 0xf149f2ca
  v_mov_b32 v70, 0xf149f2ca
  v_mov_b32 v71, 0xf149f2ca
  v_mov_b32 v72, 0xf149f2ca
  v_mov_b32 v73, 0xf149f2ca
  v_mov_b32 v74, 0xf149f2ca
  v_mov_b32 v75, 0xf149f2ca
  v_mov_b32 v76, 0xf149f2ca
  v_mov_b32 v77, 0xf149f2ca
  v_mov_b32 v78, 0xf149f2ca
  v_mov_b32 v79, 0xf149f2ca
as2_2:
  ds_read_b128 v[24:27], v3 offset:4096
  ds_read_b128 v[28:31], v3 offset:4608
  v_sub_f32 v64, v64, v212
  v_sub_f32 v65, v65, v212
  v_sub_f32 v66, v66, v212
  v_sub_f32 v67, v67, v212
  v_sub_f32 v68, v68, v212
  v_sub_f32 v69, v69, v212
  v_sub_f32 v70, v70, v212
  v_sub_f32 v71, v71, v212
  v_sub_f32 v72, v72, v212
  v_sub_f32 v73, v73, v212
  v_sub_f32 v74, v74, v212
  v_sub_f32 v75, v75, v212
  v_sub_f32 v76, v76, v212
  v_sub_f32 v77, v77, v212
  v_sub_f32 v78, v78, v212
  v_sub_f32 v79, v79, v212
  v_exp_f32 v64, v64
  v_exp_f32 v65, v65
  v_exp_f32 v66, v66
  v_exp_f32 v67, v67
  v_exp_f32 v68, v68
  v_exp_f32 v69, v69
  v_exp_f32 v70, v70
  v_exp_f32 v71, v71
  v_exp_f32 v72, v72
  v_exp_f32 v73, v73
  v_exp_f32 v74, v74
  v_exp_f32 v75, v75
  v_exp_f32 v76, v76
  v_exp_f32 v77, v77
  v_exp_f32 v78, v78
  v_exp_f32 v79, v79
  v_cvt_pk_bf16_f32 v112, v64, v65
  v_cvt_pk_bf16_f32 v113, v66, v67
  v_cvt_pk_bf16_f32 v114, v68, v69
  v_cvt_pk_bf16_f32 v115, v70, v71
  v_cvt_pk_bf16_f32 v116, v72, v73
  v_cvt_pk_bf16_f32 v117, v74, v75
  v_cvt_pk_bf16_f32 v118, v76, v77
  v_cvt_pk_bf16_f32 v119, v78, v79
  s_waitcnt lgkmcnt(0)
  v_mfma_f32_32x32x16_bf16 v[192:207], v[24:27], v[112:115], v[192:207]
  v_mfma_f32_32x32x16_bf16 v[192:207], v[28:31], v[116:119], v[192:207]
  v_mfma_f32_16x16x32_bf16 v[208:211], v[240:243], v[112:115], v[208:211]
  v_mfma_f32_16x16x32_bf16 v[208:211], v[240:243], v[116:119], v[208:211]
  s_nop 15
  ds_read_b128 v[16:19], v4 offset:6144
  ds_read_b128 v[20:23], v4 offset:6656
  s_waitcnt lgkmcnt(0)
  v_mfma_f32_32x32x16_bf16 v[64:79], v[16:19], v[8:11], 0
  v_mfma_f32_32x32x16_bf16 v[64:79], v[20:23], v[12:15], v[64:79]
  s_nop 15
  s_cmp_ge_u32 s25, 5
  s_cbranch_scc1 as2_3
  v_mov_b32 v64, 0xf149f2ca
  v_mov_b32 v65, 0xf149f2ca
  v_mov_b32 v66, 0xf149f2ca
  v_mov_b32 v67, 0xf149f2ca
  v_mov_b32 v68, 0xf149f2ca
  v_mov_b32 v69, 0xf149f2ca
  v_mov_b32 v70, 0xf149f2ca
  v_mov_b32 v71, 0xf149f2ca
  v_mov_b32 v72, 0xf149f2ca
  v_mov_b32 v73, 0xf149f2ca
  v_mov_b32 v74, 0xf149f2ca
  v_mov_b32 v75, 0xf149f2ca
  v_mov_b32 v76, 0xf149f2ca
  v_mov_b32 v77, 0xf149f2ca
  v_mov_b32 v78, 0xf149f2ca
  v_mov_b32 v79, 0xf149f2ca
as2_3:
  ds_read_b128 v[24:27], v3 offset:6144
  ds_read_b128 v[28:31], v3 offset:6656
  v_sub_f32 v64, v64, v212
  v_sub_f32 v65, v65, v212
  v_sub_f32 v66, v66, v212
  v_sub_f32 v67, v67, v212
  v_sub_f32 v68, v68, v212
  v_sub_f32 v69, v69, v212
  v_sub_f32 v70, v70, v212
  v_sub_f32 v71, v71, v212
  v_sub_f32 v72, v72, v212
  v_sub_f32 v73, v73, v212
  v_sub_f32 v74, v74, v212
  v_sub_f32 v75, v75, v212
  v_sub_f32 v76, v76, v212
  v_sub_f32 v77, v77, v212
  v_sub_f32 v78, v78, v212
  v_sub_f32 v79, v79, v212
  v_exp_f32 v64, v64
  v_exp_f32 v65, v65
  v_exp_f32 v66, v66
  v_exp_f32 v67, v67
  v_exp_f32 v68, v68
  v_exp_f32 v69, v69
  v_exp_f32 v70, v70
  v_exp_f32 v71, v71
  v_exp_f32 v72, v72
  v_exp_f32 v73, v73
  v_exp_f32 v74, v74
  v_exp_f32 v75, v75
  v_exp_f32 v76, v76
  v_exp_f32 v77, v77
  v_exp_f32 v78, v78
  v_exp_f32 v79, v79
  v_cvt_pk_bf16_f32 v112, v64, v65
  v_cvt_pk_bf16_f32 v113, v66, v67
  v_cvt_pk_bf16_f32 v114, v68, v69
  v_cvt_pk_bf16_f32 v115, v70, v71
  v_cvt_pk_bf16_f32 v116, v72, v73
  v_cvt_pk_bf16_f32 v117, v74, v75
  v_cvt_pk_bf16_f32 v118, v76, v77
  v_cvt_pk_bf16_f32 v119, v78, v79
  s_waitcnt lgkmcnt(0)
  v_mfma_f32_32x32x16_bf16 v[192:207], v[24:27], v[112:115], v[192:207]
  v_mfma_f32_32x32x16_bf16 v[192:207], v[28:31], v[116:119], v[192:207]
  v_mfma_f32_16x16x32_bf16 v[208:211], v[240:243], v[112:115], v[208:211]
  v_mfma_f32_16x16x32_bf16 v[208:211], v[240:243], v[116:119], v[208:211]
  s_nop 15
  ds_read_b128 v[16:19], v4 offset:8192
  ds_read_b128 v[20:23], v4 offset:8704
  s_waitcnt lgkmcnt(0)
  v_mfma_f32_32x32x16_bf16 v[64:79], v[16:19], v[8:11], 0
  v_mfma_f32_32x32x16_bf16 v[64:79], v[20:23], v[12:15], v[64:79]
  s_nop 15
  s_cmp_ge_u32 s25, 4
  s_cbranch_scc1 as2_4
  v_mov_b32 v64, 0xf149f2ca
  v_mov_b32 v65, 0xf149f2ca
  v_mov_b32 v66, 0xf149f2ca
  v_mov_b32 v67, 0xf149f2ca
  v_mov_b32 v68, 0xf149f2ca
  v_mov_b32 v69, 0xf149f2ca
  v_mov_b32 v70, 0xf149f2ca
  v_mov_b32 v71, 0xf149f2ca
  v_mov_b32 v72, 0xf149f2ca
  v_mov_b32 v73, 0xf149f2ca
  v_mov_b32 v74, 0xf149f2ca
  v_mov_b32 v75, 0xf149f2ca
  v_mov_b32 v76, 0xf149f2ca
  v_mov_b32 v77, 0xf149f2ca
  v_mov_b32 v78, 0xf149f2ca
  v_mov_b32 v79, 0xf149f2ca
as2_4:
  ds_read_b128 v[24:27], v3 offset:8192
  ds_read_b128 v[28:31], v3 offset:8704
  v_sub_f32 v64, v64, v212
  v_sub_f32 v65, v65, v212
  v_sub_f32 v66, v66, v212
  v_sub_f32 v67, v67, v212
  v_sub_f32 v68, v68, v212
  v_sub_f32 v69, v69, v212
  v_sub_f32 v70, v70, v212
  v_sub_f32 v71, v71, v212
  v_sub_f32 v72, v72, v212
  v_sub_f32 v73, v73, v212
  v_sub_f32 v74, v74, v212
  v_sub_f32 v75, v75, v212
  v_sub_f32 v76, v76, v212
  v_sub_f32 v77, v77, v212
  v_sub_f32 v78, v78, v212
  v_sub_f32 v79, v79, v212
  v_exp_f32 v64, v64
  v_exp_f32 v65, v65
  v_exp_f32 v66, v66
  v_exp_f32 v67, v67
  v_exp_f32 v68, v68
  v_exp_f32 v69, v69
  v_exp_f32 v70, v70
  v_exp_f32 v71, v71
  v_exp_f32 v72, v72
  v_exp_f32 v73, v73
  v_exp_f32 v74, v74
  v_exp_f32 v75, v75
  v_exp_f32 v76, v76
  v_exp_f32 v77, v77
  v_exp_f32 v78, v78
  v_exp_f32 v79, v79
  v_cvt_pk_bf16_f32 v112, v64, v65
  v_cvt_pk_bf16_f32 v113, v66, v67
  v_cvt_pk_bf16_f32 v114, v68, v69
  v_cvt_pk_bf16_f32 v115, v70, v71
  v_cvt_pk_bf16_f32 v116, v72, v73
  v_cvt_pk_bf16_f32 v117, v74, v75
  v_cvt_pk_bf16_f32 v118, v76, v77
  v_cvt_pk_bf16_f32 v119, v78, v79
  s_waitcnt lgkmcnt(0)
  v_mfma_f32_32x32x16_bf16 v[192:207], v[24:27], v[112:115], v[192:207]
  v_mfma_f32_32x32x16_bf16 v[192:207], v[28:31], v[116:119], v[192:207]
  v_mfma_f32_16x16x32_bf16 v[208:211], v[240:243], v[112:115], v[208:211]
  v_mfma_f32_16x16x32_bf16 v[208:211], v[240:243], v[116:119], v[208:211]
  s_nop 15
  ds_read_b128 v[16:19], v4 offset:10240
  ds_read_b128 v[20:23], v4 offset:10752
  s_waitcnt lgkmcnt(0)
  v_mfma_f32_32x32x16_bf16 v[64:79], v[16:19], v[8:11], 0
  v_mfma_f32_32x32x16_bf16 v[64:79], v[20:23], v[12:15], v[64:79]
  s_nop 15
  s_cmp_ge_u32 s25, 3
  s_cbranch_scc1 as2_5
  v_mov_b32 v64, 0xf149f2ca
  v_mov_b32 v65, 0xf149f2ca
  v_mov_b32 v66, 0xf149f2ca
  v_mov_b32 v67, 0xf149f2ca
  v_mov_b32 v68, 0xf149f2ca
  v_mov_b32 v69, 0xf149f2ca
  v_mov_b32 v70, 0xf149f2ca
  v_mov_b32 v71, 0xf149f2ca
  v_mov_b32 v72, 0xf149f2ca
  v_mov_b32 v73, 0xf149f2ca
  v_mov_b32 v74, 0xf149f2ca
  v_mov_b32 v75, 0xf149f2ca
  v_mov_b32 v76, 0xf149f2ca
  v_mov_b32 v77, 0xf149f2ca
  v_mov_b32 v78, 0xf149f2ca
  v_mov_b32 v79, 0xf149f2ca
as2_5:
  ds_read_b128 v[24:27], v3 offset:10240
  ds_read_b128 v[28:31], v3 offset:10752
  v_sub_f32 v64, v64, v212
  v_sub_f32 v65, v65, v212
  v_sub_f32 v66, v66, v212
  v_sub_f32 v67, v67, v212
  v_sub_f32 v68, v68, v212
  v_sub_f32 v69, v69, v212
  v_sub_f32 v70, v70, v212
  v_sub_f32 v71, v71, v212
  v_sub_f32 v72, v72, v212
  v_sub_f32 v73, v73, v212
  v_sub_f32 v74, v74, v212
  v_sub_f32 v75, v75, v212
  v_sub_f32 v76, v76, v212
  v_sub_f32 v77, v77, v212
  v_sub_f32 v78, v78, v212
  v_sub_f32 v79, v79, v212
  v_exp_f32 v64, v64
  v_exp_f32 v65, v65
  v_exp_f32 v66, v66
  v_exp_f32 v67, v67
  v_exp_f32 v68, v68
  v_exp_f32 v69, v69
  v_exp_f32 v70, v70
  v_exp_f32 v71, v71
  v_exp_f32 v72, v72
  v_exp_f32 v73, v73
  v_exp_f32 v74, v74
  v_exp_f32 v75, v75
  v_exp_f32 v76, v76
  v_exp_f32 v77, v77
  v_exp_f32 v78, v78
  v_exp_f32 v79, v79
  v_cvt_pk_bf16_f32 v112, v64, v65
  v_cvt_pk_bf16_f32 v113, v66, v67
  v_cvt_pk_bf16_f32 v114, v68, v69
  v_cvt_pk_bf16_f32 v115, v70, v71
  v_cvt_pk_bf16_f32 v116, v72, v73
  v_cvt_pk_bf16_f32 v117, v74, v75
  v_cvt_pk_bf16_f32 v118, v76, v77
  v_cvt_pk_bf16_f32 v119, v78, v79
  s_waitcnt lgkmcnt(0)
  v_mfma_f32_32x32x16_bf16 v[192:207], v[24:27], v[112:115], v[192:207]
  v_mfma_f32_32x32x16_bf16 v[192:207], v[28:31], v[116:119], v[192:207]
  v_mfma_f32_16x16x32_bf16 v[208:211], v[240:243], v[112:115], v[208:211]
  v_mfma_f32_16x16x32_bf16 v[208:211], v[240:243], v[116:119], v[208:211]
  s_nop 15
  ds_read_b128 v[16:19], v4 offset:12288
  ds_read_b128 v[20:23], v4 offset:12800
  s_waitcnt lgkmcnt(0)
  v_mfma_f32_32x32x16_bf16 v[64:79], v[16:19], v[8:11], 0
  v_mfma_f32_32x32x16_bf16 v[64:79], v[20:23], v[12:15], v[64:79]
  s_nop 15
  s_cmp_ge_u32 s25, 2
  s_cbranch_scc1 as2_6
  v_mov_b32 v64, 0xf149f2ca
  v_mov_b32 v65, 0xf149f2ca
  v_mov_b32 v66, 0xf149f2ca
  v_mov_b32 v67, 0xf149f2ca
  v_mov_b32 v68, 0xf149f2ca
  v_mov_b32 v69, 0xf149f2ca
  v_mov_b32 v70, 0xf149f2ca
  v_mov_b32 v71, 0xf149f2ca
  v_mov_b32 v72, 0xf149f2ca
  v_mov_b32 v73, 0xf149f2ca
  v_mov_b32 v74, 0xf149f2ca
  v_mov_b32 v75, 0xf149f2ca
  v_mov_b32 v76, 0xf149f2ca
  v_mov_b32 v77, 0xf149f2ca
  v_mov_b32 v78, 0xf149f2ca
  v_mov_b32 v79, 0xf149f2ca
as2_6:
  ds_read_b128 v[24:27], v3 offset:12288
  ds_read_b128 v[28:31], v3 offset:12800
  v_sub_f32 v64, v64, v212
  v_sub_f32 v65, v65, v212
  v_sub_f32 v66, v66, v212
  v_sub_f32 v67, v67, v212
  v_sub_f32 v68, v68, v212
  v_sub_f32 v69, v69, v212
  v_sub_f32 v70, v70, v212
  v_sub_f32 v71, v71, v212
  v_sub_f32 v72, v72, v212
  v_sub_f32 v73, v73, v212
  v_sub_f32 v74, v74, v212
  v_sub_f32 v75, v75, v212
  v_sub_f32 v76, v76, v212
  v_sub_f32 v77, v77, v212
  v_sub_f32 v78, v78, v212
  v_sub_f32 v79, v79, v212
  v_exp_f32 v64, v64
  v_exp_f32 v65, v65
  v_exp_f32 v66, v66
  v_exp_f32 v67, v67
  v_exp_f32 v68, v68
  v_exp_f32 v69, v69
  v_exp_f32 v70, v70
  v_exp_f32 v71, v71
  v_exp_f32 v72, v72
  v_exp_f32 v73, v73
  v_exp_f32 v74, v74
  v_exp_f32 v75, v75
  v_exp_f32 v76, v76
  v_exp_f32 v77, v77
  v_exp_f32 v78, v78
  v_exp_f32 v79, v79
  v_cvt_pk_bf16_f32 v112, v64, v65
  v_cvt_pk_bf16_f32 v113, v66, v67
  v_cvt_pk_bf16_f32 v114, v68, v69
  v_cvt_pk_bf16_f32 v115, v70, v71
  v_cvt_pk_bf16_f32 v116, v72, v73
  v_cvt_pk_bf16_f32 v117, v74, v75
  v_cvt_pk_bf16_f32 v118, v76, v77
  v_cvt_pk_bf16_f32 v119, v78, v79
  s_waitcnt lgkmcnt(0)
  v_mfma_f32_32x32x16_bf16 v[192:207], v[24:27], v[112:115], v[192:207]
  v_mfma_f32_32x32x16_bf16 v[192:207], v[28:31], v[116:119], v[192:207]
  v_mfma_f32_16x16x32_bf16 v[208:211], v[240:243], v[112:115], v[208:211]
  v_mfma_f32_16x16x32_bf16 v[208:211], v[240:243], v[116:119], v[208:211]
  s_nop 15
  ds_read_b128 v[16:19], v4 offset:14336
  ds_read_b128 v[20:23], v4 offset:14848
  s_waitcnt lgkmcnt(0)
  v_mfma_f32_32x32x16_bf16 v[64:79], v[16:19], v[8:11], 0
  v_mfma_f32_32x32x16_bf16 v[64:79], v[20:23], v[12:15], v[64:79]
  s_nop 15
  s_cmp_ge_u32 s25, 1
  s_cbranch_scc1 as2_7
  v_mov_b32 v64, 0xf149f2ca
  v_mov_b32 v65, 0xf149f2ca
  v_mov_b32 v66, 0xf149f2ca
  v_mov_b32 v67, 0xf149f2ca
  v_mov_b32 v68, 0xf149f2ca
  v_mov_b32 v69, 0xf149f2ca
  v_mov_b32 v70, 0xf149f2ca
  v_mov_b32 v71, 0xf149f2ca
  v_mov_b32 v72, 0xf149f2ca
  v_mov_b32 v73, 0xf149f2ca
  v_mov_b32 v74, 0xf149f2ca
  v_mov_b32 v75, 0xf149f2ca
  v_mov_b32 v76, 0xf149f2ca
  v_mov_b32 v77, 0xf149f2ca
  v_mov_b32 v78, 0xf149f2ca
  v_mov_b32 v79, 0xf149f2ca
as2_7:
  ds_read_b128 v[24:27], v3 offset:14336
  ds_read_b128 v[28:31], v3 offset:14848
  v_sub_f32 v64, v64, v212
  v_sub_f32 v65, v65, v212
  v_sub_f32 v66, v66, v212
  v_sub_f32 v67, v67, v212
  v_sub_f32 v68, v68, v212
  v_sub_f32 v69, v69, v212
  v_sub_f32 v70, v70, v212
  v_sub_f32 v71, v71, v212
  v_sub_f32 v72, v72, v212
  v_sub_f32 v73, v73, v212
  v_sub_f32 v74, v74, v212
  v_sub_f32 v75, v75, v212
  v_sub_f32 v76, v76, v212
  v_sub_f32 v77, v77, v212
  v_sub_f32 v78, v78, v212
  v_sub_f32 v79, v79, v212
  v_exp_f32 v64, v64
  v_exp_f32 v65, v65
  v_exp_f32 v66, v66
  v_exp_f32 v67, v67
  v_exp_f32 v68, v68
  v_exp_f32 v69, v69
  v_exp_f32 v70, v70
  v_exp_f32 v71, v71
  v_exp_f32 v72, v72
  v_exp_f32 v73, v73
  v_exp_f32 v74, v74
  v_exp_f32 v75, v75
  v_exp_f32 v76, v76
  v_exp_f32 v77, v77
  v_exp_f32 v78, v78
  v_exp_f32 v79, v79
  v_cvt_pk_bf16_f32 v112, v64, v65
  v_cvt_pk_bf16_f32 v113, v66, v67
  v_cvt_pk_bf16_f32 v114, v68, v69
  v_cvt_pk_bf16_f32 v115, v70, v71
  v_cvt_pk_bf16_f32 v116, v72, v73
  v_cvt_pk_bf16_f32 v117, v74, v75
  v_cvt_pk_bf16_f32 v118, v76, v77
  v_cvt_pk_bf16_f32 v119, v78, v79
  s_waitcnt lgkmcnt(0)
  v_mfma_f32_32x32x16_bf16 v[192:207], v[24:27], v[112:115], v[192:207]
  v_mfma_f32_32x32x16_bf16 v[192:207], v[28:31], v[116:119], v[192:207]
  v_mfma_f32_16x16x32_bf16 v[208:211], v[240:243], v[112:115], v[208:211]
  v_mfma_f32_16x16x32_bf16 v[208:211], v[240:243], v[116:119], v[208:211]
  s_nop 15
  ds_read_b128 v[16:19], v4 offset:16384
  ds_read_b128 v[20:23], v4 offset:16896
  s_waitcnt lgkmcnt(0)
  v_mfma_f32_32x32x16_bf16 v[64:79], v[16:19], v[8:11], 0
  v_mfma_f32_32x32x16_bf16 v[64:79], v[20:23], v[12:15], v[64:79]
  s_nop 15
  v_mov_b32 v215, 0xf149f2ca
  v_cmp_le_i32 vcc, 0, v7
  s_nop 1
  v_cndmask_b32 v64, v215, v64, vcc
  v_cmp_le_i32 vcc, 1, v7
  s_nop 1
  v_cndmask_b32 v65, v215, v65, vcc
  v_cmp_le_i32 vcc, 2, v7
  s_nop 1
  v_cndmask_b32 v66, v215, v66, vcc
  v_cmp_le_i32 vcc, 3, v7
  s_nop 1
  v_cndmask_b32 v67, v215, v67, vcc
  v_cmp_le_i32 vcc, 8, v7
  s_nop 1
  v_cndmask_b32 v68, v215, v68, vcc
  v_cmp_le_i32 vcc, 9, v7
  s_nop 1
  v_cndmask_b32 v69, v215, v69, vcc
  v_cmp_le_i32 vcc, 10, v7
  s_nop 1
  v_cndmask_b32 v70, v215, v70, vcc
  v_cmp_le_i32 vcc, 11, v7
  s_nop 1
  v_cndmask_b32 v71, v215, v71, vcc
  v_cmp_le_i32 vcc, 16, v7
  s_nop 1
  v_cndmask_b32 v72, v215, v72, vcc
  v_cmp_le_i32 vcc, 17, v7
  s_nop 1
  v_cndmask_b32 v73, v215, v73, vcc
  v_cmp_le_i32 vcc, 18, v7
  s_nop 1
  v_cndmask_b32 v74, v215, v74, vcc
  v_cmp_le_i32 vcc, 19, v7
  s_nop 1
  v_cndmask_b32 v75, v215, v75, vcc
  v_cmp_le_i32 vcc, 24, v7
  s_nop 1
  v_cndmask_b32 v76, v215, v76, vcc
  v_cmp_le_i32 vcc, 25, v7
  s_nop 1
  v_cndmask_b32 v77, v215, v77, vcc
  v_cmp_le_i32 vcc, 26, v7
  s_nop 1
  v_cndmask_b32 v78, v215, v78, vcc
  v_cmp_le_i32 vcc, 27, v7
  s_nop 1
  v_cndmask_b32 v79, v215, v79, vcc
  ds_read_b128 v[24:27], v3 offset:16384
  ds_read_b128 v[28:31], v3 offset:16896
  v_sub_f32 v64, v64, v212
  v_sub_f32 v65, v65, v212
  v_sub_f32 v66, v66, v212
  v_sub_f32 v67, v67, v212
  v_sub_f32 v68, v68, v212
  v_sub_f32 v69, v69, v212
  v_sub_f32 v70, v70, v212
  v_sub_f32 v71, v71, v212
  v_sub_f32 v72, v72, v212
  v_sub_f32 v73, v73, v212
  v_sub_f32 v74, v74, v212
  v_sub_f32 v75, v75, v212
  v_sub_f32 v76, v76, v212
  v_sub_f32 v77, v77, v212
  v_sub_f32 v78, v78, v212
  v_sub_f32 v79, v79, v212
  v_exp_f32 v64, v64
  v_exp_f32 v65, v65
  v_exp_f32 v66, v66
  v_exp_f32 v67, v67
  v_exp_f32 v68, v68
  v_exp_f32 v69, v69
  v_exp_f32 v70, v70
  v_exp_f32 v71, v71
  v_exp_f32 v72, v72
  v_exp_f32 v73, v73
  v_exp_f32 v74, v74
  v_exp_f32 v75, v75
  v_exp_f32 v76, v76
  v_exp_f32 v77, v77
  v_exp_f32 v78, v78
  v_exp_f32 v79, v79
  v_cvt_pk_bf16_f32 v112, v64, v65
  v_cvt_pk_bf16_f32 v113, v66, v67
  v_cvt_pk_bf16_f32 v114, v68, v69
  v_cvt_pk_bf16_f32 v115, v70, v71
  v_cvt_pk_bf16_f32 v116, v72, v73
  v_cvt_pk_bf16_f32 v117, v74, v75
  v_cvt_pk_bf16_f32 v118, v76, v77
  v_cvt_pk_bf16_f32 v119, v78, v79
  s_waitcnt lgkmcnt(0)
  v_mfma_f32_32x32x16_bf16 v[192:207], v[24:27], v[112:115], v[192:207]
  v_mfma_f32_32x32x16_bf16 v[192:207], v[28:31], v[116:119], v[192:207]
  v_mfma_f32_16x16x32_bf16 v[208:211], v[240:243], v[112:115], v[208:211]
  v_mfma_f32_16x16x32_bf16 v[208:211], v[240:243], v[116:119], v[208:211]
  s_nop 15
  v_rcp_f32 v212, v208
  s_nop 1
  s_cmp_lt_u32 s3, 4
  s_cbranch_scc1 att_fin0
  s_branch att_fin1
mk_code_end:
.section .rodata,"a"
.p2align 6
.amdhsa_kernel concat_heads__ssm_conv_h3__sliding_block__prompt_kernel
  .amdhsa_next_free_vgpr 256
  .amdhsa_next_free_sgpr 100
  .amdhsa_accum_offset 256
  .amdhsa_group_segment_fixed_size 0
  .amdhsa_kernarg_size 96
  .amdhsa_user_sgpr_count 2
  .amdhsa_user_sgpr_kernarg_segment_ptr 1
  .amdhsa_system_sgpr_workgroup_id_x 1
.end_amdhsa_kernel
```
